```python
import torch

def _softmax(x, axis=-1):
    return torch.softmax(x, dim=axis)
def _gelu(x):
    return torch.nn.functional.gelu(x, approximate="tanh")
def _silu(x):
    return torch.nn.functional.silu(x)
def _sigmoid(x):
    return torch.sigmoid(x)
def _layernorm(x, axis=-1, eps=1e-5):
    m = x.mean(dim=axis, keepdim=True)
    v = x.var(dim=axis, keepdim=True, unbiased=False)
    return (x - m) / torch.sqrt(v + eps)
def _scatter_add(tgt, idx, src, axis=0):
    return tgt.clone().index_add_(axis, idx, src)
def _segment_sum(src, seg, n):
    out = torch.zeros((n,) + src.shape[1:], dtype=src.dtype)
    return out.index_add_(0, seg, src)
def _pad(x, pw):
    flat = tuple(v for pair in reversed(pw) for v in pair)
    return torch.nn.functional.pad(x, flat)

kernel_name = 'gated_mix__compressed_kv_cla__grouped_kv_mqa__prompt'

def setup_inputs():

    _w = (lambda a: (lambda t: t.to(torch.bfloat16) if t.is_floating_point() else t)(torch.as_tensor(a)))
    def _A_setup():
        B, H, Sq, Sk, D, M = 1, 32, 2048, 2048, 128, 512
        Dc = 4 * D
        return {
            "x": _w((lambda *s: torch.randn(*s, dtype=torch.bfloat16) * 0.05)(B, Sq, M)),
            "c_kv": _w((lambda *s: torch.randn(*s, dtype=torch.bfloat16) * 0.8)(B, Sk, Dc)),
            "w_q": _w((lambda *s: torch.randn(*s, dtype=torch.bfloat16) * 6.4)(M, H, D) * (M ** -0.5)),
            "w_uk": _w((lambda *s: torch.randn(*s, dtype=torch.bfloat16) * 6.4)(Dc, H, D) * (Dc ** -0.5)),
            "w_uv": _w((lambda *s: torch.randn(*s, dtype=torch.bfloat16) * 0.8)(Dc, H, D) * (Dc ** -0.5)),
            "w_o": _w((lambda *s: torch.randn(*s, dtype=torch.bfloat16) * 0.8)(H, D, M) * ((H * D) ** -0.5)),
        }
    _A_in = _A_setup()

    def _B_setup():
        B, S, D, H = 1, 2048, 512, 32
        Dh = D // H
        return {
            "x": _w((lambda *s: torch.randn(*s, dtype=torch.bfloat16) * 0.05)(B, S, D)),
            "wq": _w((lambda *s: torch.randn(*s, dtype=torch.bfloat16) * 3.2)(D, H * Dh)),
            "wk": _w((lambda *s: torch.randn(*s, dtype=torch.bfloat16) * 3.2)(D, Dh)),
            "wv": _w((lambda *s: torch.randn(*s, dtype=torch.bfloat16) * 0.1)(D, Dh)),
            "wo": _w((lambda *s: torch.randn(*s, dtype=torch.bfloat16) * 0.1)(H * Dh, D)),
        }
    _B_in = _B_setup()

    return {
        "A_x": _A_in["x"],
        "A_c_kv": _A_in["c_kv"],
        "A_w_q": _A_in["w_q"],
        "A_w_uk": _A_in["w_uk"],
        "A_w_uv": _A_in["w_uv"],
        "A_w_o": _A_in["w_o"],
        "B_x": _B_in["x"],
        "B_wq": _B_in["wq"],
        "B_wk": _B_in["wk"],
        "B_wv": _B_in["wv"],
        "B_wo": _B_in["wo"],
        "gate_w": _w((lambda *s: torch.randn(*s, dtype=torch.bfloat16) * 0.05)(512) * 16.0),
    }

def reference(A_x, A_c_kv, A_w_q, A_w_uk, A_w_uv, A_w_o, B_x, B_wq, B_wk, B_wv, B_wo, gate_w):
    def _A_ref(x, c_kv, w_q, w_uk, w_uv, w_o):
        B, Sq, M = x.shape[0], x.shape[1], x.shape[2]
        Sk = c_kv.shape[1]
        H, D = w_q.shape[1], w_q.shape[2]
        q = torch.einsum("bqm,mhd->bhqd", x, w_q)
        k = torch.einsum("bkc,chd->bhkd", c_kv, w_uk)
        v = torch.einsum("bkc,chd->bhkd", c_kv, w_uv)
        scores = torch.einsum("bhqd,bhkd->bhqk", q, k) * (D ** -0.5)
        off = Sk - Sq
        qi = torch.arange(Sq)[:, None]
        kj = torch.arange(Sk)[None, :]
        cmask = kj <= (qi + off)
        scores = torch.where(cmask[None, None], scores, -1e9)
        p = _softmax(scores, axis=-1)
        ctx = torch.einsum("bhqk,bhkd->bhqd", p, v)
        return torch.einsum("bhqd,hdm->bqm", ctx, w_o)

    def _B_ref(x, wq, wk, wv, wo):
        B, S, D = x.shape
        H = 32
        Dh = D // H
        q = (lambda x, *d: x.permute(*d))((x @ wq).reshape(B, S, H, Dh), 0, 2, 1, 3)
        k = x @ wk
        v = x @ wv
        scores = torch.einsum("bhqd,bkd->bhqk", q, k) * (Dh ** -0.5)
        p = _softmax(scores, axis=-1)
        o = torch.einsum("bhqk,bkd->bhqd", p, v)
        return (lambda x, *d: x.permute(*d))(o, 0, 2, 1, 3).reshape(B, S, H * Dh) @ wo

    x = A_x
    g = _sigmoid((x * gate_w).sum(-1, keepdims=True))
    a = _A_ref(x, A_c_kv, A_w_q, A_w_uk, A_w_uv, A_w_o)
    b = _B_ref(x, B_wq, B_wk, B_wv, B_wo)
    return g * a + (1 - g) * b
```

```asm
; @launch kernel=proj_kernel grid=(256,1,1) block=(256,1,1) lds=163840
; @launch kernel=projb_kernel grid=(48,1,1) block=(256,1,1) lds=163840
; @launch kernel=attna_kernel grid=(256,1,1) block=(256,1,1) lds=65536
; @launch kernel=attnb_kernel grid=(256,1,1) block=(512,1,1) lds=131072
; @launch kernel=outp_kernel grid=(256,1,1) block=(256,1,1) lds=32768
.amdgcn_target "amdgcn-amd-amdhsa--gfx950"
.text
.globl proj_kernel
.p2align 8
.type proj_kernel,@function
proj_kernel:
    s_cmp_ge_u32 s2, 256
    s_cbranch_scc1 proj_kernel_end
    s_load_dwordx2 s[4:5], s[0:1], 0
    s_load_dwordx2 s[6:7], s[0:1], 8
    s_load_dwordx2 s[8:9], s[0:1], 16
    s_load_dwordx2 s[10:11], s[0:1], 24
    s_load_dwordx2 s[12:13], s[0:1], 32
    s_load_dwordx2 s[14:15], s[0:1], 112
    s_lshr_b32 s16, s2, 5
    s_and_b32 s17, s2, 31
    v_lshrrev_b32 v180, 6, v0
    v_and_b32 v183, 63, v0
    v_and_b32 v181, 31, v0
    v_lshrrev_b32 v182, 5, v183
    s_nop 1
    v_readfirstlane_b32 s18, v180
    s_waitcnt lgkmcnt(0)
    s_mov_b32 s20, s4
    s_mov_b32 s21, s5
    s_mov_b32 s22, 0x200000
    s_mov_b32 s23, 0x00020000
    s_mov_b32 s24, s6
    s_mov_b32 s25, s7
    s_mov_b32 s26, 0x200000
    s_mov_b32 s27, 0x00020000
    s_mov_b32 s28, s8
    s_mov_b32 s29, s9
    s_mov_b32 s30, 0x400000
    s_mov_b32 s31, 0x00020000
    s_mov_b32 s32, s10
    s_mov_b32 s33, s11
    s_mov_b32 s34, 0x400000
    s_mov_b32 s35, 0x00020000
    s_mov_b32 s36, s12
    s_mov_b32 s37, s13
    s_mov_b32 s38, 0x400000
    s_mov_b32 s39, 0x00020000
    s_mov_b32 s40, s14
    s_mov_b32 s41, s15
    s_mov_b32 s42, 0x1000000
    s_mov_b32 s43, 0x00020000
    s_add_u32 s44, s14, 0x1000000
    s_addc_u32 s45, s15, 0x0
    s_mov_b32 s46, 0x1000000
    s_mov_b32 s47, 0x00020000
    s_add_u32 s48, s14, 0x2000000
    s_addc_u32 s49, s15, 0x0
    s_mov_b32 s50, 0x1000000
    s_mov_b32 s51, 0x00020000
    v_lshrrev_b32 v184, 4, v183
    v_lshlrev_b32 v185, 2, v184
    v_and_b32 v1, 15, v183
    v_xor_b32 v1, v1, v185
    v_lshlrev_b32 v1, 4, v1
    v_lshlrev_b32 v184, 13, v184
    v_add_u32 v1, v1, v184
    v_lshrrev_b32 v184, 4, v183
    v_add_u32 v184, 0, v184
    v_and_b32 v184, 7, v184
    v_and_b32 v185, 7, v183
    v_xor_b32 v184, v184, v185
    v_lshlrev_b32 v184, 4, v184
    v_lshrrev_b32 v185, 3, v183
    v_lshlrev_b32 v185, 10, v185
    v_add_u32 v2, v184, v185
    v_lshrrev_b32 v184, 4, v183
    v_add_u32 v184, 4, v184
    v_and_b32 v184, 7, v184
    v_and_b32 v185, 7, v183
    v_xor_b32 v184, v184, v185
    v_lshlrev_b32 v184, 4, v184
    v_lshrrev_b32 v185, 3, v183
    v_lshlrev_b32 v185, 10, v185
    v_add_u32 v3, v184, v185
    v_lshlrev_b32 v184, 6, v180
    v_add_u32 v184, v184, v181
    v_lshlrev_b32 v184, 7, v184
    v_lshrrev_b32 v185, 1, v181
    v_and_b32 v185, 7, v185
    v_lshlrev_b32 v186, 2, v182
    v_add_u32 v4, 0, v186
    v_xor_b32 v4, v4, v185
    v_lshlrev_b32 v4, 4, v4
    v_add_u32 v4, v4, v184
    v_add_u32 v4, 65536, v4
    v_add_u32 v5, 1, v186
    v_xor_b32 v5, v5, v185
    v_lshlrev_b32 v5, 4, v5
    v_add_u32 v5, v5, v184
    v_add_u32 v5, 65536, v5
    v_add_u32 v6, 2, v186
    v_xor_b32 v6, v6, v185
    v_lshlrev_b32 v6, 4, v6
    v_add_u32 v6, v6, v184
    v_add_u32 v6, 65536, v6
    v_add_u32 v7, 3, v186
    v_xor_b32 v7, v7, v185
    v_lshlrev_b32 v7, 4, v7
    v_add_u32 v7, v7, v184
    v_add_u32 v7, 65536, v7
    v_add_u32 v8, 65536, v4
    v_add_u32 v9, 65536, v5
    v_add_u32 v10, 65536, v6
    v_add_u32 v11, 65536, v7
    s_lshl_b32 s52, s18, 17
    s_lshl_b32 s53, s17, 8
    s_add_u32 s52, s52, s53
    s_lshl_b32 s54, s18, 12
    s_lshl_b32 s55, s16, 8
    s_lshl_b32 s53, s18, 6
    s_add_u32 s55, s55, s53
    s_lshl_b32 s55, s55, 10
    s_lshl_b32 s56, s18, 13
    s_lshl_b32 s57, s17, 6
    s_lshl_b32 s53, s16, 3
    s_add_u32 s57, s57, s53
    s_lshl_b32 s53, s18, 1
    s_add_u32 s57, s57, s53
    s_lshl_b32 s57, s57, 13
    s_lshl_b32 s58, s17, 9
    s_lshl_b32 s53, s16, 4
    s_add_u32 s58, s58, s53
    s_lshl_b32 s53, s18, 2
    s_add_u32 s58, s58, s53
    s_lshl_b32 s58, s58, 10
    v_lshrrev_b32 v187, 4, v183
    v_and_b32 v188, 15, v183
    v_lshrrev_b32 v188, 2, v188
    v_lshrrev_b32 v184, 1, v187
    v_lshlrev_b32 v184, 5, v184
    v_add_u32 v184, v184, v188
    v_lshlrev_b32 v184, 8, v184
    v_and_b32 v185, 1, v187
    v_lshlrev_b32 v185, 5, v185
    v_add_u32 v184, v184, v185
    v_and_b32 v185, 3, v183
    v_lshlrev_b32 v185, 3, v185
    v_add_u32 v184, v184, v185
    v_xor_b32 v185, 0, v188
    v_lshlrev_b32 v185, 6, v185
    v_add_u32 v12, v184, v185
    v_xor_b32 v185, 1, v188
    v_lshlrev_b32 v185, 6, v185
    v_add_u32 v13, v184, v185
    v_xor_b32 v185, 2, v188
    v_lshlrev_b32 v185, 6, v185
    v_add_u32 v14, v184, v185
    v_xor_b32 v185, 3, v188
    v_lshlrev_b32 v185, 6, v185
    v_add_u32 v15, v184, v185
    v_lshlrev_b32 v16, 4, v183
    s_add_u32 s53, s55, 0x0
    s_add_u32 m0, s56, 0x10000
    buffer_load_dwordx4 v2, s[20:23], s53 offen lds
    s_add_u32 s53, s55, 0x2000
    s_add_u32 m0, s56, 0x10400
    buffer_load_dwordx4 v3, s[20:23], s53 offen lds
    s_add_u32 s53, s55, 0x4000
    s_add_u32 m0, s56, 0x10800
    buffer_load_dwordx4 v2, s[20:23], s53 offen lds
    s_add_u32 s53, s55, 0x6000
    s_add_u32 m0, s56, 0x10c00
    buffer_load_dwordx4 v3, s[20:23], s53 offen lds
    s_add_u32 s53, s55, 0x8000
    s_add_u32 m0, s56, 0x11000
    buffer_load_dwordx4 v2, s[20:23], s53 offen lds
    s_add_u32 s53, s55, 0xa000
    s_add_u32 m0, s56, 0x11400
    buffer_load_dwordx4 v3, s[20:23], s53 offen lds
    s_add_u32 s53, s55, 0xc000
    s_add_u32 m0, s56, 0x11800
    buffer_load_dwordx4 v2, s[20:23], s53 offen lds
    s_add_u32 s53, s55, 0xe000
    s_add_u32 m0, s56, 0x11c00
    buffer_load_dwordx4 v3, s[20:23], s53 offen lds
    s_add_u32 s53, s52, 0x0
    s_add_u32 m0, s54, 0x0
    buffer_load_dwordx4 v1, s[28:31], s53 offen lds
    s_add_u32 s53, s52, 0x8000
    s_add_u32 m0, s54, 0x400
    buffer_load_dwordx4 v1, s[28:31], s53 offen lds
    s_add_u32 s53, s52, 0x10000
    s_add_u32 m0, s54, 0x800
    buffer_load_dwordx4 v1, s[28:31], s53 offen lds
    s_add_u32 s53, s52, 0x18000
    s_add_u32 m0, s54, 0xc00
    buffer_load_dwordx4 v1, s[28:31], s53 offen lds
    s_add_u32 s53, s55, 0x80
    s_add_u32 m0, s56, 0x18000
    buffer_load_dwordx4 v2, s[20:23], s53 offen lds
    s_add_u32 s53, s55, 0x2080
    s_add_u32 m0, s56, 0x18400
    buffer_load_dwordx4 v3, s[20:23], s53 offen lds
    s_add_u32 s53, s55, 0x4080
    s_add_u32 m0, s56, 0x18800
    buffer_load_dwordx4 v2, s[20:23], s53 offen lds
    s_add_u32 s53, s55, 0x6080
    s_add_u32 m0, s56, 0x18c00
    buffer_load_dwordx4 v3, s[20:23], s53 offen lds
    s_add_u32 s53, s55, 0x8080
    s_add_u32 m0, s56, 0x19000
    buffer_load_dwordx4 v2, s[20:23], s53 offen lds
    s_add_u32 s53, s55, 0xa080
    s_add_u32 m0, s56, 0x19400
    buffer_load_dwordx4 v3, s[20:23], s53 offen lds
    s_add_u32 s53, s55, 0xc080
    s_add_u32 m0, s56, 0x19800
    buffer_load_dwordx4 v2, s[20:23], s53 offen lds
    s_add_u32 s53, s55, 0xe080
    s_add_u32 m0, s56, 0x19c00
    buffer_load_dwordx4 v3, s[20:23], s53 offen lds
    s_add_u32 s53, s52, 0x80000
    s_add_u32 m0, s54, 0x4000
    buffer_load_dwordx4 v1, s[28:31], s53 offen lds
    s_add_u32 s53, s52, 0x88000
    s_add_u32 m0, s54, 0x4400
    buffer_load_dwordx4 v1, s[28:31], s53 offen lds
    s_add_u32 s53, s52, 0x90000
    s_add_u32 m0, s54, 0x4800
    buffer_load_dwordx4 v1, s[28:31], s53 offen lds
    s_add_u32 s53, s52, 0x98000
    s_add_u32 m0, s54, 0x4c00
    buffer_load_dwordx4 v1, s[28:31], s53 offen lds
    s_add_u32 s53, s55, 0x100
    s_add_u32 m0, s56, 0x20000
    buffer_load_dwordx4 v2, s[20:23], s53 offen lds
    s_add_u32 s53, s55, 0x2100
    s_add_u32 m0, s56, 0x20400
    buffer_load_dwordx4 v3, s[20:23], s53 offen lds
    s_add_u32 s53, s55, 0x4100
    s_add_u32 m0, s56, 0x20800
    buffer_load_dwordx4 v2, s[20:23], s53 offen lds
    s_add_u32 s53, s55, 0x6100
    s_add_u32 m0, s56, 0x20c00
    buffer_load_dwordx4 v3, s[20:23], s53 offen lds
    s_add_u32 s53, s55, 0x8100
    s_add_u32 m0, s56, 0x21000
    buffer_load_dwordx4 v2, s[20:23], s53 offen lds
    s_add_u32 s53, s55, 0xa100
    s_add_u32 m0, s56, 0x21400
    buffer_load_dwordx4 v3, s[20:23], s53 offen lds
    s_add_u32 s53, s55, 0xc100
    s_add_u32 m0, s56, 0x21800
    buffer_load_dwordx4 v2, s[20:23], s53 offen lds
    s_add_u32 s53, s55, 0xe100
    s_add_u32 m0, s56, 0x21c00
    buffer_load_dwordx4 v3, s[20:23], s53 offen lds
    s_add_u32 s53, s52, 0x100000
    s_add_u32 m0, s54, 0x8000
    buffer_load_dwordx4 v1, s[28:31], s53 offen lds
    s_add_u32 s53, s52, 0x108000
    s_add_u32 m0, s54, 0x8400
    buffer_load_dwordx4 v1, s[28:31], s53 offen lds
    s_add_u32 s53, s52, 0x110000
    s_add_u32 m0, s54, 0x8800
    buffer_load_dwordx4 v1, s[28:31], s53 offen lds
    s_add_u32 s53, s52, 0x118000
    s_add_u32 m0, s54, 0x8c00
    buffer_load_dwordx4 v1, s[28:31], s53 offen lds
    s_waitcnt vmcnt(24)
    s_barrier
    ds_read_b64_tr_b16 v[148:149], v12 offset:0
    ds_read_b64_tr_b16 v[150:151], v12 offset:1024
    ds_read_b64_tr_b16 v[152:153], v13 offset:0
    ds_read_b64_tr_b16 v[154:155], v13 offset:1024
    ds_read_b64_tr_b16 v[156:157], v14 offset:0
    ds_read_b64_tr_b16 v[158:159], v14 offset:1024
    ds_read_b64_tr_b16 v[160:161], v15 offset:0
    ds_read_b64_tr_b16 v[162:163], v15 offset:1024
    ds_read_b128 a[0:3], v4 offset:0
    ds_read_b128 a[4:7], v5 offset:0
    ds_read_b128 a[8:11], v6 offset:0
    ds_read_b128 a[12:15], v7 offset:0
    ds_read_b128 a[128:131], v4 offset:4096
    ds_read_b128 a[132:135], v5 offset:4096
    ds_read_b128 a[136:139], v6 offset:4096
    ds_read_b128 a[140:143], v7 offset:4096
    s_waitcnt lgkmcnt(11)
    s_waitcnt vmcnt(12)
    s_barrier
    s_waitcnt lgkmcnt(7)
    v_mfma_f32_32x32x16_bf16 v[20:35], v[148:151], a[0:3], 0
    ds_read_b64_tr_b16 v[164:165], v12 offset:2048
    ds_read_b64_tr_b16 v[166:167], v12 offset:3072
    s_waitcnt lgkmcnt(5)
    v_mfma_f32_32x32x16_bf16 v[84:99], v[148:151], a[128:131], 0
    ds_read_b64_tr_b16 v[168:169], v13 offset:2048
    ds_read_b64_tr_b16 v[170:171], v13 offset:3072
    v_mfma_f32_32x32x16_bf16 v[36:51], v[152:155], a[0:3], 0
    ds_read_b64_tr_b16 v[172:173], v14 offset:2048
    ds_read_b64_tr_b16 v[174:175], v14 offset:3072
    v_mfma_f32_32x32x16_bf16 v[100:115], v[152:155], a[128:131], 0
    ds_read_b64_tr_b16 v[176:177], v15 offset:2048
    ds_read_b64_tr_b16 v[178:179], v15 offset:3072
    v_mfma_f32_32x32x16_bf16 v[52:67], v[156:159], a[0:3], 0
    ds_read_b128 a[16:19], v4 offset:32768
    v_mfma_f32_32x32x16_bf16 v[116:131], v[156:159], a[128:131], 0
    ds_read_b128 a[20:23], v5 offset:32768
    v_mfma_f32_32x32x16_bf16 v[68:83], v[160:163], a[0:3], 0
    ds_read_b128 a[24:27], v6 offset:32768
    v_mfma_f32_32x32x16_bf16 v[132:147], v[160:163], a[128:131], 0
    ds_read_b128 a[28:31], v7 offset:32768
    s_waitcnt lgkmcnt(10)
    v_mfma_f32_32x32x16_bf16 v[20:35], v[164:167], a[4:7], v[20:35]
    ds_read_b64_tr_b16 v[148:149], v12 offset:4096
    ds_read_b64_tr_b16 v[150:151], v12 offset:5120
    v_mfma_f32_32x32x16_bf16 v[84:99], v[164:167], a[132:135], v[84:99]
    ds_read_b64_tr_b16 v[152:153], v13 offset:4096
    ds_read_b64_tr_b16 v[154:155], v13 offset:5120
    s_waitcnt lgkmcnt(12)
    v_mfma_f32_32x32x16_bf16 v[36:51], v[168:171], a[4:7], v[36:51]
    ds_read_b64_tr_b16 v[156:157], v14 offset:4096
    ds_read_b64_tr_b16 v[158:159], v14 offset:5120
    v_mfma_f32_32x32x16_bf16 v[100:115], v[168:171], a[132:135], v[100:115]
    ds_read_b64_tr_b16 v[160:161], v15 offset:4096
    ds_read_b64_tr_b16 v[162:163], v15 offset:5120
    s_waitcnt lgkmcnt(11)
    v_mfma_f32_32x32x16_bf16 v[52:67], v[172:175], a[4:7], v[52:67]
    ds_read_b128 a[144:147], v4 offset:36864
    v_mfma_f32_32x32x16_bf16 v[116:131], v[172:175], a[132:135], v[116:131]
    ds_read_b128 a[148:151], v5 offset:36864
    v_mfma_f32_32x32x16_bf16 v[68:83], v[176:179], a[4:7], v[68:83]
    ds_read_b128 a[152:155], v6 offset:36864
    v_mfma_f32_32x32x16_bf16 v[132:147], v[176:179], a[132:135], v[132:147]
    ds_read_b128 a[156:159], v7 offset:36864
    s_waitcnt lgkmcnt(11)
    s_waitcnt lgkmcnt(10)
    v_mfma_f32_32x32x16_bf16 v[20:35], v[148:151], a[8:11], v[20:35]
    ds_read_b64_tr_b16 v[164:165], v12 offset:6144
    ds_read_b64_tr_b16 v[166:167], v12 offset:7168
    ds_read_b64_tr_b16 v[168:169], v13 offset:6144
    ds_read_b64_tr_b16 v[170:171], v13 offset:7168
    v_mfma_f32_32x32x16_bf16 v[84:99], v[148:151], a[136:139], v[84:99]
    ds_read_b64_tr_b16 v[172:173], v14 offset:6144
    ds_read_b64_tr_b16 v[174:175], v14 offset:7168
    s_waitcnt lgkmcnt(11)
    v_mfma_f32_32x32x16_bf16 v[36:51], v[152:155], a[8:11], v[36:51]
    ds_read_b64_tr_b16 v[176:177], v15 offset:6144
    ds_read_b64_tr_b16 v[178:179], v15 offset:7168
    v_mfma_f32_32x32x16_bf16 v[100:115], v[152:155], a[136:139], v[100:115]
    s_add_u32 s53, s55, 0x180
    s_add_u32 m0, s56, 0x10000
    buffer_load_dwordx4 v2, s[20:23], s53 offen lds
    v_mfma_f32_32x32x16_bf16 v[52:67], v[156:159], a[8:11], v[52:67]
    s_add_u32 s53, s55, 0x2180
    s_add_u32 m0, s56, 0x10400
    buffer_load_dwordx4 v3, s[20:23], s53 offen lds
    v_mfma_f32_32x32x16_bf16 v[116:131], v[156:159], a[136:139], v[116:131]
    s_add_u32 s53, s55, 0x4180
    s_add_u32 m0, s56, 0x10800
    buffer_load_dwordx4 v2, s[20:23], s53 offen lds
    s_waitcnt lgkmcnt(12)
    v_mfma_f32_32x32x16_bf16 v[68:83], v[160:163], a[8:11], v[68:83]
    s_add_u32 s53, s55, 0x6180
    s_add_u32 m0, s56, 0x10c00
    buffer_load_dwordx4 v3, s[20:23], s53 offen lds
    v_mfma_f32_32x32x16_bf16 v[132:147], v[160:163], a[136:139], v[132:147]
    s_add_u32 s53, s55, 0x8180
    s_add_u32 m0, s56, 0x11000
    buffer_load_dwordx4 v2, s[20:23], s53 offen lds
    s_waitcnt lgkmcnt(6)
    v_mfma_f32_32x32x16_bf16 v[20:35], v[164:167], a[12:15], v[20:35]
    ds_read_b64_tr_b16 v[148:149], v12 offset:16384
    ds_read_b64_tr_b16 v[150:151], v12 offset:17408
    ds_read_b64_tr_b16 v[152:153], v13 offset:16384
    ds_read_b64_tr_b16 v[154:155], v13 offset:17408
    v_mfma_f32_32x32x16_bf16 v[84:99], v[164:167], a[140:143], v[84:99]
    ds_read_b64_tr_b16 v[156:157], v14 offset:16384
    ds_read_b64_tr_b16 v[158:159], v14 offset:17408
    ds_read_b64_tr_b16 v[160:161], v15 offset:16384
    ds_read_b64_tr_b16 v[162:163], v15 offset:17408
    s_waitcnt lgkmcnt(12)
    v_mfma_f32_32x32x16_bf16 v[36:51], v[168:171], a[12:15], v[36:51]
    s_add_u32 s53, s55, 0xa180
    s_add_u32 m0, s56, 0x11400
    buffer_load_dwordx4 v3, s[20:23], s53 offen lds
    s_add_u32 s53, s55, 0xc180
    s_add_u32 m0, s56, 0x11800
    buffer_load_dwordx4 v2, s[20:23], s53 offen lds
    v_mfma_f32_32x32x16_bf16 v[100:115], v[168:171], a[140:143], v[100:115]
    s_add_u32 s53, s55, 0xe180
    s_add_u32 m0, s56, 0x11c00
    buffer_load_dwordx4 v3, s[20:23], s53 offen lds
    s_add_u32 s53, s52, 0x180000
    s_add_u32 m0, s54, 0xc000
    buffer_load_dwordx4 v1, s[28:31], s53 offen lds
    s_waitcnt lgkmcnt(10)
    v_mfma_f32_32x32x16_bf16 v[52:67], v[172:175], a[12:15], v[52:67]
    s_add_u32 s53, s52, 0x188000
    s_add_u32 m0, s54, 0xc400
    buffer_load_dwordx4 v1, s[28:31], s53 offen lds
    v_mfma_f32_32x32x16_bf16 v[116:131], v[172:175], a[140:143], v[116:131]
    s_add_u32 s53, s52, 0x190000
    s_add_u32 m0, s54, 0xc800
    buffer_load_dwordx4 v1, s[28:31], s53 offen lds
    s_waitcnt lgkmcnt(8)
    v_mfma_f32_32x32x16_bf16 v[68:83], v[176:179], a[12:15], v[68:83]
    s_add_u32 s53, s52, 0x198000
    s_add_u32 m0, s54, 0xcc00
    buffer_load_dwordx4 v1, s[28:31], s53 offen lds
    v_mfma_f32_32x32x16_bf16 v[132:147], v[176:179], a[140:143], v[132:147]
    s_waitcnt vmcnt(12)
    s_barrier
    s_waitcnt lgkmcnt(6)
    v_mfma_f32_32x32x16_bf16 v[20:35], v[148:151], a[16:19], v[20:35]
    ds_read_b64_tr_b16 v[164:165], v12 offset:18432
    ds_read_b64_tr_b16 v[166:167], v12 offset:19456
    v_mfma_f32_32x32x16_bf16 v[84:99], v[148:151], a[144:147], v[84:99]
    ds_read_b64_tr_b16 v[168:169], v13 offset:18432
    ds_read_b64_tr_b16 v[170:171], v13 offset:19456
    s_waitcnt lgkmcnt(8)
    v_mfma_f32_32x32x16_bf16 v[36:51], v[152:155], a[16:19], v[36:51]
    ds_read_b64_tr_b16 v[172:173], v14 offset:18432
    ds_read_b64_tr_b16 v[174:175], v14 offset:19456
    v_mfma_f32_32x32x16_bf16 v[100:115], v[152:155], a[144:147], v[100:115]
    ds_read_b64_tr_b16 v[176:177], v15 offset:18432
    ds_read_b64_tr_b16 v[178:179], v15 offset:19456
    s_waitcnt lgkmcnt(10)
    v_mfma_f32_32x32x16_bf16 v[52:67], v[156:159], a[16:19], v[52:67]
    ds_read_b128 a[32:35], v8 offset:0
    v_mfma_f32_32x32x16_bf16 v[116:131], v[156:159], a[144:147], v[116:131]
    ds_read_b128 a[36:39], v9 offset:0
    s_waitcnt lgkmcnt(10)
    v_mfma_f32_32x32x16_bf16 v[68:83], v[160:163], a[16:19], v[68:83]
    ds_read_b128 a[40:43], v10 offset:0
    v_mfma_f32_32x32x16_bf16 v[132:147], v[160:163], a[144:147], v[132:147]
    ds_read_b128 a[44:47], v11 offset:0
    s_waitcnt lgkmcnt(10)
    v_mfma_f32_32x32x16_bf16 v[20:35], v[164:167], a[20:23], v[20:35]
    ds_read_b64_tr_b16 v[148:149], v12 offset:20480
    ds_read_b64_tr_b16 v[150:151], v12 offset:21504
    v_mfma_f32_32x32x16_bf16 v[84:99], v[164:167], a[148:151], v[84:99]
    ds_read_b64_tr_b16 v[152:153], v13 offset:20480
    ds_read_b64_tr_b16 v[154:155], v13 offset:21504
    s_waitcnt lgkmcnt(12)
    v_mfma_f32_32x32x16_bf16 v[36:51], v[168:171], a[20:23], v[36:51]
    ds_read_b64_tr_b16 v[156:157], v14 offset:20480
    ds_read_b64_tr_b16 v[158:159], v14 offset:21504
    v_mfma_f32_32x32x16_bf16 v[100:115], v[168:171], a[148:151], v[100:115]
    ds_read_b64_tr_b16 v[160:161], v15 offset:20480
    ds_read_b64_tr_b16 v[162:163], v15 offset:21504
    s_waitcnt lgkmcnt(11)
    v_mfma_f32_32x32x16_bf16 v[52:67], v[172:175], a[20:23], v[52:67]
    ds_read_b128 a[160:163], v8 offset:4096
    v_mfma_f32_32x32x16_bf16 v[116:131], v[172:175], a[148:151], v[116:131]
    ds_read_b128 a[164:167], v9 offset:4096
    v_mfma_f32_32x32x16_bf16 v[68:83], v[176:179], a[20:23], v[68:83]
    ds_read_b128 a[168:171], v10 offset:4096
    v_mfma_f32_32x32x16_bf16 v[132:147], v[176:179], a[148:151], v[132:147]
    ds_read_b128 a[172:175], v11 offset:4096
    s_waitcnt lgkmcnt(11)
    s_waitcnt lgkmcnt(10)
    v_mfma_f32_32x32x16_bf16 v[20:35], v[148:151], a[24:27], v[20:35]
    ds_read_b64_tr_b16 v[164:165], v12 offset:22528
    ds_read_b64_tr_b16 v[166:167], v12 offset:23552
    ds_read_b64_tr_b16 v[168:169], v13 offset:22528
    ds_read_b64_tr_b16 v[170:171], v13 offset:23552
    v_mfma_f32_32x32x16_bf16 v[84:99], v[148:151], a[152:155], v[84:99]
    ds_read_b64_tr_b16 v[172:173], v14 offset:22528
    ds_read_b64_tr_b16 v[174:175], v14 offset:23552
    s_waitcnt lgkmcnt(11)
    v_mfma_f32_32x32x16_bf16 v[36:51], v[152:155], a[24:27], v[36:51]
    ds_read_b64_tr_b16 v[176:177], v15 offset:22528
    ds_read_b64_tr_b16 v[178:179], v15 offset:23552
    v_mfma_f32_32x32x16_bf16 v[100:115], v[152:155], a[152:155], v[100:115]
    s_add_u32 s53, s55, 0x200
    s_add_u32 m0, s56, 0x18000
    buffer_load_dwordx4 v2, s[20:23], s53 offen lds
    v_mfma_f32_32x32x16_bf16 v[52:67], v[156:159], a[24:27], v[52:67]
    s_add_u32 s53, s55, 0x2200
    s_add_u32 m0, s56, 0x18400
    buffer_load_dwordx4 v3, s[20:23], s53 offen lds
    v_mfma_f32_32x32x16_bf16 v[116:131], v[156:159], a[152:155], v[116:131]
    s_add_u32 s53, s55, 0x4200
    s_add_u32 m0, s56, 0x18800
    buffer_load_dwordx4 v2, s[20:23], s53 offen lds
    s_waitcnt lgkmcnt(12)
    v_mfma_f32_32x32x16_bf16 v[68:83], v[160:163], a[24:27], v[68:83]
    s_add_u32 s53, s55, 0x6200
    s_add_u32 m0, s56, 0x18c00
    buffer_load_dwordx4 v3, s[20:23], s53 offen lds
    v_mfma_f32_32x32x16_bf16 v[132:147], v[160:163], a[152:155], v[132:147]
    s_add_u32 s53, s55, 0x8200
    s_add_u32 m0, s56, 0x19000
    buffer_load_dwordx4 v2, s[20:23], s53 offen lds
    s_waitcnt lgkmcnt(6)
    v_mfma_f32_32x32x16_bf16 v[20:35], v[164:167], a[28:31], v[20:35]
    ds_read_b64_tr_b16 v[148:149], v12 offset:32768
    ds_read_b64_tr_b16 v[150:151], v12 offset:33792
    ds_read_b64_tr_b16 v[152:153], v13 offset:32768
    ds_read_b64_tr_b16 v[154:155], v13 offset:33792
    v_mfma_f32_32x32x16_bf16 v[84:99], v[164:167], a[156:159], v[84:99]
    ds_read_b64_tr_b16 v[156:157], v14 offset:32768
    ds_read_b64_tr_b16 v[158:159], v14 offset:33792
    ds_read_b64_tr_b16 v[160:161], v15 offset:32768
    ds_read_b64_tr_b16 v[162:163], v15 offset:33792
    s_waitcnt lgkmcnt(12)
    v_mfma_f32_32x32x16_bf16 v[36:51], v[168:171], a[28:31], v[36:51]
    s_add_u32 s53, s55, 0xa200
    s_add_u32 m0, s56, 0x19400
    buffer_load_dwordx4 v3, s[20:23], s53 offen lds
    s_add_u32 s53, s55, 0xc200
    s_add_u32 m0, s56, 0x19800
    buffer_load_dwordx4 v2, s[20:23], s53 offen lds
    v_mfma_f32_32x32x16_bf16 v[100:115], v[168:171], a[156:159], v[100:115]
    s_add_u32 s53, s55, 0xe200
    s_add_u32 m0, s56, 0x19c00
    buffer_load_dwordx4 v3, s[20:23], s53 offen lds
    s_add_u32 s53, s52, 0x200000
    s_add_u32 m0, s54, 0x0
    buffer_load_dwordx4 v1, s[28:31], s53 offen lds
    s_waitcnt lgkmcnt(10)
    v_mfma_f32_32x32x16_bf16 v[52:67], v[172:175], a[28:31], v[52:67]
    s_add_u32 s53, s52, 0x208000
    s_add_u32 m0, s54, 0x400
    buffer_load_dwordx4 v1, s[28:31], s53 offen lds
    v_mfma_f32_32x32x16_bf16 v[116:131], v[172:175], a[156:159], v[116:131]
    s_add_u32 s53, s52, 0x210000
    s_add_u32 m0, s54, 0x800
    buffer_load_dwordx4 v1, s[28:31], s53 offen lds
    s_waitcnt lgkmcnt(8)
    v_mfma_f32_32x32x16_bf16 v[68:83], v[176:179], a[28:31], v[68:83]
    s_add_u32 s53, s52, 0x218000
    s_add_u32 m0, s54, 0xc00
    buffer_load_dwordx4 v1, s[28:31], s53 offen lds
    v_mfma_f32_32x32x16_bf16 v[132:147], v[176:179], a[156:159], v[132:147]
    s_waitcnt vmcnt(12)
    s_barrier
    s_waitcnt lgkmcnt(6)
    v_mfma_f32_32x32x16_bf16 v[20:35], v[148:151], a[32:35], v[20:35]
    ds_read_b64_tr_b16 v[164:165], v12 offset:34816
    ds_read_b64_tr_b16 v[166:167], v12 offset:35840
    v_mfma_f32_32x32x16_bf16 v[84:99], v[148:151], a[160:163], v[84:99]
    ds_read_b64_tr_b16 v[168:169], v13 offset:34816
    ds_read_b64_tr_b16 v[170:171], v13 offset:35840
    s_waitcnt lgkmcnt(8)
    v_mfma_f32_32x32x16_bf16 v[36:51], v[152:155], a[32:35], v[36:51]
    ds_read_b64_tr_b16 v[172:173], v14 offset:34816
    ds_read_b64_tr_b16 v[174:175], v14 offset:35840
    v_mfma_f32_32x32x16_bf16 v[100:115], v[152:155], a[160:163], v[100:115]
    ds_read_b64_tr_b16 v[176:177], v15 offset:34816
    ds_read_b64_tr_b16 v[178:179], v15 offset:35840
    s_waitcnt lgkmcnt(10)
    v_mfma_f32_32x32x16_bf16 v[52:67], v[156:159], a[32:35], v[52:67]
    ds_read_b128 a[48:51], v4 offset:0
    v_mfma_f32_32x32x16_bf16 v[116:131], v[156:159], a[160:163], v[116:131]
    ds_read_b128 a[52:55], v5 offset:0
    s_waitcnt lgkmcnt(10)
    v_mfma_f32_32x32x16_bf16 v[68:83], v[160:163], a[32:35], v[68:83]
    ds_read_b128 a[56:59], v6 offset:0
    v_mfma_f32_32x32x16_bf16 v[132:147], v[160:163], a[160:163], v[132:147]
    ds_read_b128 a[60:63], v7 offset:0
    s_waitcnt lgkmcnt(10)
    v_mfma_f32_32x32x16_bf16 v[20:35], v[164:167], a[36:39], v[20:35]
    ds_read_b64_tr_b16 v[148:149], v12 offset:36864
    ds_read_b64_tr_b16 v[150:151], v12 offset:37888
    v_mfma_f32_32x32x16_bf16 v[84:99], v[164:167], a[164:167], v[84:99]
    ds_read_b64_tr_b16 v[152:153], v13 offset:36864
    ds_read_b64_tr_b16 v[154:155], v13 offset:37888
    s_waitcnt lgkmcnt(12)
    v_mfma_f32_32x32x16_bf16 v[36:51], v[168:171], a[36:39], v[36:51]
    ds_read_b64_tr_b16 v[156:157], v14 offset:36864
    ds_read_b64_tr_b16 v[158:159], v14 offset:37888
    v_mfma_f32_32x32x16_bf16 v[100:115], v[168:171], a[164:167], v[100:115]
    ds_read_b64_tr_b16 v[160:161], v15 offset:36864
    ds_read_b64_tr_b16 v[162:163], v15 offset:37888
    s_waitcnt lgkmcnt(11)
    v_mfma_f32_32x32x16_bf16 v[52:67], v[172:175], a[36:39], v[52:67]
    ds_read_b128 a[176:179], v4 offset:4096
    v_mfma_f32_32x32x16_bf16 v[116:131], v[172:175], a[164:167], v[116:131]
    ds_read_b128 a[180:183], v5 offset:4096
    v_mfma_f32_32x32x16_bf16 v[68:83], v[176:179], a[36:39], v[68:83]
    ds_read_b128 a[184:187], v6 offset:4096
    v_mfma_f32_32x32x16_bf16 v[132:147], v[176:179], a[164:167], v[132:147]
    ds_read_b128 a[188:191], v7 offset:4096
    s_waitcnt lgkmcnt(11)
    s_waitcnt lgkmcnt(10)
    v_mfma_f32_32x32x16_bf16 v[20:35], v[148:151], a[40:43], v[20:35]
    ds_read_b64_tr_b16 v[164:165], v12 offset:38912
    ds_read_b64_tr_b16 v[166:167], v12 offset:39936
    ds_read_b64_tr_b16 v[168:169], v13 offset:38912
    ds_read_b64_tr_b16 v[170:171], v13 offset:39936
    v_mfma_f32_32x32x16_bf16 v[84:99], v[148:151], a[168:171], v[84:99]
    ds_read_b64_tr_b16 v[172:173], v14 offset:38912
    ds_read_b64_tr_b16 v[174:175], v14 offset:39936
    s_waitcnt lgkmcnt(11)
    v_mfma_f32_32x32x16_bf16 v[36:51], v[152:155], a[40:43], v[36:51]
    ds_read_b64_tr_b16 v[176:177], v15 offset:38912
    ds_read_b64_tr_b16 v[178:179], v15 offset:39936
    v_mfma_f32_32x32x16_bf16 v[100:115], v[152:155], a[168:171], v[100:115]
    s_add_u32 s53, s55, 0x280
    s_add_u32 m0, s56, 0x20000
    buffer_load_dwordx4 v2, s[20:23], s53 offen lds
    v_mfma_f32_32x32x16_bf16 v[52:67], v[156:159], a[40:43], v[52:67]
    s_add_u32 s53, s55, 0x2280
    s_add_u32 m0, s56, 0x20400
    buffer_load_dwordx4 v3, s[20:23], s53 offen lds
    v_mfma_f32_32x32x16_bf16 v[116:131], v[156:159], a[168:171], v[116:131]
    s_add_u32 s53, s55, 0x4280
    s_add_u32 m0, s56, 0x20800
    buffer_load_dwordx4 v2, s[20:23], s53 offen lds
    s_waitcnt lgkmcnt(12)
    v_mfma_f32_32x32x16_bf16 v[68:83], v[160:163], a[40:43], v[68:83]
    s_add_u32 s53, s55, 0x6280
    s_add_u32 m0, s56, 0x20c00
    buffer_load_dwordx4 v3, s[20:23], s53 offen lds
    v_mfma_f32_32x32x16_bf16 v[132:147], v[160:163], a[168:171], v[132:147]
    s_add_u32 s53, s55, 0x8280
    s_add_u32 m0, s56, 0x21000
    buffer_load_dwordx4 v2, s[20:23], s53 offen lds
    s_waitcnt lgkmcnt(6)
    v_mfma_f32_32x32x16_bf16 v[20:35], v[164:167], a[44:47], v[20:35]
    ds_read_b64_tr_b16 v[148:149], v12 offset:49152
    ds_read_b64_tr_b16 v[150:151], v12 offset:50176
    ds_read_b64_tr_b16 v[152:153], v13 offset:49152
    ds_read_b64_tr_b16 v[154:155], v13 offset:50176
    v_mfma_f32_32x32x16_bf16 v[84:99], v[164:167], a[172:175], v[84:99]
    ds_read_b64_tr_b16 v[156:157], v14 offset:49152
    ds_read_b64_tr_b16 v[158:159], v14 offset:50176
    ds_read_b64_tr_b16 v[160:161], v15 offset:49152
    ds_read_b64_tr_b16 v[162:163], v15 offset:50176
    s_waitcnt lgkmcnt(12)
    v_mfma_f32_32x32x16_bf16 v[36:51], v[168:171], a[44:47], v[36:51]
    s_add_u32 s53, s55, 0xa280
    s_add_u32 m0, s56, 0x21400
    buffer_load_dwordx4 v3, s[20:23], s53 offen lds
    s_add_u32 s53, s55, 0xc280
    s_add_u32 m0, s56, 0x21800
    buffer_load_dwordx4 v2, s[20:23], s53 offen lds
    v_mfma_f32_32x32x16_bf16 v[100:115], v[168:171], a[172:175], v[100:115]
    s_add_u32 s53, s55, 0xe280
    s_add_u32 m0, s56, 0x21c00
    buffer_load_dwordx4 v3, s[20:23], s53 offen lds
    s_add_u32 s53, s52, 0x280000
    s_add_u32 m0, s54, 0x4000
    buffer_load_dwordx4 v1, s[28:31], s53 offen lds
    s_waitcnt lgkmcnt(10)
    v_mfma_f32_32x32x16_bf16 v[52:67], v[172:175], a[44:47], v[52:67]
    s_add_u32 s53, s52, 0x288000
    s_add_u32 m0, s54, 0x4400
    buffer_load_dwordx4 v1, s[28:31], s53 offen lds
    v_mfma_f32_32x32x16_bf16 v[116:131], v[172:175], a[172:175], v[116:131]
    s_add_u32 s53, s52, 0x290000
    s_add_u32 m0, s54, 0x4800
    buffer_load_dwordx4 v1, s[28:31], s53 offen lds
    s_waitcnt lgkmcnt(8)
    v_mfma_f32_32x32x16_bf16 v[68:83], v[176:179], a[44:47], v[68:83]
    s_add_u32 s53, s52, 0x298000
    s_add_u32 m0, s54, 0x4c00
    buffer_load_dwordx4 v1, s[28:31], s53 offen lds
    v_mfma_f32_32x32x16_bf16 v[132:147], v[176:179], a[172:175], v[132:147]
    s_waitcnt vmcnt(12)
    s_barrier
    s_waitcnt lgkmcnt(6)
    v_mfma_f32_32x32x16_bf16 v[20:35], v[148:151], a[48:51], v[20:35]
    ds_read_b64_tr_b16 v[164:165], v12 offset:51200
    ds_read_b64_tr_b16 v[166:167], v12 offset:52224
    v_mfma_f32_32x32x16_bf16 v[84:99], v[148:151], a[176:179], v[84:99]
    ds_read_b64_tr_b16 v[168:169], v13 offset:51200
    ds_read_b64_tr_b16 v[170:171], v13 offset:52224
    s_waitcnt lgkmcnt(8)
    v_mfma_f32_32x32x16_bf16 v[36:51], v[152:155], a[48:51], v[36:51]
    ds_read_b64_tr_b16 v[172:173], v14 offset:51200
    ds_read_b64_tr_b16 v[174:175], v14 offset:52224
    v_mfma_f32_32x32x16_bf16 v[100:115], v[152:155], a[176:179], v[100:115]
    ds_read_b64_tr_b16 v[176:177], v15 offset:51200
    ds_read_b64_tr_b16 v[178:179], v15 offset:52224
    s_waitcnt lgkmcnt(10)
    v_mfma_f32_32x32x16_bf16 v[52:67], v[156:159], a[48:51], v[52:67]
    ds_read_b128 a[64:67], v4 offset:32768
    v_mfma_f32_32x32x16_bf16 v[116:131], v[156:159], a[176:179], v[116:131]
    ds_read_b128 a[68:71], v5 offset:32768
    s_waitcnt lgkmcnt(10)
    v_mfma_f32_32x32x16_bf16 v[68:83], v[160:163], a[48:51], v[68:83]
    ds_read_b128 a[72:75], v6 offset:32768
    v_mfma_f32_32x32x16_bf16 v[132:147], v[160:163], a[176:179], v[132:147]
    ds_read_b128 a[76:79], v7 offset:32768
    s_waitcnt lgkmcnt(10)
    v_mfma_f32_32x32x16_bf16 v[20:35], v[164:167], a[52:55], v[20:35]
    ds_read_b64_tr_b16 v[148:149], v12 offset:53248
    ds_read_b64_tr_b16 v[150:151], v12 offset:54272
    v_mfma_f32_32x32x16_bf16 v[84:99], v[164:167], a[180:183], v[84:99]
    ds_read_b64_tr_b16 v[152:153], v13 offset:53248
    ds_read_b64_tr_b16 v[154:155], v13 offset:54272
    s_waitcnt lgkmcnt(12)
    v_mfma_f32_32x32x16_bf16 v[36:51], v[168:171], a[52:55], v[36:51]
    ds_read_b64_tr_b16 v[156:157], v14 offset:53248
    ds_read_b64_tr_b16 v[158:159], v14 offset:54272
    v_mfma_f32_32x32x16_bf16 v[100:115], v[168:171], a[180:183], v[100:115]
    ds_read_b64_tr_b16 v[160:161], v15 offset:53248
    ds_read_b64_tr_b16 v[162:163], v15 offset:54272
    s_waitcnt lgkmcnt(11)
    v_mfma_f32_32x32x16_bf16 v[52:67], v[172:175], a[52:55], v[52:67]
    ds_read_b128 a[192:195], v4 offset:36864
    v_mfma_f32_32x32x16_bf16 v[116:131], v[172:175], a[180:183], v[116:131]
    ds_read_b128 a[196:199], v5 offset:36864
    v_mfma_f32_32x32x16_bf16 v[68:83], v[176:179], a[52:55], v[68:83]
    ds_read_b128 a[200:203], v6 offset:36864
    v_mfma_f32_32x32x16_bf16 v[132:147], v[176:179], a[180:183], v[132:147]
    ds_read_b128 a[204:207], v7 offset:36864
    s_waitcnt lgkmcnt(11)
    s_waitcnt lgkmcnt(10)
    v_mfma_f32_32x32x16_bf16 v[20:35], v[148:151], a[56:59], v[20:35]
    ds_read_b64_tr_b16 v[164:165], v12 offset:55296
    ds_read_b64_tr_b16 v[166:167], v12 offset:56320
    ds_read_b64_tr_b16 v[168:169], v13 offset:55296
    ds_read_b64_tr_b16 v[170:171], v13 offset:56320
    v_mfma_f32_32x32x16_bf16 v[84:99], v[148:151], a[184:187], v[84:99]
    ds_read_b64_tr_b16 v[172:173], v14 offset:55296
    ds_read_b64_tr_b16 v[174:175], v14 offset:56320
    s_waitcnt lgkmcnt(11)
    v_mfma_f32_32x32x16_bf16 v[36:51], v[152:155], a[56:59], v[36:51]
    ds_read_b64_tr_b16 v[176:177], v15 offset:55296
    ds_read_b64_tr_b16 v[178:179], v15 offset:56320
    v_mfma_f32_32x32x16_bf16 v[100:115], v[152:155], a[184:187], v[100:115]
    s_add_u32 s53, s55, 0x300
    s_add_u32 m0, s56, 0x10000
    buffer_load_dwordx4 v2, s[20:23], s53 offen lds
    v_mfma_f32_32x32x16_bf16 v[52:67], v[156:159], a[56:59], v[52:67]
    s_add_u32 s53, s55, 0x2300
    s_add_u32 m0, s56, 0x10400
    buffer_load_dwordx4 v3, s[20:23], s53 offen lds
    v_mfma_f32_32x32x16_bf16 v[116:131], v[156:159], a[184:187], v[116:131]
    s_add_u32 s53, s55, 0x4300
    s_add_u32 m0, s56, 0x10800
    buffer_load_dwordx4 v2, s[20:23], s53 offen lds
    s_waitcnt lgkmcnt(12)
    v_mfma_f32_32x32x16_bf16 v[68:83], v[160:163], a[56:59], v[68:83]
    s_add_u32 s53, s55, 0x6300
    s_add_u32 m0, s56, 0x10c00
    buffer_load_dwordx4 v3, s[20:23], s53 offen lds
    v_mfma_f32_32x32x16_bf16 v[132:147], v[160:163], a[184:187], v[132:147]
    s_add_u32 s53, s55, 0x8300
    s_add_u32 m0, s56, 0x11000
    buffer_load_dwordx4 v2, s[20:23], s53 offen lds
    s_waitcnt lgkmcnt(6)
    v_mfma_f32_32x32x16_bf16 v[20:35], v[164:167], a[60:63], v[20:35]
    ds_read_b64_tr_b16 v[148:149], v12 offset:0
    ds_read_b64_tr_b16 v[150:151], v12 offset:1024
    ds_read_b64_tr_b16 v[152:153], v13 offset:0
    ds_read_b64_tr_b16 v[154:155], v13 offset:1024
    v_mfma_f32_32x32x16_bf16 v[84:99], v[164:167], a[188:191], v[84:99]
    ds_read_b64_tr_b16 v[156:157], v14 offset:0
    ds_read_b64_tr_b16 v[158:159], v14 offset:1024
    ds_read_b64_tr_b16 v[160:161], v15 offset:0
    ds_read_b64_tr_b16 v[162:163], v15 offset:1024
    s_waitcnt lgkmcnt(12)
    v_mfma_f32_32x32x16_bf16 v[36:51], v[168:171], a[60:63], v[36:51]
    s_add_u32 s53, s55, 0xa300
    s_add_u32 m0, s56, 0x11400
    buffer_load_dwordx4 v3, s[20:23], s53 offen lds
    s_add_u32 s53, s55, 0xc300
    s_add_u32 m0, s56, 0x11800
    buffer_load_dwordx4 v2, s[20:23], s53 offen lds
    v_mfma_f32_32x32x16_bf16 v[100:115], v[168:171], a[188:191], v[100:115]
    s_add_u32 s53, s55, 0xe300
    s_add_u32 m0, s56, 0x11c00
    buffer_load_dwordx4 v3, s[20:23], s53 offen lds
    s_add_u32 s53, s52, 0x300000
    s_add_u32 m0, s54, 0x8000
    buffer_load_dwordx4 v1, s[28:31], s53 offen lds
    s_waitcnt lgkmcnt(10)
    v_mfma_f32_32x32x16_bf16 v[52:67], v[172:175], a[60:63], v[52:67]
    s_add_u32 s53, s52, 0x308000
    s_add_u32 m0, s54, 0x8400
    buffer_load_dwordx4 v1, s[28:31], s53 offen lds
    v_mfma_f32_32x32x16_bf16 v[116:131], v[172:175], a[188:191], v[116:131]
    s_add_u32 s53, s52, 0x310000
    s_add_u32 m0, s54, 0x8800
    buffer_load_dwordx4 v1, s[28:31], s53 offen lds
    s_waitcnt lgkmcnt(8)
    v_mfma_f32_32x32x16_bf16 v[68:83], v[176:179], a[60:63], v[68:83]
    s_add_u32 s53, s52, 0x318000
    s_add_u32 m0, s54, 0x8c00
    buffer_load_dwordx4 v1, s[28:31], s53 offen lds
    v_mfma_f32_32x32x16_bf16 v[132:147], v[176:179], a[188:191], v[132:147]
    s_waitcnt vmcnt(12)
    s_barrier
    s_waitcnt lgkmcnt(6)
    v_mfma_f32_32x32x16_bf16 v[20:35], v[148:151], a[64:67], v[20:35]
    ds_read_b64_tr_b16 v[164:165], v12 offset:2048
    ds_read_b64_tr_b16 v[166:167], v12 offset:3072
    v_mfma_f32_32x32x16_bf16 v[84:99], v[148:151], a[192:195], v[84:99]
    ds_read_b64_tr_b16 v[168:169], v13 offset:2048
    ds_read_b64_tr_b16 v[170:171], v13 offset:3072
    s_waitcnt lgkmcnt(8)
    v_mfma_f32_32x32x16_bf16 v[36:51], v[152:155], a[64:67], v[36:51]
    ds_read_b64_tr_b16 v[172:173], v14 offset:2048
    ds_read_b64_tr_b16 v[174:175], v14 offset:3072
    v_mfma_f32_32x32x16_bf16 v[100:115], v[152:155], a[192:195], v[100:115]
    ds_read_b64_tr_b16 v[176:177], v15 offset:2048
    ds_read_b64_tr_b16 v[178:179], v15 offset:3072
    s_waitcnt lgkmcnt(10)
    v_mfma_f32_32x32x16_bf16 v[52:67], v[156:159], a[64:67], v[52:67]
    ds_read_b128 a[80:83], v8 offset:0
    v_mfma_f32_32x32x16_bf16 v[116:131], v[156:159], a[192:195], v[116:131]
    ds_read_b128 a[84:87], v9 offset:0
    s_waitcnt lgkmcnt(10)
    v_mfma_f32_32x32x16_bf16 v[68:83], v[160:163], a[64:67], v[68:83]
    ds_read_b128 a[88:91], v10 offset:0
    v_mfma_f32_32x32x16_bf16 v[132:147], v[160:163], a[192:195], v[132:147]
    ds_read_b128 a[92:95], v11 offset:0
    s_waitcnt lgkmcnt(10)
    v_mfma_f32_32x32x16_bf16 v[20:35], v[164:167], a[68:71], v[20:35]
    ds_read_b64_tr_b16 v[148:149], v12 offset:4096
    ds_read_b64_tr_b16 v[150:151], v12 offset:5120
    v_mfma_f32_32x32x16_bf16 v[84:99], v[164:167], a[196:199], v[84:99]
    ds_read_b64_tr_b16 v[152:153], v13 offset:4096
    ds_read_b64_tr_b16 v[154:155], v13 offset:5120
    s_waitcnt lgkmcnt(12)
    v_mfma_f32_32x32x16_bf16 v[36:51], v[168:171], a[68:71], v[36:51]
    ds_read_b64_tr_b16 v[156:157], v14 offset:4096
    ds_read_b64_tr_b16 v[158:159], v14 offset:5120
    v_mfma_f32_32x32x16_bf16 v[100:115], v[168:171], a[196:199], v[100:115]
    ds_read_b64_tr_b16 v[160:161], v15 offset:4096
    ds_read_b64_tr_b16 v[162:163], v15 offset:5120
    s_waitcnt lgkmcnt(11)
    v_mfma_f32_32x32x16_bf16 v[52:67], v[172:175], a[68:71], v[52:67]
    ds_read_b128 a[208:211], v8 offset:4096
    v_mfma_f32_32x32x16_bf16 v[116:131], v[172:175], a[196:199], v[116:131]
    ds_read_b128 a[212:215], v9 offset:4096
    v_mfma_f32_32x32x16_bf16 v[68:83], v[176:179], a[68:71], v[68:83]
    ds_read_b128 a[216:219], v10 offset:4096
    v_mfma_f32_32x32x16_bf16 v[132:147], v[176:179], a[196:199], v[132:147]
    ds_read_b128 a[220:223], v11 offset:4096
    s_waitcnt lgkmcnt(11)
    s_waitcnt lgkmcnt(10)
    v_mfma_f32_32x32x16_bf16 v[20:35], v[148:151], a[72:75], v[20:35]
    ds_read_b64_tr_b16 v[164:165], v12 offset:6144
    ds_read_b64_tr_b16 v[166:167], v12 offset:7168
    ds_read_b64_tr_b16 v[168:169], v13 offset:6144
    ds_read_b64_tr_b16 v[170:171], v13 offset:7168
    v_mfma_f32_32x32x16_bf16 v[84:99], v[148:151], a[200:203], v[84:99]
    ds_read_b64_tr_b16 v[172:173], v14 offset:6144
    ds_read_b64_tr_b16 v[174:175], v14 offset:7168
    s_waitcnt lgkmcnt(11)
    v_mfma_f32_32x32x16_bf16 v[36:51], v[152:155], a[72:75], v[36:51]
    ds_read_b64_tr_b16 v[176:177], v15 offset:6144
    ds_read_b64_tr_b16 v[178:179], v15 offset:7168
    v_mfma_f32_32x32x16_bf16 v[100:115], v[152:155], a[200:203], v[100:115]
    s_add_u32 s53, s55, 0x380
    s_add_u32 m0, s56, 0x18000
    buffer_load_dwordx4 v2, s[20:23], s53 offen lds
    v_mfma_f32_32x32x16_bf16 v[52:67], v[156:159], a[72:75], v[52:67]
    s_add_u32 s53, s55, 0x2380
    s_add_u32 m0, s56, 0x18400
    buffer_load_dwordx4 v3, s[20:23], s53 offen lds
    v_mfma_f32_32x32x16_bf16 v[116:131], v[156:159], a[200:203], v[116:131]
    s_add_u32 s53, s55, 0x4380
    s_add_u32 m0, s56, 0x18800
    buffer_load_dwordx4 v2, s[20:23], s53 offen lds
    s_waitcnt lgkmcnt(12)
    v_mfma_f32_32x32x16_bf16 v[68:83], v[160:163], a[72:75], v[68:83]
    s_add_u32 s53, s55, 0x6380
    s_add_u32 m0, s56, 0x18c00
    buffer_load_dwordx4 v3, s[20:23], s53 offen lds
    v_mfma_f32_32x32x16_bf16 v[132:147], v[160:163], a[200:203], v[132:147]
    s_add_u32 s53, s55, 0x8380
    s_add_u32 m0, s56, 0x19000
    buffer_load_dwordx4 v2, s[20:23], s53 offen lds
    s_waitcnt lgkmcnt(6)
    v_mfma_f32_32x32x16_bf16 v[20:35], v[164:167], a[76:79], v[20:35]
    ds_read_b64_tr_b16 v[148:149], v12 offset:16384
    ds_read_b64_tr_b16 v[150:151], v12 offset:17408
    ds_read_b64_tr_b16 v[152:153], v13 offset:16384
    ds_read_b64_tr_b16 v[154:155], v13 offset:17408
    v_mfma_f32_32x32x16_bf16 v[84:99], v[164:167], a[204:207], v[84:99]
    ds_read_b64_tr_b16 v[156:157], v14 offset:16384
    ds_read_b64_tr_b16 v[158:159], v14 offset:17408
    ds_read_b64_tr_b16 v[160:161], v15 offset:16384
    ds_read_b64_tr_b16 v[162:163], v15 offset:17408
    s_waitcnt lgkmcnt(12)
    v_mfma_f32_32x32x16_bf16 v[36:51], v[168:171], a[76:79], v[36:51]
    s_add_u32 s53, s55, 0xa380
    s_add_u32 m0, s56, 0x19400
    buffer_load_dwordx4 v3, s[20:23], s53 offen lds
    s_add_u32 s53, s55, 0xc380
    s_add_u32 m0, s56, 0x19800
    buffer_load_dwordx4 v2, s[20:23], s53 offen lds
    v_mfma_f32_32x32x16_bf16 v[100:115], v[168:171], a[204:207], v[100:115]
    s_add_u32 s53, s55, 0xe380
    s_add_u32 m0, s56, 0x19c00
    buffer_load_dwordx4 v3, s[20:23], s53 offen lds
    s_add_u32 s53, s52, 0x380000
    s_add_u32 m0, s54, 0xc000
    buffer_load_dwordx4 v1, s[28:31], s53 offen lds
    s_waitcnt lgkmcnt(10)
    v_mfma_f32_32x32x16_bf16 v[52:67], v[172:175], a[76:79], v[52:67]
    s_add_u32 s53, s52, 0x388000
    s_add_u32 m0, s54, 0xc400
    buffer_load_dwordx4 v1, s[28:31], s53 offen lds
    v_mfma_f32_32x32x16_bf16 v[116:131], v[172:175], a[204:207], v[116:131]
    s_add_u32 s53, s52, 0x390000
    s_add_u32 m0, s54, 0xc800
    buffer_load_dwordx4 v1, s[28:31], s53 offen lds
    s_waitcnt lgkmcnt(8)
    v_mfma_f32_32x32x16_bf16 v[68:83], v[176:179], a[76:79], v[68:83]
    s_add_u32 s53, s52, 0x398000
    s_add_u32 m0, s54, 0xcc00
    buffer_load_dwordx4 v1, s[28:31], s53 offen lds
    v_mfma_f32_32x32x16_bf16 v[132:147], v[176:179], a[204:207], v[132:147]
    s_waitcnt vmcnt(12)
    s_barrier
    s_waitcnt lgkmcnt(6)
    v_mfma_f32_32x32x16_bf16 v[20:35], v[148:151], a[80:83], v[20:35]
    ds_read_b64_tr_b16 v[164:165], v12 offset:18432
    ds_read_b64_tr_b16 v[166:167], v12 offset:19456
    v_mfma_f32_32x32x16_bf16 v[84:99], v[148:151], a[208:211], v[84:99]
    ds_read_b64_tr_b16 v[168:169], v13 offset:18432
    ds_read_b64_tr_b16 v[170:171], v13 offset:19456
    s_waitcnt lgkmcnt(8)
    v_mfma_f32_32x32x16_bf16 v[36:51], v[152:155], a[80:83], v[36:51]
    ds_read_b64_tr_b16 v[172:173], v14 offset:18432
    ds_read_b64_tr_b16 v[174:175], v14 offset:19456
    v_mfma_f32_32x32x16_bf16 v[100:115], v[152:155], a[208:211], v[100:115]
    ds_read_b64_tr_b16 v[176:177], v15 offset:18432
    ds_read_b64_tr_b16 v[178:179], v15 offset:19456
    s_waitcnt lgkmcnt(10)
    v_mfma_f32_32x32x16_bf16 v[52:67], v[156:159], a[80:83], v[52:67]
    ds_read_b128 a[96:99], v4 offset:0
    v_mfma_f32_32x32x16_bf16 v[116:131], v[156:159], a[208:211], v[116:131]
    ds_read_b128 a[100:103], v5 offset:0
    s_waitcnt lgkmcnt(10)
    v_mfma_f32_32x32x16_bf16 v[68:83], v[160:163], a[80:83], v[68:83]
    ds_read_b128 a[104:107], v6 offset:0
    v_mfma_f32_32x32x16_bf16 v[132:147], v[160:163], a[208:211], v[132:147]
    ds_read_b128 a[108:111], v7 offset:0
    s_waitcnt lgkmcnt(10)
    v_mfma_f32_32x32x16_bf16 v[20:35], v[164:167], a[84:87], v[20:35]
    ds_read_b64_tr_b16 v[148:149], v12 offset:20480
    ds_read_b64_tr_b16 v[150:151], v12 offset:21504
    v_mfma_f32_32x32x16_bf16 v[84:99], v[164:167], a[212:215], v[84:99]
    ds_read_b64_tr_b16 v[152:153], v13 offset:20480
    ds_read_b64_tr_b16 v[154:155], v13 offset:21504
    s_waitcnt lgkmcnt(12)
    v_mfma_f32_32x32x16_bf16 v[36:51], v[168:171], a[84:87], v[36:51]
    ds_read_b64_tr_b16 v[156:157], v14 offset:20480
    ds_read_b64_tr_b16 v[158:159], v14 offset:21504
    v_mfma_f32_32x32x16_bf16 v[100:115], v[168:171], a[212:215], v[100:115]
    ds_read_b64_tr_b16 v[160:161], v15 offset:20480
    ds_read_b64_tr_b16 v[162:163], v15 offset:21504
    s_waitcnt lgkmcnt(11)
    v_mfma_f32_32x32x16_bf16 v[52:67], v[172:175], a[84:87], v[52:67]
    ds_read_b128 a[224:227], v4 offset:4096
    v_mfma_f32_32x32x16_bf16 v[116:131], v[172:175], a[212:215], v[116:131]
    ds_read_b128 a[228:231], v5 offset:4096
    v_mfma_f32_32x32x16_bf16 v[68:83], v[176:179], a[84:87], v[68:83]
    ds_read_b128 a[232:235], v6 offset:4096
    v_mfma_f32_32x32x16_bf16 v[132:147], v[176:179], a[212:215], v[132:147]
    ds_read_b128 a[236:239], v7 offset:4096
    s_waitcnt lgkmcnt(11)
    s_waitcnt lgkmcnt(10)
    v_mfma_f32_32x32x16_bf16 v[20:35], v[148:151], a[88:91], v[20:35]
    ds_read_b64_tr_b16 v[164:165], v12 offset:22528
    ds_read_b64_tr_b16 v[166:167], v12 offset:23552
    ds_read_b64_tr_b16 v[168:169], v13 offset:22528
    ds_read_b64_tr_b16 v[170:171], v13 offset:23552
    v_mfma_f32_32x32x16_bf16 v[84:99], v[148:151], a[216:219], v[84:99]
    ds_read_b64_tr_b16 v[172:173], v14 offset:22528
    ds_read_b64_tr_b16 v[174:175], v14 offset:23552
    s_waitcnt lgkmcnt(11)
    v_mfma_f32_32x32x16_bf16 v[36:51], v[152:155], a[88:91], v[36:51]
    ds_read_b64_tr_b16 v[176:177], v15 offset:22528
    ds_read_b64_tr_b16 v[178:179], v15 offset:23552
    v_mfma_f32_32x32x16_bf16 v[100:115], v[152:155], a[216:219], v[100:115]
    s_add_u32 s53, s55, 0x0
    s_add_u32 m0, s56, 0x20000
    buffer_load_dwordx4 v2, s[24:27], s53 offen lds
    v_mfma_f32_32x32x16_bf16 v[52:67], v[156:159], a[88:91], v[52:67]
    s_add_u32 s53, s55, 0x2000
    s_add_u32 m0, s56, 0x20400
    buffer_load_dwordx4 v3, s[24:27], s53 offen lds
    v_mfma_f32_32x32x16_bf16 v[116:131], v[156:159], a[216:219], v[116:131]
    s_add_u32 s53, s55, 0x4000
    s_add_u32 m0, s56, 0x20800
    buffer_load_dwordx4 v2, s[24:27], s53 offen lds
    s_waitcnt lgkmcnt(12)
    v_mfma_f32_32x32x16_bf16 v[68:83], v[160:163], a[88:91], v[68:83]
    s_add_u32 s53, s55, 0x6000
    s_add_u32 m0, s56, 0x20c00
    buffer_load_dwordx4 v3, s[24:27], s53 offen lds
    v_mfma_f32_32x32x16_bf16 v[132:147], v[160:163], a[216:219], v[132:147]
    s_add_u32 s53, s55, 0x8000
    s_add_u32 m0, s56, 0x21000
    buffer_load_dwordx4 v2, s[24:27], s53 offen lds
    s_waitcnt lgkmcnt(6)
    v_mfma_f32_32x32x16_bf16 v[20:35], v[164:167], a[92:95], v[20:35]
    ds_read_b64_tr_b16 v[148:149], v12 offset:32768
    ds_read_b64_tr_b16 v[150:151], v12 offset:33792
    ds_read_b64_tr_b16 v[152:153], v13 offset:32768
    ds_read_b64_tr_b16 v[154:155], v13 offset:33792
    v_mfma_f32_32x32x16_bf16 v[84:99], v[164:167], a[220:223], v[84:99]
    ds_read_b64_tr_b16 v[156:157], v14 offset:32768
    ds_read_b64_tr_b16 v[158:159], v14 offset:33792
    ds_read_b64_tr_b16 v[160:161], v15 offset:32768
    ds_read_b64_tr_b16 v[162:163], v15 offset:33792
    s_waitcnt lgkmcnt(12)
    v_mfma_f32_32x32x16_bf16 v[36:51], v[168:171], a[92:95], v[36:51]
    s_add_u32 s53, s55, 0xa000
    s_add_u32 m0, s56, 0x21400
    buffer_load_dwordx4 v3, s[24:27], s53 offen lds
    s_add_u32 s53, s55, 0xc000
    s_add_u32 m0, s56, 0x21800
    buffer_load_dwordx4 v2, s[24:27], s53 offen lds
    v_mfma_f32_32x32x16_bf16 v[100:115], v[168:171], a[220:223], v[100:115]
    s_add_u32 s53, s55, 0xe000
    s_add_u32 m0, s56, 0x21c00
    buffer_load_dwordx4 v3, s[24:27], s53 offen lds
    s_add_u32 s53, s52, 0x0
    s_add_u32 m0, s54, 0x0
    buffer_load_dwordx4 v1, s[32:35], s53 offen lds
    s_waitcnt lgkmcnt(10)
    v_mfma_f32_32x32x16_bf16 v[52:67], v[172:175], a[92:95], v[52:67]
    s_add_u32 s53, s52, 0x8000
    s_add_u32 m0, s54, 0x400
    buffer_load_dwordx4 v1, s[32:35], s53 offen lds
    v_mfma_f32_32x32x16_bf16 v[116:131], v[172:175], a[220:223], v[116:131]
    s_add_u32 s53, s52, 0x10000
    s_add_u32 m0, s54, 0x800
    buffer_load_dwordx4 v1, s[32:35], s53 offen lds
    s_waitcnt lgkmcnt(8)
    v_mfma_f32_32x32x16_bf16 v[68:83], v[176:179], a[92:95], v[68:83]
    s_add_u32 s53, s52, 0x18000
    s_add_u32 m0, s54, 0xc00
    buffer_load_dwordx4 v1, s[32:35], s53 offen lds
    v_mfma_f32_32x32x16_bf16 v[132:147], v[176:179], a[220:223], v[132:147]
    s_waitcnt vmcnt(12)
    s_barrier
    s_waitcnt lgkmcnt(6)
    v_mfma_f32_32x32x16_bf16 v[20:35], v[148:151], a[96:99], v[20:35]
    ds_read_b64_tr_b16 v[164:165], v12 offset:34816
    ds_read_b64_tr_b16 v[166:167], v12 offset:35840
    v_mfma_f32_32x32x16_bf16 v[84:99], v[148:151], a[224:227], v[84:99]
    ds_read_b64_tr_b16 v[168:169], v13 offset:34816
    ds_read_b64_tr_b16 v[170:171], v13 offset:35840
    s_waitcnt lgkmcnt(8)
    v_mfma_f32_32x32x16_bf16 v[36:51], v[152:155], a[96:99], v[36:51]
    ds_read_b64_tr_b16 v[172:173], v14 offset:34816
    ds_read_b64_tr_b16 v[174:175], v14 offset:35840
    v_mfma_f32_32x32x16_bf16 v[100:115], v[152:155], a[224:227], v[100:115]
    ds_read_b64_tr_b16 v[176:177], v15 offset:34816
    ds_read_b64_tr_b16 v[178:179], v15 offset:35840
    s_waitcnt lgkmcnt(10)
    v_mfma_f32_32x32x16_bf16 v[52:67], v[156:159], a[96:99], v[52:67]
    ds_read_b128 a[112:115], v4 offset:32768
    v_mfma_f32_32x32x16_bf16 v[116:131], v[156:159], a[224:227], v[116:131]
    ds_read_b128 a[116:119], v5 offset:32768
    s_waitcnt lgkmcnt(10)
    v_mfma_f32_32x32x16_bf16 v[68:83], v[160:163], a[96:99], v[68:83]
    ds_read_b128 a[120:123], v6 offset:32768
    v_mfma_f32_32x32x16_bf16 v[132:147], v[160:163], a[224:227], v[132:147]
    ds_read_b128 a[124:127], v7 offset:32768
    s_waitcnt lgkmcnt(10)
    v_mfma_f32_32x32x16_bf16 v[20:35], v[164:167], a[100:103], v[20:35]
    ds_read_b64_tr_b16 v[148:149], v12 offset:36864
    ds_read_b64_tr_b16 v[150:151], v12 offset:37888
    v_mfma_f32_32x32x16_bf16 v[84:99], v[164:167], a[228:231], v[84:99]
    ds_read_b64_tr_b16 v[152:153], v13 offset:36864
    ds_read_b64_tr_b16 v[154:155], v13 offset:37888
    s_waitcnt lgkmcnt(12)
    v_mfma_f32_32x32x16_bf16 v[36:51], v[168:171], a[100:103], v[36:51]
    ds_read_b64_tr_b16 v[156:157], v14 offset:36864
    ds_read_b64_tr_b16 v[158:159], v14 offset:37888
    v_mfma_f32_32x32x16_bf16 v[100:115], v[168:171], a[228:231], v[100:115]
    ds_read_b64_tr_b16 v[160:161], v15 offset:36864
    ds_read_b64_tr_b16 v[162:163], v15 offset:37888
    s_waitcnt lgkmcnt(11)
    v_mfma_f32_32x32x16_bf16 v[52:67], v[172:175], a[100:103], v[52:67]
    ds_read_b128 a[240:243], v4 offset:36864
    v_mfma_f32_32x32x16_bf16 v[116:131], v[172:175], a[228:231], v[116:131]
    ds_read_b128 a[244:247], v5 offset:36864
    v_mfma_f32_32x32x16_bf16 v[68:83], v[176:179], a[100:103], v[68:83]
    ds_read_b128 a[248:251], v6 offset:36864
    v_mfma_f32_32x32x16_bf16 v[132:147], v[176:179], a[228:231], v[132:147]
    ds_read_b128 a[252:255], v7 offset:36864
    s_waitcnt lgkmcnt(11)
    s_waitcnt lgkmcnt(10)
    v_mfma_f32_32x32x16_bf16 v[20:35], v[148:151], a[104:107], v[20:35]
    ds_read_b64_tr_b16 v[164:165], v12 offset:38912
    ds_read_b64_tr_b16 v[166:167], v12 offset:39936
    ds_read_b64_tr_b16 v[168:169], v13 offset:38912
    ds_read_b64_tr_b16 v[170:171], v13 offset:39936
    v_mfma_f32_32x32x16_bf16 v[84:99], v[148:151], a[232:235], v[84:99]
    ds_read_b64_tr_b16 v[172:173], v14 offset:38912
    ds_read_b64_tr_b16 v[174:175], v14 offset:39936
    s_waitcnt lgkmcnt(11)
    v_mfma_f32_32x32x16_bf16 v[36:51], v[152:155], a[104:107], v[36:51]
    ds_read_b64_tr_b16 v[176:177], v15 offset:38912
    ds_read_b64_tr_b16 v[178:179], v15 offset:39936
    v_mfma_f32_32x32x16_bf16 v[100:115], v[152:155], a[232:235], v[100:115]
    s_add_u32 s53, s55, 0x80
    s_add_u32 m0, s56, 0x10000
    buffer_load_dwordx4 v2, s[24:27], s53 offen lds
    v_mfma_f32_32x32x16_bf16 v[52:67], v[156:159], a[104:107], v[52:67]
    s_add_u32 s53, s55, 0x2080
    s_add_u32 m0, s56, 0x10400
    buffer_load_dwordx4 v3, s[24:27], s53 offen lds
    v_mfma_f32_32x32x16_bf16 v[116:131], v[156:159], a[232:235], v[116:131]
    s_add_u32 s53, s55, 0x4080
    s_add_u32 m0, s56, 0x10800
    buffer_load_dwordx4 v2, s[24:27], s53 offen lds
    s_waitcnt lgkmcnt(12)
    v_mfma_f32_32x32x16_bf16 v[68:83], v[160:163], a[104:107], v[68:83]
    s_add_u32 s53, s55, 0x6080
    s_add_u32 m0, s56, 0x10c00
    buffer_load_dwordx4 v3, s[24:27], s53 offen lds
    v_mfma_f32_32x32x16_bf16 v[132:147], v[160:163], a[232:235], v[132:147]
    s_add_u32 s53, s55, 0x8080
    s_add_u32 m0, s56, 0x11000
    buffer_load_dwordx4 v2, s[24:27], s53 offen lds
    s_waitcnt lgkmcnt(6)
    v_mfma_f32_32x32x16_bf16 v[20:35], v[164:167], a[108:111], v[20:35]
    ds_read_b64_tr_b16 v[148:149], v12 offset:49152
    ds_read_b64_tr_b16 v[150:151], v12 offset:50176
    ds_read_b64_tr_b16 v[152:153], v13 offset:49152
    ds_read_b64_tr_b16 v[154:155], v13 offset:50176
    v_mfma_f32_32x32x16_bf16 v[84:99], v[164:167], a[236:239], v[84:99]
    ds_read_b64_tr_b16 v[156:157], v14 offset:49152
    ds_read_b64_tr_b16 v[158:159], v14 offset:50176
    ds_read_b64_tr_b16 v[160:161], v15 offset:49152
    ds_read_b64_tr_b16 v[162:163], v15 offset:50176
    s_waitcnt lgkmcnt(12)
    v_mfma_f32_32x32x16_bf16 v[36:51], v[168:171], a[108:111], v[36:51]
    s_add_u32 s53, s55, 0xa080
    s_add_u32 m0, s56, 0x11400
    buffer_load_dwordx4 v3, s[24:27], s53 offen lds
    s_add_u32 s53, s55, 0xc080
    s_add_u32 m0, s56, 0x11800
    buffer_load_dwordx4 v2, s[24:27], s53 offen lds
    v_mfma_f32_32x32x16_bf16 v[100:115], v[168:171], a[236:239], v[100:115]
    s_add_u32 s53, s55, 0xe080
    s_add_u32 m0, s56, 0x11c00
    buffer_load_dwordx4 v3, s[24:27], s53 offen lds
    s_add_u32 s53, s52, 0x80000
    s_add_u32 m0, s54, 0x4000
    buffer_load_dwordx4 v1, s[32:35], s53 offen lds
    s_waitcnt lgkmcnt(10)
    v_mfma_f32_32x32x16_bf16 v[52:67], v[172:175], a[108:111], v[52:67]
    s_add_u32 s53, s52, 0x88000
    s_add_u32 m0, s54, 0x4400
    buffer_load_dwordx4 v1, s[32:35], s53 offen lds
    v_mfma_f32_32x32x16_bf16 v[116:131], v[172:175], a[236:239], v[116:131]
    s_add_u32 s53, s52, 0x90000
    s_add_u32 m0, s54, 0x4800
    buffer_load_dwordx4 v1, s[32:35], s53 offen lds
    s_waitcnt lgkmcnt(8)
    v_mfma_f32_32x32x16_bf16 v[68:83], v[176:179], a[108:111], v[68:83]
    s_add_u32 s53, s52, 0x98000
    s_add_u32 m0, s54, 0x4c00
    buffer_load_dwordx4 v1, s[32:35], s53 offen lds
    v_mfma_f32_32x32x16_bf16 v[132:147], v[176:179], a[236:239], v[132:147]
    s_waitcnt vmcnt(12)
    s_barrier
    s_waitcnt lgkmcnt(6)
    v_mfma_f32_32x32x16_bf16 v[20:35], v[148:151], a[112:115], v[20:35]
    ds_read_b64_tr_b16 v[164:165], v12 offset:51200
    ds_read_b64_tr_b16 v[166:167], v12 offset:52224
    v_mfma_f32_32x32x16_bf16 v[84:99], v[148:151], a[240:243], v[84:99]
    ds_read_b64_tr_b16 v[168:169], v13 offset:51200
    ds_read_b64_tr_b16 v[170:171], v13 offset:52224
    s_waitcnt lgkmcnt(8)
    v_mfma_f32_32x32x16_bf16 v[36:51], v[152:155], a[112:115], v[36:51]
    ds_read_b64_tr_b16 v[172:173], v14 offset:51200
    ds_read_b64_tr_b16 v[174:175], v14 offset:52224
    v_mfma_f32_32x32x16_bf16 v[100:115], v[152:155], a[240:243], v[100:115]
    ds_read_b64_tr_b16 v[176:177], v15 offset:51200
    ds_read_b64_tr_b16 v[178:179], v15 offset:52224
    s_waitcnt lgkmcnt(10)
    v_mfma_f32_32x32x16_bf16 v[52:67], v[156:159], a[112:115], v[52:67]
    ds_read_b128 a[0:3], v8 offset:0
    v_mfma_f32_32x32x16_bf16 v[116:131], v[156:159], a[240:243], v[116:131]
    ds_read_b128 a[4:7], v9 offset:0
    s_waitcnt lgkmcnt(10)
    v_mfma_f32_32x32x16_bf16 v[68:83], v[160:163], a[112:115], v[68:83]
    ds_read_b128 a[8:11], v10 offset:0
    v_mfma_f32_32x32x16_bf16 v[132:147], v[160:163], a[240:243], v[132:147]
    ds_read_b128 a[12:15], v11 offset:0
    s_waitcnt lgkmcnt(10)
    v_mfma_f32_32x32x16_bf16 v[20:35], v[164:167], a[116:119], v[20:35]
    ds_read_b64_tr_b16 v[148:149], v12 offset:53248
    ds_read_b64_tr_b16 v[150:151], v12 offset:54272
    v_mfma_f32_32x32x16_bf16 v[84:99], v[164:167], a[244:247], v[84:99]
    ds_read_b64_tr_b16 v[152:153], v13 offset:53248
    ds_read_b64_tr_b16 v[154:155], v13 offset:54272
    s_waitcnt lgkmcnt(12)
    v_mfma_f32_32x32x16_bf16 v[36:51], v[168:171], a[116:119], v[36:51]
    ds_read_b64_tr_b16 v[156:157], v14 offset:53248
    ds_read_b64_tr_b16 v[158:159], v14 offset:54272
    v_mfma_f32_32x32x16_bf16 v[100:115], v[168:171], a[244:247], v[100:115]
    ds_read_b64_tr_b16 v[160:161], v15 offset:53248
    ds_read_b64_tr_b16 v[162:163], v15 offset:54272
    s_waitcnt lgkmcnt(11)
    v_mfma_f32_32x32x16_bf16 v[52:67], v[172:175], a[116:119], v[52:67]
    ds_read_b128 a[128:131], v8 offset:4096
    v_mfma_f32_32x32x16_bf16 v[116:131], v[172:175], a[244:247], v[116:131]
    ds_read_b128 a[132:135], v9 offset:4096
    v_mfma_f32_32x32x16_bf16 v[68:83], v[176:179], a[116:119], v[68:83]
    ds_read_b128 a[136:139], v10 offset:4096
    v_mfma_f32_32x32x16_bf16 v[132:147], v[176:179], a[244:247], v[132:147]
    ds_read_b128 a[140:143], v11 offset:4096
    s_waitcnt lgkmcnt(11)
    s_waitcnt lgkmcnt(10)
    v_mfma_f32_32x32x16_bf16 v[20:35], v[148:151], a[120:123], v[20:35]
    ds_read_b64_tr_b16 v[164:165], v12 offset:55296
    ds_read_b64_tr_b16 v[166:167], v12 offset:56320
    ds_read_b64_tr_b16 v[168:169], v13 offset:55296
    ds_read_b64_tr_b16 v[170:171], v13 offset:56320
    v_mfma_f32_32x32x16_bf16 v[84:99], v[148:151], a[248:251], v[84:99]
    ds_read_b64_tr_b16 v[172:173], v14 offset:55296
    ds_read_b64_tr_b16 v[174:175], v14 offset:56320
    s_waitcnt lgkmcnt(11)
    v_mfma_f32_32x32x16_bf16 v[36:51], v[152:155], a[120:123], v[36:51]
    ds_read_b64_tr_b16 v[176:177], v15 offset:55296
    ds_read_b64_tr_b16 v[178:179], v15 offset:56320
    v_mfma_f32_32x32x16_bf16 v[100:115], v[152:155], a[248:251], v[100:115]
    s_add_u32 s53, s55, 0x100
    s_add_u32 m0, s56, 0x18000
    buffer_load_dwordx4 v2, s[24:27], s53 offen lds
    v_mfma_f32_32x32x16_bf16 v[52:67], v[156:159], a[120:123], v[52:67]
    s_add_u32 s53, s55, 0x2100
    s_add_u32 m0, s56, 0x18400
    buffer_load_dwordx4 v3, s[24:27], s53 offen lds
    v_mfma_f32_32x32x16_bf16 v[116:131], v[156:159], a[248:251], v[116:131]
    s_add_u32 s53, s55, 0x4100
    s_add_u32 m0, s56, 0x18800
    buffer_load_dwordx4 v2, s[24:27], s53 offen lds
    s_waitcnt lgkmcnt(12)
    v_mfma_f32_32x32x16_bf16 v[68:83], v[160:163], a[120:123], v[68:83]
    s_add_u32 s53, s55, 0x6100
    s_add_u32 m0, s56, 0x18c00
    buffer_load_dwordx4 v3, s[24:27], s53 offen lds
    v_mfma_f32_32x32x16_bf16 v[132:147], v[160:163], a[248:251], v[132:147]
    s_add_u32 s53, s55, 0x8100
    s_add_u32 m0, s56, 0x19000
    buffer_load_dwordx4 v2, s[24:27], s53 offen lds
    s_waitcnt lgkmcnt(6)
    v_mfma_f32_32x32x16_bf16 v[20:35], v[164:167], a[124:127], v[20:35]
    ds_read_b64_tr_b16 v[148:149], v12 offset:0
    ds_read_b64_tr_b16 v[150:151], v12 offset:1024
    ds_read_b64_tr_b16 v[152:153], v13 offset:0
    ds_read_b64_tr_b16 v[154:155], v13 offset:1024
    v_mfma_f32_32x32x16_bf16 v[84:99], v[164:167], a[252:255], v[84:99]
    ds_read_b64_tr_b16 v[156:157], v14 offset:0
    ds_read_b64_tr_b16 v[158:159], v14 offset:1024
    ds_read_b64_tr_b16 v[160:161], v15 offset:0
    ds_read_b64_tr_b16 v[162:163], v15 offset:1024
    s_waitcnt lgkmcnt(12)
    v_mfma_f32_32x32x16_bf16 v[36:51], v[168:171], a[124:127], v[36:51]
    s_add_u32 s53, s55, 0xa100
    s_add_u32 m0, s56, 0x19400
    buffer_load_dwordx4 v3, s[24:27], s53 offen lds
    s_add_u32 s53, s55, 0xc100
    s_add_u32 m0, s56, 0x19800
    buffer_load_dwordx4 v2, s[24:27], s53 offen lds
    v_mfma_f32_32x32x16_bf16 v[100:115], v[168:171], a[252:255], v[100:115]
    s_add_u32 s53, s55, 0xe100
    s_add_u32 m0, s56, 0x19c00
    buffer_load_dwordx4 v3, s[24:27], s53 offen lds
    s_add_u32 s53, s52, 0x100000
    s_add_u32 m0, s54, 0x8000
    buffer_load_dwordx4 v1, s[32:35], s53 offen lds
    s_waitcnt lgkmcnt(10)
    v_mfma_f32_32x32x16_bf16 v[52:67], v[172:175], a[124:127], v[52:67]
    s_add_u32 s53, s52, 0x108000
    s_add_u32 m0, s54, 0x8400
    buffer_load_dwordx4 v1, s[32:35], s53 offen lds
    v_mfma_f32_32x32x16_bf16 v[116:131], v[172:175], a[252:255], v[116:131]
    s_add_u32 s53, s52, 0x110000
    s_add_u32 m0, s54, 0x8800
    buffer_load_dwordx4 v1, s[32:35], s53 offen lds
    s_waitcnt lgkmcnt(8)
    v_mfma_f32_32x32x16_bf16 v[68:83], v[176:179], a[124:127], v[68:83]
    s_add_u32 s53, s52, 0x118000
    s_add_u32 m0, s54, 0x8c00
    buffer_load_dwordx4 v1, s[32:35], s53 offen lds
    v_mfma_f32_32x32x16_bf16 v[132:147], v[176:179], a[252:255], v[132:147]
    s_nop 7
    s_waitcnt vmcnt(12)
    s_barrier
    v_cvt_pk_bf16_f32 v180, v20, v21
    v_cvt_pk_bf16_f32 v181, v22, v23
    v_cvt_pk_bf16_f32 v182, v24, v25
    v_cvt_pk_bf16_f32 v183, v26, v27
    s_nop 1
    v_permlane32_swap_b32 v180, v182
    v_permlane32_swap_b32 v181, v183
    v_cvt_pk_bf16_f32 v184, v28, v29
    v_cvt_pk_bf16_f32 v185, v30, v31
    v_cvt_pk_bf16_f32 v186, v32, v33
    v_cvt_pk_bf16_f32 v187, v34, v35
    s_nop 1
    v_permlane32_swap_b32 v184, v186
    v_permlane32_swap_b32 v185, v187
    s_waitcnt lgkmcnt(6)
    v_mfma_f32_32x32x16_bf16 v[20:35], v[148:151], a[0:3], 0
    ds_read_b64_tr_b16 v[164:165], v12 offset:2048
    ds_read_b64_tr_b16 v[166:167], v12 offset:3072
    v_cvt_pk_bf16_f32 v212, v84, v85
    v_cvt_pk_bf16_f32 v213, v86, v87
    v_cvt_pk_bf16_f32 v214, v88, v89
    v_cvt_pk_bf16_f32 v215, v90, v91
    s_nop 1
    v_permlane32_swap_b32 v212, v214
    v_permlane32_swap_b32 v213, v215
    v_cvt_pk_bf16_f32 v216, v92, v93
    v_cvt_pk_bf16_f32 v217, v94, v95
    v_cvt_pk_bf16_f32 v218, v96, v97
    v_cvt_pk_bf16_f32 v219, v98, v99
    s_nop 1
    v_permlane32_swap_b32 v216, v218
    v_permlane32_swap_b32 v217, v219
    v_mfma_f32_32x32x16_bf16 v[84:99], v[148:151], a[128:131], 0
    ds_read_b64_tr_b16 v[168:169], v13 offset:2048
    ds_read_b64_tr_b16 v[170:171], v13 offset:3072
    v_cvt_pk_bf16_f32 v188, v36, v37
    v_cvt_pk_bf16_f32 v189, v38, v39
    v_cvt_pk_bf16_f32 v190, v40, v41
    v_cvt_pk_bf16_f32 v191, v42, v43
    s_nop 1
    v_permlane32_swap_b32 v188, v190
    v_permlane32_swap_b32 v189, v191
    v_cvt_pk_bf16_f32 v192, v44, v45
    v_cvt_pk_bf16_f32 v193, v46, v47
    v_cvt_pk_bf16_f32 v194, v48, v49
    v_cvt_pk_bf16_f32 v195, v50, v51
    s_nop 1
    v_permlane32_swap_b32 v192, v194
    v_permlane32_swap_b32 v193, v195
    s_waitcnt lgkmcnt(8)
    v_mfma_f32_32x32x16_bf16 v[36:51], v[152:155], a[0:3], 0
    ds_read_b64_tr_b16 v[172:173], v14 offset:2048
    ds_read_b64_tr_b16 v[174:175], v14 offset:3072
    v_cvt_pk_bf16_f32 v220, v100, v101
    v_cvt_pk_bf16_f32 v221, v102, v103
    v_cvt_pk_bf16_f32 v222, v104, v105
    v_cvt_pk_bf16_f32 v223, v106, v107
    s_nop 1
    v_permlane32_swap_b32 v220, v222
    v_permlane32_swap_b32 v221, v223
    v_cvt_pk_bf16_f32 v224, v108, v109
    v_cvt_pk_bf16_f32 v225, v110, v111
    v_cvt_pk_bf16_f32 v226, v112, v113
    v_cvt_pk_bf16_f32 v227, v114, v115
    s_nop 1
    v_permlane32_swap_b32 v224, v226
    v_permlane32_swap_b32 v225, v227
    v_mfma_f32_32x32x16_bf16 v[100:115], v[152:155], a[128:131], 0
    ds_read_b64_tr_b16 v[176:177], v15 offset:2048
    ds_read_b64_tr_b16 v[178:179], v15 offset:3072
    v_cvt_pk_bf16_f32 v196, v52, v53
    v_cvt_pk_bf16_f32 v197, v54, v55
    v_cvt_pk_bf16_f32 v198, v56, v57
    v_cvt_pk_bf16_f32 v199, v58, v59
    s_nop 1
    v_permlane32_swap_b32 v196, v198
    v_permlane32_swap_b32 v197, v199
    v_cvt_pk_bf16_f32 v200, v60, v61
    v_cvt_pk_bf16_f32 v201, v62, v63
    v_cvt_pk_bf16_f32 v202, v64, v65
    v_cvt_pk_bf16_f32 v203, v66, v67
    s_nop 1
    v_permlane32_swap_b32 v200, v202
    v_permlane32_swap_b32 v201, v203
    s_waitcnt lgkmcnt(10)
    v_mfma_f32_32x32x16_bf16 v[52:67], v[156:159], a[0:3], 0
    ds_read_b128 a[16:19], v4 offset:0
    v_cvt_pk_bf16_f32 v228, v116, v117
    v_cvt_pk_bf16_f32 v229, v118, v119
    v_cvt_pk_bf16_f32 v230, v120, v121
    v_cvt_pk_bf16_f32 v231, v122, v123
    s_nop 1
    v_permlane32_swap_b32 v228, v230
    v_permlane32_swap_b32 v229, v231
    v_cvt_pk_bf16_f32 v232, v124, v125
    v_cvt_pk_bf16_f32 v233, v126, v127
    v_cvt_pk_bf16_f32 v234, v128, v129
    v_cvt_pk_bf16_f32 v235, v130, v131
    s_nop 1
    v_permlane32_swap_b32 v232, v234
    v_permlane32_swap_b32 v233, v235
    v_mfma_f32_32x32x16_bf16 v[116:131], v[156:159], a[128:131], 0
    ds_read_b128 a[20:23], v5 offset:0
    v_cvt_pk_bf16_f32 v204, v68, v69
    v_cvt_pk_bf16_f32 v205, v70, v71
    v_cvt_pk_bf16_f32 v206, v72, v73
    v_cvt_pk_bf16_f32 v207, v74, v75
    s_nop 1
    v_permlane32_swap_b32 v204, v206
    v_permlane32_swap_b32 v205, v207
    v_cvt_pk_bf16_f32 v208, v76, v77
    v_cvt_pk_bf16_f32 v209, v78, v79
    v_cvt_pk_bf16_f32 v210, v80, v81
    v_cvt_pk_bf16_f32 v211, v82, v83
    s_nop 1
    v_permlane32_swap_b32 v208, v210
    v_permlane32_swap_b32 v209, v211
    s_waitcnt lgkmcnt(10)
    v_mfma_f32_32x32x16_bf16 v[68:83], v[160:163], a[0:3], 0
    ds_read_b128 a[24:27], v6 offset:0
    v_cvt_pk_bf16_f32 v236, v132, v133
    v_cvt_pk_bf16_f32 v237, v134, v135
    v_cvt_pk_bf16_f32 v238, v136, v137
    v_cvt_pk_bf16_f32 v239, v138, v139
    s_nop 1
    v_permlane32_swap_b32 v236, v238
    v_permlane32_swap_b32 v237, v239
    v_cvt_pk_bf16_f32 v240, v140, v141
    v_cvt_pk_bf16_f32 v241, v142, v143
    v_cvt_pk_bf16_f32 v242, v144, v145
    v_cvt_pk_bf16_f32 v243, v146, v147
    s_nop 1
    v_permlane32_swap_b32 v240, v242
    v_permlane32_swap_b32 v241, v243
    v_mfma_f32_32x32x16_bf16 v[132:147], v[160:163], a[128:131], 0
    ds_read_b128 a[28:31], v7 offset:0
    s_waitcnt lgkmcnt(10)
    v_mfma_f32_32x32x16_bf16 v[20:35], v[164:167], a[4:7], v[20:35]
    ds_read_b64_tr_b16 v[148:149], v12 offset:4096
    ds_read_b64_tr_b16 v[150:151], v12 offset:5120
    v_mfma_f32_32x32x16_bf16 v[84:99], v[164:167], a[132:135], v[84:99]
    ds_read_b64_tr_b16 v[152:153], v13 offset:4096
    ds_read_b64_tr_b16 v[154:155], v13 offset:5120
    s_waitcnt lgkmcnt(12)
    v_mfma_f32_32x32x16_bf16 v[36:51], v[168:171], a[4:7], v[36:51]
    ds_read_b64_tr_b16 v[156:157], v14 offset:4096
    ds_read_b64_tr_b16 v[158:159], v14 offset:5120
    v_mfma_f32_32x32x16_bf16 v[100:115], v[168:171], a[132:135], v[100:115]
    ds_read_b64_tr_b16 v[160:161], v15 offset:4096
    ds_read_b64_tr_b16 v[162:163], v15 offset:5120
    s_waitcnt lgkmcnt(11)
    v_mfma_f32_32x32x16_bf16 v[52:67], v[172:175], a[4:7], v[52:67]
    s_add_u32 s53, s57, 0x0
    buffer_store_dwordx4 v[180:183], v16, s[40:43], s53 offen
    ds_read_b128 a[144:147], v4 offset:4096
    v_mfma_f32_32x32x16_bf16 v[116:131], v[172:175], a[132:135], v[116:131]
    ds_read_b128 a[148:151], v5 offset:4096
    v_mfma_f32_32x32x16_bf16 v[68:83], v[176:179], a[4:7], v[68:83]
    ds_read_b128 a[152:155], v6 offset:4096
    v_mfma_f32_32x32x16_bf16 v[132:147], v[176:179], a[132:135], v[132:147]
    ds_read_b128 a[156:159], v7 offset:4096
    s_waitcnt lgkmcnt(11)
    s_waitcnt lgkmcnt(10)
    v_mfma_f32_32x32x16_bf16 v[20:35], v[148:151], a[8:11], v[20:35]
    ds_read_b64_tr_b16 v[164:165], v12 offset:6144
    ds_read_b64_tr_b16 v[166:167], v12 offset:7168
    ds_read_b64_tr_b16 v[168:169], v13 offset:6144
    ds_read_b64_tr_b16 v[170:171], v13 offset:7168
    v_mfma_f32_32x32x16_bf16 v[84:99], v[148:151], a[136:139], v[84:99]
    ds_read_b64_tr_b16 v[172:173], v14 offset:6144
    ds_read_b64_tr_b16 v[174:175], v14 offset:7168
    s_waitcnt lgkmcnt(11)
    v_mfma_f32_32x32x16_bf16 v[36:51], v[152:155], a[8:11], v[36:51]
    ds_read_b64_tr_b16 v[176:177], v15 offset:6144
    ds_read_b64_tr_b16 v[178:179], v15 offset:7168
    v_mfma_f32_32x32x16_bf16 v[100:115], v[152:155], a[136:139], v[100:115]
    s_add_u32 s53, s55, 0x180
    s_add_u32 m0, s56, 0x20000
    buffer_load_dwordx4 v2, s[24:27], s53 offen lds
    v_mfma_f32_32x32x16_bf16 v[52:67], v[156:159], a[8:11], v[52:67]
    s_add_u32 s53, s57, 0x400
    buffer_store_dwordx4 v[184:187], v16, s[40:43], s53 offen
    s_add_u32 s53, s55, 0x2180
    s_add_u32 m0, s56, 0x20400
    buffer_load_dwordx4 v3, s[24:27], s53 offen lds
    v_mfma_f32_32x32x16_bf16 v[116:131], v[156:159], a[136:139], v[116:131]
    s_add_u32 s53, s55, 0x4180
    s_add_u32 m0, s56, 0x20800
    buffer_load_dwordx4 v2, s[24:27], s53 offen lds
    s_waitcnt lgkmcnt(12)
    v_mfma_f32_32x32x16_bf16 v[68:83], v[160:163], a[8:11], v[68:83]
    s_add_u32 s53, s55, 0x6180
    s_add_u32 m0, s56, 0x20c00
    buffer_load_dwordx4 v3, s[24:27], s53 offen lds
    v_mfma_f32_32x32x16_bf16 v[132:147], v[160:163], a[136:139], v[132:147]
    s_add_u32 s53, s55, 0x8180
    s_add_u32 m0, s56, 0x21000
    buffer_load_dwordx4 v2, s[24:27], s53 offen lds
    s_waitcnt lgkmcnt(6)
    v_mfma_f32_32x32x16_bf16 v[20:35], v[164:167], a[12:15], v[20:35]
    ds_read_b64_tr_b16 v[148:149], v12 offset:16384
    ds_read_b64_tr_b16 v[150:151], v12 offset:17408
    ds_read_b64_tr_b16 v[152:153], v13 offset:16384
    ds_read_b64_tr_b16 v[154:155], v13 offset:17408
    v_mfma_f32_32x32x16_bf16 v[84:99], v[164:167], a[140:143], v[84:99]
    ds_read_b64_tr_b16 v[156:157], v14 offset:16384
    ds_read_b64_tr_b16 v[158:159], v14 offset:17408
    ds_read_b64_tr_b16 v[160:161], v15 offset:16384
    ds_read_b64_tr_b16 v[162:163], v15 offset:17408
    s_waitcnt lgkmcnt(12)
    v_mfma_f32_32x32x16_bf16 v[36:51], v[168:171], a[12:15], v[36:51]
    s_add_u32 s53, s55, 0xa180
    s_add_u32 m0, s56, 0x21400
    buffer_load_dwordx4 v3, s[24:27], s53 offen lds
    s_add_u32 s53, s55, 0xc180
    s_add_u32 m0, s56, 0x21800
    buffer_load_dwordx4 v2, s[24:27], s53 offen lds
    v_mfma_f32_32x32x16_bf16 v[100:115], v[168:171], a[140:143], v[100:115]
    s_add_u32 s53, s55, 0xe180
    s_add_u32 m0, s56, 0x21c00
    buffer_load_dwordx4 v3, s[24:27], s53 offen lds
    s_add_u32 s53, s52, 0x180000
    s_add_u32 m0, s54, 0xc000
    buffer_load_dwordx4 v1, s[32:35], s53 offen lds
    s_waitcnt lgkmcnt(10)
    v_mfma_f32_32x32x16_bf16 v[52:67], v[172:175], a[12:15], v[52:67]
    s_add_u32 s53, s57, 0x2000
    buffer_store_dwordx4 v[212:215], v16, s[40:43], s53 offen
    s_add_u32 s53, s52, 0x188000
    s_add_u32 m0, s54, 0xc400
    buffer_load_dwordx4 v1, s[32:35], s53 offen lds
    v_mfma_f32_32x32x16_bf16 v[116:131], v[172:175], a[140:143], v[116:131]
    s_add_u32 s53, s52, 0x190000
    s_add_u32 m0, s54, 0xc800
    buffer_load_dwordx4 v1, s[32:35], s53 offen lds
    s_waitcnt lgkmcnt(8)
    v_mfma_f32_32x32x16_bf16 v[68:83], v[176:179], a[12:15], v[68:83]
    s_add_u32 s53, s52, 0x198000
    s_add_u32 m0, s54, 0xcc00
    buffer_load_dwordx4 v1, s[32:35], s53 offen lds
    v_mfma_f32_32x32x16_bf16 v[132:147], v[176:179], a[140:143], v[132:147]
    s_waitcnt vmcnt(15)
    s_barrier
    s_waitcnt lgkmcnt(6)
    v_mfma_f32_32x32x16_bf16 v[20:35], v[148:151], a[16:19], v[20:35]
    ds_read_b64_tr_b16 v[164:165], v12 offset:18432
    ds_read_b64_tr_b16 v[166:167], v12 offset:19456
    v_mfma_f32_32x32x16_bf16 v[84:99], v[148:151], a[144:147], v[84:99]
    ds_read_b64_tr_b16 v[168:169], v13 offset:18432
    ds_read_b64_tr_b16 v[170:171], v13 offset:19456
    s_waitcnt lgkmcnt(8)
    v_mfma_f32_32x32x16_bf16 v[36:51], v[152:155], a[16:19], v[36:51]
    ds_read_b64_tr_b16 v[172:173], v14 offset:18432
    ds_read_b64_tr_b16 v[174:175], v14 offset:19456
    v_mfma_f32_32x32x16_bf16 v[100:115], v[152:155], a[144:147], v[100:115]
    ds_read_b64_tr_b16 v[176:177], v15 offset:18432
    ds_read_b64_tr_b16 v[178:179], v15 offset:19456
    s_waitcnt lgkmcnt(10)
    v_mfma_f32_32x32x16_bf16 v[52:67], v[156:159], a[16:19], v[52:67]
    s_add_u32 s53, s57, 0x2400
    buffer_store_dwordx4 v[216:219], v16, s[40:43], s53 offen
    ds_read_b128 a[32:35], v4 offset:32768
    v_mfma_f32_32x32x16_bf16 v[116:131], v[156:159], a[144:147], v[116:131]
    ds_read_b128 a[36:39], v5 offset:32768
    s_waitcnt lgkmcnt(10)
    v_mfma_f32_32x32x16_bf16 v[68:83], v[160:163], a[16:19], v[68:83]
    ds_read_b128 a[40:43], v6 offset:32768
    v_mfma_f32_32x32x16_bf16 v[132:147], v[160:163], a[144:147], v[132:147]
    ds_read_b128 a[44:47], v7 offset:32768
    s_waitcnt lgkmcnt(10)
    v_mfma_f32_32x32x16_bf16 v[20:35], v[164:167], a[20:23], v[20:35]
    ds_read_b64_tr_b16 v[148:149], v12 offset:20480
    ds_read_b64_tr_b16 v[150:151], v12 offset:21504
    v_mfma_f32_32x32x16_bf16 v[84:99], v[164:167], a[148:151], v[84:99]
    ds_read_b64_tr_b16 v[152:153], v13 offset:20480
    ds_read_b64_tr_b16 v[154:155], v13 offset:21504
    s_waitcnt lgkmcnt(12)
    v_mfma_f32_32x32x16_bf16 v[36:51], v[168:171], a[20:23], v[36:51]
    ds_read_b64_tr_b16 v[156:157], v14 offset:20480
    ds_read_b64_tr_b16 v[158:159], v14 offset:21504
    v_mfma_f32_32x32x16_bf16 v[100:115], v[168:171], a[148:151], v[100:115]
    ds_read_b64_tr_b16 v[160:161], v15 offset:20480
    ds_read_b64_tr_b16 v[162:163], v15 offset:21504
    s_waitcnt lgkmcnt(11)
    v_mfma_f32_32x32x16_bf16 v[52:67], v[172:175], a[20:23], v[52:67]
    s_add_u32 s53, s57, 0x800
    buffer_store_dwordx4 v[188:191], v16, s[40:43], s53 offen
    ds_read_b128 a[160:163], v4 offset:36864
    v_mfma_f32_32x32x16_bf16 v[116:131], v[172:175], a[148:151], v[116:131]
    ds_read_b128 a[164:167], v5 offset:36864
    v_mfma_f32_32x32x16_bf16 v[68:83], v[176:179], a[20:23], v[68:83]
    ds_read_b128 a[168:171], v6 offset:36864
    v_mfma_f32_32x32x16_bf16 v[132:147], v[176:179], a[148:151], v[132:147]
    ds_read_b128 a[172:175], v7 offset:36864
    s_waitcnt lgkmcnt(11)
    s_waitcnt lgkmcnt(10)
    v_mfma_f32_32x32x16_bf16 v[20:35], v[148:151], a[24:27], v[20:35]
    ds_read_b64_tr_b16 v[164:165], v12 offset:22528
    ds_read_b64_tr_b16 v[166:167], v12 offset:23552
    ds_read_b64_tr_b16 v[168:169], v13 offset:22528
    ds_read_b64_tr_b16 v[170:171], v13 offset:23552
    v_mfma_f32_32x32x16_bf16 v[84:99], v[148:151], a[152:155], v[84:99]
    ds_read_b64_tr_b16 v[172:173], v14 offset:22528
    ds_read_b64_tr_b16 v[174:175], v14 offset:23552
    s_waitcnt lgkmcnt(11)
    v_mfma_f32_32x32x16_bf16 v[36:51], v[152:155], a[24:27], v[36:51]
    ds_read_b64_tr_b16 v[176:177], v15 offset:22528
    ds_read_b64_tr_b16 v[178:179], v15 offset:23552
    v_mfma_f32_32x32x16_bf16 v[100:115], v[152:155], a[152:155], v[100:115]
    s_add_u32 s53, s55, 0x200
    s_add_u32 m0, s56, 0x10000
    buffer_load_dwordx4 v2, s[24:27], s53 offen lds
    v_mfma_f32_32x32x16_bf16 v[52:67], v[156:159], a[24:27], v[52:67]
    s_add_u32 s53, s57, 0xc00
    buffer_store_dwordx4 v[192:195], v16, s[40:43], s53 offen
    s_add_u32 s53, s55, 0x2200
    s_add_u32 m0, s56, 0x10400
    buffer_load_dwordx4 v3, s[24:27], s53 offen lds
    v_mfma_f32_32x32x16_bf16 v[116:131], v[156:159], a[152:155], v[116:131]
    s_add_u32 s53, s55, 0x4200
    s_add_u32 m0, s56, 0x10800
    buffer_load_dwordx4 v2, s[24:27], s53 offen lds
    s_waitcnt lgkmcnt(12)
    v_mfma_f32_32x32x16_bf16 v[68:83], v[160:163], a[24:27], v[68:83]
    s_add_u32 s53, s55, 0x6200
    s_add_u32 m0, s56, 0x10c00
    buffer_load_dwordx4 v3, s[24:27], s53 offen lds
    v_mfma_f32_32x32x16_bf16 v[132:147], v[160:163], a[152:155], v[132:147]
    s_add_u32 s53, s55, 0x8200
    s_add_u32 m0, s56, 0x11000
    buffer_load_dwordx4 v2, s[24:27], s53 offen lds
    s_waitcnt lgkmcnt(6)
    v_mfma_f32_32x32x16_bf16 v[20:35], v[164:167], a[28:31], v[20:35]
    ds_read_b64_tr_b16 v[148:149], v12 offset:32768
    ds_read_b64_tr_b16 v[150:151], v12 offset:33792
    ds_read_b64_tr_b16 v[152:153], v13 offset:32768
    ds_read_b64_tr_b16 v[154:155], v13 offset:33792
    v_mfma_f32_32x32x16_bf16 v[84:99], v[164:167], a[156:159], v[84:99]
    ds_read_b64_tr_b16 v[156:157], v14 offset:32768
    ds_read_b64_tr_b16 v[158:159], v14 offset:33792
    ds_read_b64_tr_b16 v[160:161], v15 offset:32768
    ds_read_b64_tr_b16 v[162:163], v15 offset:33792
    s_waitcnt lgkmcnt(12)
    v_mfma_f32_32x32x16_bf16 v[36:51], v[168:171], a[28:31], v[36:51]
    s_add_u32 s53, s55, 0xa200
    s_add_u32 m0, s56, 0x11400
    buffer_load_dwordx4 v3, s[24:27], s53 offen lds
    s_add_u32 s53, s55, 0xc200
    s_add_u32 m0, s56, 0x11800
    buffer_load_dwordx4 v2, s[24:27], s53 offen lds
    v_mfma_f32_32x32x16_bf16 v[100:115], v[168:171], a[156:159], v[100:115]
    s_add_u32 s53, s55, 0xe200
    s_add_u32 m0, s56, 0x11c00
    buffer_load_dwordx4 v3, s[24:27], s53 offen lds
    s_add_u32 s53, s52, 0x200000
    s_add_u32 m0, s54, 0x0
    buffer_load_dwordx4 v1, s[32:35], s53 offen lds
    s_waitcnt lgkmcnt(10)
    v_mfma_f32_32x32x16_bf16 v[52:67], v[172:175], a[28:31], v[52:67]
    s_add_u32 s53, s57, 0x2800
    buffer_store_dwordx4 v[220:223], v16, s[40:43], s53 offen
    s_add_u32 s53, s52, 0x208000
    s_add_u32 m0, s54, 0x400
    buffer_load_dwordx4 v1, s[32:35], s53 offen lds
    v_mfma_f32_32x32x16_bf16 v[116:131], v[172:175], a[156:159], v[116:131]
    s_add_u32 s53, s52, 0x210000
    s_add_u32 m0, s54, 0x800
    buffer_load_dwordx4 v1, s[32:35], s53 offen lds
    s_waitcnt lgkmcnt(8)
    v_mfma_f32_32x32x16_bf16 v[68:83], v[176:179], a[28:31], v[68:83]
    s_add_u32 s53, s52, 0x218000
    s_add_u32 m0, s54, 0xc00
    buffer_load_dwordx4 v1, s[32:35], s53 offen lds
    v_mfma_f32_32x32x16_bf16 v[132:147], v[176:179], a[156:159], v[132:147]
    s_waitcnt vmcnt(16)
    s_barrier
    s_waitcnt lgkmcnt(6)
    v_mfma_f32_32x32x16_bf16 v[20:35], v[148:151], a[32:35], v[20:35]
    ds_read_b64_tr_b16 v[164:165], v12 offset:34816
    ds_read_b64_tr_b16 v[166:167], v12 offset:35840
    v_mfma_f32_32x32x16_bf16 v[84:99], v[148:151], a[160:163], v[84:99]
    ds_read_b64_tr_b16 v[168:169], v13 offset:34816
    ds_read_b64_tr_b16 v[170:171], v13 offset:35840
    s_waitcnt lgkmcnt(8)
    v_mfma_f32_32x32x16_bf16 v[36:51], v[152:155], a[32:35], v[36:51]
    ds_read_b64_tr_b16 v[172:173], v14 offset:34816
    ds_read_b64_tr_b16 v[174:175], v14 offset:35840
    v_mfma_f32_32x32x16_bf16 v[100:115], v[152:155], a[160:163], v[100:115]
    ds_read_b64_tr_b16 v[176:177], v15 offset:34816
    ds_read_b64_tr_b16 v[178:179], v15 offset:35840
    s_waitcnt lgkmcnt(10)
    v_mfma_f32_32x32x16_bf16 v[52:67], v[156:159], a[32:35], v[52:67]
    s_add_u32 s53, s57, 0x2c00
    buffer_store_dwordx4 v[224:227], v16, s[40:43], s53 offen
    ds_read_b128 a[48:51], v8 offset:0
    v_mfma_f32_32x32x16_bf16 v[116:131], v[156:159], a[160:163], v[116:131]
    ds_read_b128 a[52:55], v9 offset:0
    s_waitcnt lgkmcnt(10)
    v_mfma_f32_32x32x16_bf16 v[68:83], v[160:163], a[32:35], v[68:83]
    ds_read_b128 a[56:59], v10 offset:0
    v_mfma_f32_32x32x16_bf16 v[132:147], v[160:163], a[160:163], v[132:147]
    ds_read_b128 a[60:63], v11 offset:0
    s_waitcnt lgkmcnt(10)
    v_mfma_f32_32x32x16_bf16 v[20:35], v[164:167], a[36:39], v[20:35]
    ds_read_b64_tr_b16 v[148:149], v12 offset:36864
    ds_read_b64_tr_b16 v[150:151], v12 offset:37888
    v_mfma_f32_32x32x16_bf16 v[84:99], v[164:167], a[164:167], v[84:99]
    ds_read_b64_tr_b16 v[152:153], v13 offset:36864
    ds_read_b64_tr_b16 v[154:155], v13 offset:37888
    s_waitcnt lgkmcnt(12)
    v_mfma_f32_32x32x16_bf16 v[36:51], v[168:171], a[36:39], v[36:51]
    ds_read_b64_tr_b16 v[156:157], v14 offset:36864
    ds_read_b64_tr_b16 v[158:159], v14 offset:37888
    v_mfma_f32_32x32x16_bf16 v[100:115], v[168:171], a[164:167], v[100:115]
    ds_read_b64_tr_b16 v[160:161], v15 offset:36864
    ds_read_b64_tr_b16 v[162:163], v15 offset:37888
    s_waitcnt lgkmcnt(11)
    v_mfma_f32_32x32x16_bf16 v[52:67], v[172:175], a[36:39], v[52:67]
    s_add_u32 s53, s57, 0x1000
    buffer_store_dwordx4 v[196:199], v16, s[40:43], s53 offen
    ds_read_b128 a[176:179], v8 offset:4096
    v_mfma_f32_32x32x16_bf16 v[116:131], v[172:175], a[164:167], v[116:131]
    ds_read_b128 a[180:183], v9 offset:4096
    v_mfma_f32_32x32x16_bf16 v[68:83], v[176:179], a[36:39], v[68:83]
    ds_read_b128 a[184:187], v10 offset:4096
    v_mfma_f32_32x32x16_bf16 v[132:147], v[176:179], a[164:167], v[132:147]
    ds_read_b128 a[188:191], v11 offset:4096
    s_waitcnt lgkmcnt(11)
    s_waitcnt lgkmcnt(10)
    v_mfma_f32_32x32x16_bf16 v[20:35], v[148:151], a[40:43], v[20:35]
    ds_read_b64_tr_b16 v[164:165], v12 offset:38912
    ds_read_b64_tr_b16 v[166:167], v12 offset:39936
    ds_read_b64_tr_b16 v[168:169], v13 offset:38912
    ds_read_b64_tr_b16 v[170:171], v13 offset:39936
    v_mfma_f32_32x32x16_bf16 v[84:99], v[148:151], a[168:171], v[84:99]
    ds_read_b64_tr_b16 v[172:173], v14 offset:38912
    ds_read_b64_tr_b16 v[174:175], v14 offset:39936
    s_waitcnt lgkmcnt(11)
    v_mfma_f32_32x32x16_bf16 v[36:51], v[152:155], a[40:43], v[36:51]
    ds_read_b64_tr_b16 v[176:177], v15 offset:38912
    ds_read_b64_tr_b16 v[178:179], v15 offset:39936
    v_mfma_f32_32x32x16_bf16 v[100:115], v[152:155], a[168:171], v[100:115]
    s_add_u32 s53, s55, 0x280
    s_add_u32 m0, s56, 0x18000
    buffer_load_dwordx4 v2, s[24:27], s53 offen lds
    v_mfma_f32_32x32x16_bf16 v[52:67], v[156:159], a[40:43], v[52:67]
    s_add_u32 s53, s57, 0x1400
    buffer_store_dwordx4 v[200:203], v16, s[40:43], s53 offen
    s_add_u32 s53, s55, 0x2280
    s_add_u32 m0, s56, 0x18400
    buffer_load_dwordx4 v3, s[24:27], s53 offen lds
    v_mfma_f32_32x32x16_bf16 v[116:131], v[156:159], a[168:171], v[116:131]
    s_add_u32 s53, s55, 0x4280
    s_add_u32 m0, s56, 0x18800
    buffer_load_dwordx4 v2, s[24:27], s53 offen lds
    s_waitcnt lgkmcnt(12)
    v_mfma_f32_32x32x16_bf16 v[68:83], v[160:163], a[40:43], v[68:83]
    s_add_u32 s53, s55, 0x6280
    s_add_u32 m0, s56, 0x18c00
    buffer_load_dwordx4 v3, s[24:27], s53 offen lds
    v_mfma_f32_32x32x16_bf16 v[132:147], v[160:163], a[168:171], v[132:147]
    s_add_u32 s53, s55, 0x8280
    s_add_u32 m0, s56, 0x19000
    buffer_load_dwordx4 v2, s[24:27], s53 offen lds
    s_waitcnt lgkmcnt(6)
    v_mfma_f32_32x32x16_bf16 v[20:35], v[164:167], a[44:47], v[20:35]
    ds_read_b64_tr_b16 v[148:149], v12 offset:49152
    ds_read_b64_tr_b16 v[150:151], v12 offset:50176
    ds_read_b64_tr_b16 v[152:153], v13 offset:49152
    ds_read_b64_tr_b16 v[154:155], v13 offset:50176
    v_mfma_f32_32x32x16_bf16 v[84:99], v[164:167], a[172:175], v[84:99]
    ds_read_b64_tr_b16 v[156:157], v14 offset:49152
    ds_read_b64_tr_b16 v[158:159], v14 offset:50176
    ds_read_b64_tr_b16 v[160:161], v15 offset:49152
    ds_read_b64_tr_b16 v[162:163], v15 offset:50176
    s_waitcnt lgkmcnt(12)
    v_mfma_f32_32x32x16_bf16 v[36:51], v[168:171], a[44:47], v[36:51]
    s_add_u32 s53, s55, 0xa280
    s_add_u32 m0, s56, 0x19400
    buffer_load_dwordx4 v3, s[24:27], s53 offen lds
    s_add_u32 s53, s55, 0xc280
    s_add_u32 m0, s56, 0x19800
    buffer_load_dwordx4 v2, s[24:27], s53 offen lds
    v_mfma_f32_32x32x16_bf16 v[100:115], v[168:171], a[172:175], v[100:115]
    s_add_u32 s53, s55, 0xe280
    s_add_u32 m0, s56, 0x19c00
    buffer_load_dwordx4 v3, s[24:27], s53 offen lds
    s_add_u32 s53, s52, 0x280000
    s_add_u32 m0, s54, 0x4000
    buffer_load_dwordx4 v1, s[32:35], s53 offen lds
    s_waitcnt lgkmcnt(10)
    v_mfma_f32_32x32x16_bf16 v[52:67], v[172:175], a[44:47], v[52:67]
    s_add_u32 s53, s57, 0x3000
    buffer_store_dwordx4 v[228:231], v16, s[40:43], s53 offen
    s_add_u32 s53, s52, 0x288000
    s_add_u32 m0, s54, 0x4400
    buffer_load_dwordx4 v1, s[32:35], s53 offen lds
    v_mfma_f32_32x32x16_bf16 v[116:131], v[172:175], a[172:175], v[116:131]
    s_add_u32 s53, s52, 0x290000
    s_add_u32 m0, s54, 0x4800
    buffer_load_dwordx4 v1, s[32:35], s53 offen lds
    s_waitcnt lgkmcnt(8)
    v_mfma_f32_32x32x16_bf16 v[68:83], v[176:179], a[44:47], v[68:83]
    s_add_u32 s53, s52, 0x298000
    s_add_u32 m0, s54, 0x4c00
    buffer_load_dwordx4 v1, s[32:35], s53 offen lds
    v_mfma_f32_32x32x16_bf16 v[132:147], v[176:179], a[172:175], v[132:147]
    s_waitcnt vmcnt(16)
    s_barrier
    s_waitcnt lgkmcnt(6)
    v_mfma_f32_32x32x16_bf16 v[20:35], v[148:151], a[48:51], v[20:35]
    ds_read_b64_tr_b16 v[164:165], v12 offset:51200
    ds_read_b64_tr_b16 v[166:167], v12 offset:52224
    v_mfma_f32_32x32x16_bf16 v[84:99], v[148:151], a[176:179], v[84:99]
    ds_read_b64_tr_b16 v[168:169], v13 offset:51200
    ds_read_b64_tr_b16 v[170:171], v13 offset:52224
    s_waitcnt lgkmcnt(8)
    v_mfma_f32_32x32x16_bf16 v[36:51], v[152:155], a[48:51], v[36:51]
    ds_read_b64_tr_b16 v[172:173], v14 offset:51200
    ds_read_b64_tr_b16 v[174:175], v14 offset:52224
    v_mfma_f32_32x32x16_bf16 v[100:115], v[152:155], a[176:179], v[100:115]
    ds_read_b64_tr_b16 v[176:177], v15 offset:51200
    ds_read_b64_tr_b16 v[178:179], v15 offset:52224
    s_waitcnt lgkmcnt(10)
    v_mfma_f32_32x32x16_bf16 v[52:67], v[156:159], a[48:51], v[52:67]
    s_add_u32 s53, s57, 0x3400
    buffer_store_dwordx4 v[232:235], v16, s[40:43], s53 offen
    ds_read_b128 a[64:67], v4 offset:0
    v_mfma_f32_32x32x16_bf16 v[116:131], v[156:159], a[176:179], v[116:131]
    ds_read_b128 a[68:71], v5 offset:0
    s_waitcnt lgkmcnt(10)
    v_mfma_f32_32x32x16_bf16 v[68:83], v[160:163], a[48:51], v[68:83]
    ds_read_b128 a[72:75], v6 offset:0
    v_mfma_f32_32x32x16_bf16 v[132:147], v[160:163], a[176:179], v[132:147]
    ds_read_b128 a[76:79], v7 offset:0
    s_waitcnt lgkmcnt(10)
    v_mfma_f32_32x32x16_bf16 v[20:35], v[164:167], a[52:55], v[20:35]
    ds_read_b64_tr_b16 v[148:149], v12 offset:53248
    ds_read_b64_tr_b16 v[150:151], v12 offset:54272
    v_mfma_f32_32x32x16_bf16 v[84:99], v[164:167], a[180:183], v[84:99]
    ds_read_b64_tr_b16 v[152:153], v13 offset:53248
    ds_read_b64_tr_b16 v[154:155], v13 offset:54272
    s_waitcnt lgkmcnt(12)
    v_mfma_f32_32x32x16_bf16 v[36:51], v[168:171], a[52:55], v[36:51]
    ds_read_b64_tr_b16 v[156:157], v14 offset:53248
    ds_read_b64_tr_b16 v[158:159], v14 offset:54272
    v_mfma_f32_32x32x16_bf16 v[100:115], v[168:171], a[180:183], v[100:115]
    ds_read_b64_tr_b16 v[160:161], v15 offset:53248
    ds_read_b64_tr_b16 v[162:163], v15 offset:54272
    s_waitcnt lgkmcnt(11)
    v_mfma_f32_32x32x16_bf16 v[52:67], v[172:175], a[52:55], v[52:67]
    s_add_u32 s53, s57, 0x1800
    buffer_store_dwordx4 v[204:207], v16, s[40:43], s53 offen
    ds_read_b128 a[192:195], v4 offset:4096
    v_mfma_f32_32x32x16_bf16 v[116:131], v[172:175], a[180:183], v[116:131]
    ds_read_b128 a[196:199], v5 offset:4096
    v_mfma_f32_32x32x16_bf16 v[68:83], v[176:179], a[52:55], v[68:83]
    ds_read_b128 a[200:203], v6 offset:4096
    v_mfma_f32_32x32x16_bf16 v[132:147], v[176:179], a[180:183], v[132:147]
    ds_read_b128 a[204:207], v7 offset:4096
    s_waitcnt lgkmcnt(11)
    s_waitcnt lgkmcnt(10)
    v_mfma_f32_32x32x16_bf16 v[20:35], v[148:151], a[56:59], v[20:35]
    ds_read_b64_tr_b16 v[164:165], v12 offset:55296
    ds_read_b64_tr_b16 v[166:167], v12 offset:56320
    ds_read_b64_tr_b16 v[168:169], v13 offset:55296
    ds_read_b64_tr_b16 v[170:171], v13 offset:56320
    v_mfma_f32_32x32x16_bf16 v[84:99], v[148:151], a[184:187], v[84:99]
    ds_read_b64_tr_b16 v[172:173], v14 offset:55296
    ds_read_b64_tr_b16 v[174:175], v14 offset:56320
    s_waitcnt lgkmcnt(11)
    v_mfma_f32_32x32x16_bf16 v[36:51], v[152:155], a[56:59], v[36:51]
    ds_read_b64_tr_b16 v[176:177], v15 offset:55296
    ds_read_b64_tr_b16 v[178:179], v15 offset:56320
    v_mfma_f32_32x32x16_bf16 v[100:115], v[152:155], a[184:187], v[100:115]
    s_add_u32 s53, s55, 0x300
    s_add_u32 m0, s56, 0x20000
    buffer_load_dwordx4 v2, s[24:27], s53 offen lds
    v_mfma_f32_32x32x16_bf16 v[52:67], v[156:159], a[56:59], v[52:67]
    s_add_u32 s53, s57, 0x1c00
    buffer_store_dwordx4 v[208:211], v16, s[40:43], s53 offen
    s_add_u32 s53, s55, 0x2300
    s_add_u32 m0, s56, 0x20400
    buffer_load_dwordx4 v3, s[24:27], s53 offen lds
    v_mfma_f32_32x32x16_bf16 v[116:131], v[156:159], a[184:187], v[116:131]
    s_add_u32 s53, s55, 0x4300
    s_add_u32 m0, s56, 0x20800
    buffer_load_dwordx4 v2, s[24:27], s53 offen lds
    s_waitcnt lgkmcnt(12)
    v_mfma_f32_32x32x16_bf16 v[68:83], v[160:163], a[56:59], v[68:83]
    s_add_u32 s53, s55, 0x6300
    s_add_u32 m0, s56, 0x20c00
    buffer_load_dwordx4 v3, s[24:27], s53 offen lds
    v_mfma_f32_32x32x16_bf16 v[132:147], v[160:163], a[184:187], v[132:147]
    s_add_u32 s53, s55, 0x8300
    s_add_u32 m0, s56, 0x21000
    buffer_load_dwordx4 v2, s[24:27], s53 offen lds
    s_waitcnt lgkmcnt(6)
    v_mfma_f32_32x32x16_bf16 v[20:35], v[164:167], a[60:63], v[20:35]
    ds_read_b64_tr_b16 v[148:149], v12 offset:0
    ds_read_b64_tr_b16 v[150:151], v12 offset:1024
    ds_read_b64_tr_b16 v[152:153], v13 offset:0
    ds_read_b64_tr_b16 v[154:155], v13 offset:1024
    v_mfma_f32_32x32x16_bf16 v[84:99], v[164:167], a[188:191], v[84:99]
    ds_read_b64_tr_b16 v[156:157], v14 offset:0
    ds_read_b64_tr_b16 v[158:159], v14 offset:1024
    ds_read_b64_tr_b16 v[160:161], v15 offset:0
    ds_read_b64_tr_b16 v[162:163], v15 offset:1024
    s_waitcnt lgkmcnt(12)
    v_mfma_f32_32x32x16_bf16 v[36:51], v[168:171], a[60:63], v[36:51]
    s_add_u32 s53, s55, 0xa300
    s_add_u32 m0, s56, 0x21400
    buffer_load_dwordx4 v3, s[24:27], s53 offen lds
    s_add_u32 s53, s55, 0xc300
    s_add_u32 m0, s56, 0x21800
    buffer_load_dwordx4 v2, s[24:27], s53 offen lds
    v_mfma_f32_32x32x16_bf16 v[100:115], v[168:171], a[188:191], v[100:115]
    s_add_u32 s53, s55, 0xe300
    s_add_u32 m0, s56, 0x21c00
    buffer_load_dwordx4 v3, s[24:27], s53 offen lds
    s_add_u32 s53, s52, 0x300000
    s_add_u32 m0, s54, 0x8000
    buffer_load_dwordx4 v1, s[32:35], s53 offen lds
    s_waitcnt lgkmcnt(10)
    v_mfma_f32_32x32x16_bf16 v[52:67], v[172:175], a[60:63], v[52:67]
    s_add_u32 s53, s57, 0x3800
    buffer_store_dwordx4 v[236:239], v16, s[40:43], s53 offen
    s_add_u32 s53, s52, 0x308000
    s_add_u32 m0, s54, 0x8400
    buffer_load_dwordx4 v1, s[32:35], s53 offen lds
    v_mfma_f32_32x32x16_bf16 v[116:131], v[172:175], a[188:191], v[116:131]
    s_add_u32 s53, s52, 0x310000
    s_add_u32 m0, s54, 0x8800
    buffer_load_dwordx4 v1, s[32:35], s53 offen lds
    s_waitcnt lgkmcnt(8)
    v_mfma_f32_32x32x16_bf16 v[68:83], v[176:179], a[60:63], v[68:83]
    s_add_u32 s53, s52, 0x318000
    s_add_u32 m0, s54, 0x8c00
    buffer_load_dwordx4 v1, s[32:35], s53 offen lds
    v_mfma_f32_32x32x16_bf16 v[132:147], v[176:179], a[188:191], v[132:147]
    s_waitcnt vmcnt(16)
    s_barrier
    s_waitcnt lgkmcnt(6)
    v_mfma_f32_32x32x16_bf16 v[20:35], v[148:151], a[64:67], v[20:35]
    ds_read_b64_tr_b16 v[164:165], v12 offset:2048
    ds_read_b64_tr_b16 v[166:167], v12 offset:3072
    v_mfma_f32_32x32x16_bf16 v[84:99], v[148:151], a[192:195], v[84:99]
    ds_read_b64_tr_b16 v[168:169], v13 offset:2048
    ds_read_b64_tr_b16 v[170:171], v13 offset:3072
    s_waitcnt lgkmcnt(8)
    v_mfma_f32_32x32x16_bf16 v[36:51], v[152:155], a[64:67], v[36:51]
    ds_read_b64_tr_b16 v[172:173], v14 offset:2048
    ds_read_b64_tr_b16 v[174:175], v14 offset:3072
    v_mfma_f32_32x32x16_bf16 v[100:115], v[152:155], a[192:195], v[100:115]
    ds_read_b64_tr_b16 v[176:177], v15 offset:2048
    ds_read_b64_tr_b16 v[178:179], v15 offset:3072
    s_waitcnt lgkmcnt(10)
    v_mfma_f32_32x32x16_bf16 v[52:67], v[156:159], a[64:67], v[52:67]
    s_add_u32 s53, s57, 0x3c00
    buffer_store_dwordx4 v[240:243], v16, s[40:43], s53 offen
    ds_read_b128 a[80:83], v4 offset:32768
    v_mfma_f32_32x32x16_bf16 v[116:131], v[156:159], a[192:195], v[116:131]
    ds_read_b128 a[84:87], v5 offset:32768
    s_waitcnt lgkmcnt(10)
    v_mfma_f32_32x32x16_bf16 v[68:83], v[160:163], a[64:67], v[68:83]
    ds_read_b128 a[88:91], v6 offset:32768
    v_mfma_f32_32x32x16_bf16 v[132:147], v[160:163], a[192:195], v[132:147]
    ds_read_b128 a[92:95], v7 offset:32768
    s_waitcnt lgkmcnt(10)
    v_mfma_f32_32x32x16_bf16 v[20:35], v[164:167], a[68:71], v[20:35]
    ds_read_b64_tr_b16 v[148:149], v12 offset:4096
    ds_read_b64_tr_b16 v[150:151], v12 offset:5120
    v_mfma_f32_32x32x16_bf16 v[84:99], v[164:167], a[196:199], v[84:99]
    ds_read_b64_tr_b16 v[152:153], v13 offset:4096
    ds_read_b64_tr_b16 v[154:155], v13 offset:5120
    s_waitcnt lgkmcnt(12)
    v_mfma_f32_32x32x16_bf16 v[36:51], v[168:171], a[68:71], v[36:51]
    ds_read_b64_tr_b16 v[156:157], v14 offset:4096
    ds_read_b64_tr_b16 v[158:159], v14 offset:5120
    v_mfma_f32_32x32x16_bf16 v[100:115], v[168:171], a[196:199], v[100:115]
    ds_read_b64_tr_b16 v[160:161], v15 offset:4096
    ds_read_b64_tr_b16 v[162:163], v15 offset:5120
    s_waitcnt lgkmcnt(11)
    v_mfma_f32_32x32x16_bf16 v[52:67], v[172:175], a[68:71], v[52:67]
    ds_read_b128 a[208:211], v4 offset:36864
    v_mfma_f32_32x32x16_bf16 v[116:131], v[172:175], a[196:199], v[116:131]
    ds_read_b128 a[212:215], v5 offset:36864
    v_mfma_f32_32x32x16_bf16 v[68:83], v[176:179], a[68:71], v[68:83]
    ds_read_b128 a[216:219], v6 offset:36864
    v_mfma_f32_32x32x16_bf16 v[132:147], v[176:179], a[196:199], v[132:147]
    ds_read_b128 a[220:223], v7 offset:36864
    s_waitcnt lgkmcnt(11)
    s_waitcnt lgkmcnt(10)
    v_mfma_f32_32x32x16_bf16 v[20:35], v[148:151], a[72:75], v[20:35]
    ds_read_b64_tr_b16 v[164:165], v12 offset:6144
    ds_read_b64_tr_b16 v[166:167], v12 offset:7168
    ds_read_b64_tr_b16 v[168:169], v13 offset:6144
    ds_read_b64_tr_b16 v[170:171], v13 offset:7168
    v_mfma_f32_32x32x16_bf16 v[84:99], v[148:151], a[200:203], v[84:99]
    ds_read_b64_tr_b16 v[172:173], v14 offset:6144
    ds_read_b64_tr_b16 v[174:175], v14 offset:7168
    s_waitcnt lgkmcnt(11)
    v_mfma_f32_32x32x16_bf16 v[36:51], v[152:155], a[72:75], v[36:51]
    ds_read_b64_tr_b16 v[176:177], v15 offset:6144
    ds_read_b64_tr_b16 v[178:179], v15 offset:7168
    v_mfma_f32_32x32x16_bf16 v[100:115], v[152:155], a[200:203], v[100:115]
    s_add_u32 s53, s55, 0x380
    s_add_u32 m0, s56, 0x10000
    buffer_load_dwordx4 v2, s[24:27], s53 offen lds
    v_mfma_f32_32x32x16_bf16 v[52:67], v[156:159], a[72:75], v[52:67]
    s_add_u32 s53, s55, 0x2380
    s_add_u32 m0, s56, 0x10400
    buffer_load_dwordx4 v3, s[24:27], s53 offen lds
    v_mfma_f32_32x32x16_bf16 v[116:131], v[156:159], a[200:203], v[116:131]
    s_add_u32 s53, s55, 0x4380
    s_add_u32 m0, s56, 0x10800
    buffer_load_dwordx4 v2, s[24:27], s53 offen lds
    s_waitcnt lgkmcnt(12)
    v_mfma_f32_32x32x16_bf16 v[68:83], v[160:163], a[72:75], v[68:83]
    s_add_u32 s53, s55, 0x6380
    s_add_u32 m0, s56, 0x10c00
    buffer_load_dwordx4 v3, s[24:27], s53 offen lds
    v_mfma_f32_32x32x16_bf16 v[132:147], v[160:163], a[200:203], v[132:147]
    s_add_u32 s53, s55, 0x8380
    s_add_u32 m0, s56, 0x11000
    buffer_load_dwordx4 v2, s[24:27], s53 offen lds
    s_waitcnt lgkmcnt(6)
    v_mfma_f32_32x32x16_bf16 v[20:35], v[164:167], a[76:79], v[20:35]
    ds_read_b64_tr_b16 v[148:149], v12 offset:16384
    ds_read_b64_tr_b16 v[150:151], v12 offset:17408
    ds_read_b64_tr_b16 v[152:153], v13 offset:16384
    ds_read_b64_tr_b16 v[154:155], v13 offset:17408
    v_mfma_f32_32x32x16_bf16 v[84:99], v[164:167], a[204:207], v[84:99]
    ds_read_b64_tr_b16 v[156:157], v14 offset:16384
    ds_read_b64_tr_b16 v[158:159], v14 offset:17408
    ds_read_b64_tr_b16 v[160:161], v15 offset:16384
    ds_read_b64_tr_b16 v[162:163], v15 offset:17408
    s_waitcnt lgkmcnt(12)
    v_mfma_f32_32x32x16_bf16 v[36:51], v[168:171], a[76:79], v[36:51]
    s_add_u32 s53, s55, 0xa380
    s_add_u32 m0, s56, 0x11400
    buffer_load_dwordx4 v3, s[24:27], s53 offen lds
    s_add_u32 s53, s55, 0xc380
    s_add_u32 m0, s56, 0x11800
    buffer_load_dwordx4 v2, s[24:27], s53 offen lds
    v_mfma_f32_32x32x16_bf16 v[100:115], v[168:171], a[204:207], v[100:115]
    s_add_u32 s53, s55, 0xe380
    s_add_u32 m0, s56, 0x11c00
    buffer_load_dwordx4 v3, s[24:27], s53 offen lds
    s_add_u32 s53, s52, 0x380000
    s_add_u32 m0, s54, 0xc000
    buffer_load_dwordx4 v1, s[32:35], s53 offen lds
    s_waitcnt lgkmcnt(10)
    v_mfma_f32_32x32x16_bf16 v[52:67], v[172:175], a[76:79], v[52:67]
    s_add_u32 s53, s52, 0x388000
    s_add_u32 m0, s54, 0xc400
    buffer_load_dwordx4 v1, s[32:35], s53 offen lds
    v_mfma_f32_32x32x16_bf16 v[116:131], v[172:175], a[204:207], v[116:131]
    s_add_u32 s53, s52, 0x390000
    s_add_u32 m0, s54, 0xc800
    buffer_load_dwordx4 v1, s[32:35], s53 offen lds
    s_waitcnt lgkmcnt(8)
    v_mfma_f32_32x32x16_bf16 v[68:83], v[176:179], a[76:79], v[68:83]
    s_add_u32 s53, s52, 0x398000
    s_add_u32 m0, s54, 0xcc00
    buffer_load_dwordx4 v1, s[32:35], s53 offen lds
    v_mfma_f32_32x32x16_bf16 v[132:147], v[176:179], a[204:207], v[132:147]
    s_waitcnt vmcnt(13)
    s_barrier
    s_waitcnt lgkmcnt(6)
    v_mfma_f32_32x32x16_bf16 v[20:35], v[148:151], a[80:83], v[20:35]
    ds_read_b64_tr_b16 v[164:165], v12 offset:18432
    ds_read_b64_tr_b16 v[166:167], v12 offset:19456
    v_mfma_f32_32x32x16_bf16 v[84:99], v[148:151], a[208:211], v[84:99]
    ds_read_b64_tr_b16 v[168:169], v13 offset:18432
    ds_read_b64_tr_b16 v[170:171], v13 offset:19456
    s_waitcnt lgkmcnt(8)
    v_mfma_f32_32x32x16_bf16 v[36:51], v[152:155], a[80:83], v[36:51]
    ds_read_b64_tr_b16 v[172:173], v14 offset:18432
    ds_read_b64_tr_b16 v[174:175], v14 offset:19456
    v_mfma_f32_32x32x16_bf16 v[100:115], v[152:155], a[208:211], v[100:115]
    ds_read_b64_tr_b16 v[176:177], v15 offset:18432
    ds_read_b64_tr_b16 v[178:179], v15 offset:19456
    s_waitcnt lgkmcnt(10)
    v_mfma_f32_32x32x16_bf16 v[52:67], v[156:159], a[80:83], v[52:67]
    ds_read_b128 a[96:99], v8 offset:0
    v_mfma_f32_32x32x16_bf16 v[116:131], v[156:159], a[208:211], v[116:131]
    ds_read_b128 a[100:103], v9 offset:0
    s_waitcnt lgkmcnt(10)
    v_mfma_f32_32x32x16_bf16 v[68:83], v[160:163], a[80:83], v[68:83]
    ds_read_b128 a[104:107], v10 offset:0
    v_mfma_f32_32x32x16_bf16 v[132:147], v[160:163], a[208:211], v[132:147]
    ds_read_b128 a[108:111], v11 offset:0
    s_waitcnt lgkmcnt(10)
    v_mfma_f32_32x32x16_bf16 v[20:35], v[164:167], a[84:87], v[20:35]
    ds_read_b64_tr_b16 v[148:149], v12 offset:20480
    ds_read_b64_tr_b16 v[150:151], v12 offset:21504
    v_mfma_f32_32x32x16_bf16 v[84:99], v[164:167], a[212:215], v[84:99]
    ds_read_b64_tr_b16 v[152:153], v13 offset:20480
    ds_read_b64_tr_b16 v[154:155], v13 offset:21504
    s_waitcnt lgkmcnt(12)
    v_mfma_f32_32x32x16_bf16 v[36:51], v[168:171], a[84:87], v[36:51]
    ds_read_b64_tr_b16 v[156:157], v14 offset:20480
    ds_read_b64_tr_b16 v[158:159], v14 offset:21504
    v_mfma_f32_32x32x16_bf16 v[100:115], v[168:171], a[212:215], v[100:115]
    ds_read_b64_tr_b16 v[160:161], v15 offset:20480
    ds_read_b64_tr_b16 v[162:163], v15 offset:21504
    s_waitcnt lgkmcnt(11)
    v_mfma_f32_32x32x16_bf16 v[52:67], v[172:175], a[84:87], v[52:67]
    ds_read_b128 a[224:227], v8 offset:4096
    v_mfma_f32_32x32x16_bf16 v[116:131], v[172:175], a[212:215], v[116:131]
    ds_read_b128 a[228:231], v9 offset:4096
    v_mfma_f32_32x32x16_bf16 v[68:83], v[176:179], a[84:87], v[68:83]
    ds_read_b128 a[232:235], v10 offset:4096
    v_mfma_f32_32x32x16_bf16 v[132:147], v[176:179], a[212:215], v[132:147]
    ds_read_b128 a[236:239], v11 offset:4096
    s_waitcnt lgkmcnt(11)
    s_waitcnt lgkmcnt(10)
    v_mfma_f32_32x32x16_bf16 v[20:35], v[148:151], a[88:91], v[20:35]
    ds_read_b64_tr_b16 v[164:165], v12 offset:22528
    ds_read_b64_tr_b16 v[166:167], v12 offset:23552
    v_mfma_f32_32x32x16_bf16 v[84:99], v[148:151], a[216:219], v[84:99]
    ds_read_b64_tr_b16 v[168:169], v13 offset:22528
    ds_read_b64_tr_b16 v[170:171], v13 offset:23552
    s_waitcnt lgkmcnt(12)
    v_mfma_f32_32x32x16_bf16 v[36:51], v[152:155], a[88:91], v[36:51]
    ds_read_b64_tr_b16 v[172:173], v14 offset:22528
    ds_read_b64_tr_b16 v[174:175], v14 offset:23552
    v_mfma_f32_32x32x16_bf16 v[100:115], v[152:155], a[216:219], v[100:115]
    ds_read_b64_tr_b16 v[176:177], v15 offset:22528
    ds_read_b64_tr_b16 v[178:179], v15 offset:23552
    s_waitcnt lgkmcnt(11)
    v_mfma_f32_32x32x16_bf16 v[52:67], v[156:159], a[88:91], v[52:67]
    s_add_u32 s53, s52, 0x0
    s_add_u32 m0, s54, 0x0
    buffer_load_dwordx4 v1, s[36:39], s53 offen lds
    v_mfma_f32_32x32x16_bf16 v[116:131], v[156:159], a[216:219], v[116:131]
    s_add_u32 s53, s52, 0x8000
    s_add_u32 m0, s54, 0x400
    buffer_load_dwordx4 v1, s[36:39], s53 offen lds
    v_mfma_f32_32x32x16_bf16 v[68:83], v[160:163], a[88:91], v[68:83]
    s_add_u32 s53, s52, 0x10000
    s_add_u32 m0, s54, 0x800
    buffer_load_dwordx4 v1, s[36:39], s53 offen lds
    v_mfma_f32_32x32x16_bf16 v[132:147], v[160:163], a[216:219], v[132:147]
    s_add_u32 s53, s52, 0x18000
    s_add_u32 m0, s54, 0xc00
    buffer_load_dwordx4 v1, s[36:39], s53 offen lds
    s_waitcnt lgkmcnt(6)
    v_mfma_f32_32x32x16_bf16 v[20:35], v[164:167], a[92:95], v[20:35]
    ds_read_b64_tr_b16 v[148:149], v12 offset:32768
    ds_read_b64_tr_b16 v[150:151], v12 offset:33792
    v_mfma_f32_32x32x16_bf16 v[84:99], v[164:167], a[220:223], v[84:99]
    ds_read_b64_tr_b16 v[152:153], v13 offset:32768
    ds_read_b64_tr_b16 v[154:155], v13 offset:33792
    s_waitcnt lgkmcnt(8)
    v_mfma_f32_32x32x16_bf16 v[36:51], v[168:171], a[92:95], v[36:51]
    ds_read_b64_tr_b16 v[156:157], v14 offset:32768
    ds_read_b64_tr_b16 v[158:159], v14 offset:33792
    v_mfma_f32_32x32x16_bf16 v[100:115], v[168:171], a[220:223], v[100:115]
    ds_read_b64_tr_b16 v[160:161], v15 offset:32768
    ds_read_b64_tr_b16 v[162:163], v15 offset:33792
    s_waitcnt lgkmcnt(10)
    v_mfma_f32_32x32x16_bf16 v[52:67], v[172:175], a[92:95], v[52:67]
    v_mfma_f32_32x32x16_bf16 v[116:131], v[172:175], a[220:223], v[116:131]
    s_waitcnt lgkmcnt(8)
    v_mfma_f32_32x32x16_bf16 v[68:83], v[176:179], a[92:95], v[68:83]
    v_mfma_f32_32x32x16_bf16 v[132:147], v[176:179], a[220:223], v[132:147]
    s_waitcnt vmcnt(4)
    s_barrier
    s_waitcnt lgkmcnt(6)
    v_mfma_f32_32x32x16_bf16 v[20:35], v[148:151], a[96:99], v[20:35]
    ds_read_b64_tr_b16 v[164:165], v12 offset:34816
    ds_read_b64_tr_b16 v[166:167], v12 offset:35840
    v_mfma_f32_32x32x16_bf16 v[84:99], v[148:151], a[224:227], v[84:99]
    ds_read_b64_tr_b16 v[168:169], v13 offset:34816
    ds_read_b64_tr_b16 v[170:171], v13 offset:35840
    s_waitcnt lgkmcnt(8)
    v_mfma_f32_32x32x16_bf16 v[36:51], v[152:155], a[96:99], v[36:51]
    ds_read_b64_tr_b16 v[172:173], v14 offset:34816
    ds_read_b64_tr_b16 v[174:175], v14 offset:35840
    v_mfma_f32_32x32x16_bf16 v[100:115], v[152:155], a[224:227], v[100:115]
    ds_read_b64_tr_b16 v[176:177], v15 offset:34816
    ds_read_b64_tr_b16 v[178:179], v15 offset:35840
    s_waitcnt lgkmcnt(10)
    v_mfma_f32_32x32x16_bf16 v[52:67], v[156:159], a[96:99], v[52:67]
    ds_read_b128 a[112:115], v4 offset:0
    v_mfma_f32_32x32x16_bf16 v[116:131], v[156:159], a[224:227], v[116:131]
    ds_read_b128 a[116:119], v5 offset:0
    s_waitcnt lgkmcnt(10)
    v_mfma_f32_32x32x16_bf16 v[68:83], v[160:163], a[96:99], v[68:83]
    ds_read_b128 a[120:123], v6 offset:0
    v_mfma_f32_32x32x16_bf16 v[132:147], v[160:163], a[224:227], v[132:147]
    ds_read_b128 a[124:127], v7 offset:0
    s_waitcnt lgkmcnt(10)
    v_mfma_f32_32x32x16_bf16 v[20:35], v[164:167], a[100:103], v[20:35]
    ds_read_b64_tr_b16 v[148:149], v12 offset:36864
    ds_read_b64_tr_b16 v[150:151], v12 offset:37888
    v_mfma_f32_32x32x16_bf16 v[84:99], v[164:167], a[228:231], v[84:99]
    ds_read_b64_tr_b16 v[152:153], v13 offset:36864
    ds_read_b64_tr_b16 v[154:155], v13 offset:37888
    s_waitcnt lgkmcnt(12)
    v_mfma_f32_32x32x16_bf16 v[36:51], v[168:171], a[100:103], v[36:51]
    ds_read_b64_tr_b16 v[156:157], v14 offset:36864
    ds_read_b64_tr_b16 v[158:159], v14 offset:37888
    v_mfma_f32_32x32x16_bf16 v[100:115], v[168:171], a[228:231], v[100:115]
    ds_read_b64_tr_b16 v[160:161], v15 offset:36864
    ds_read_b64_tr_b16 v[162:163], v15 offset:37888
    s_waitcnt lgkmcnt(11)
    v_mfma_f32_32x32x16_bf16 v[52:67], v[172:175], a[100:103], v[52:67]
    ds_read_b128 a[240:243], v4 offset:4096
    v_mfma_f32_32x32x16_bf16 v[116:131], v[172:175], a[228:231], v[116:131]
    ds_read_b128 a[244:247], v5 offset:4096
    v_mfma_f32_32x32x16_bf16 v[68:83], v[176:179], a[100:103], v[68:83]
    ds_read_b128 a[248:251], v6 offset:4096
    v_mfma_f32_32x32x16_bf16 v[132:147], v[176:179], a[228:231], v[132:147]
    ds_read_b128 a[252:255], v7 offset:4096
    s_waitcnt lgkmcnt(11)
    s_waitcnt lgkmcnt(10)
    v_mfma_f32_32x32x16_bf16 v[20:35], v[148:151], a[104:107], v[20:35]
    ds_read_b64_tr_b16 v[164:165], v12 offset:38912
    ds_read_b64_tr_b16 v[166:167], v12 offset:39936
    v_mfma_f32_32x32x16_bf16 v[84:99], v[148:151], a[232:235], v[84:99]
    ds_read_b64_tr_b16 v[168:169], v13 offset:38912
    ds_read_b64_tr_b16 v[170:171], v13 offset:39936
    s_waitcnt lgkmcnt(12)
    v_mfma_f32_32x32x16_bf16 v[36:51], v[152:155], a[104:107], v[36:51]
    ds_read_b64_tr_b16 v[172:173], v14 offset:38912
    ds_read_b64_tr_b16 v[174:175], v14 offset:39936
    v_mfma_f32_32x32x16_bf16 v[100:115], v[152:155], a[232:235], v[100:115]
    ds_read_b64_tr_b16 v[176:177], v15 offset:38912
    ds_read_b64_tr_b16 v[178:179], v15 offset:39936
    s_waitcnt lgkmcnt(11)
    v_mfma_f32_32x32x16_bf16 v[52:67], v[156:159], a[104:107], v[52:67]
    s_add_u32 s53, s52, 0x80000
    s_add_u32 m0, s54, 0x4000
    buffer_load_dwordx4 v1, s[36:39], s53 offen lds
    v_mfma_f32_32x32x16_bf16 v[116:131], v[156:159], a[232:235], v[116:131]
    s_add_u32 s53, s52, 0x88000
    s_add_u32 m0, s54, 0x4400
    buffer_load_dwordx4 v1, s[36:39], s53 offen lds
    v_mfma_f32_32x32x16_bf16 v[68:83], v[160:163], a[104:107], v[68:83]
    s_add_u32 s53, s52, 0x90000
    s_add_u32 m0, s54, 0x4800
    buffer_load_dwordx4 v1, s[36:39], s53 offen lds
    v_mfma_f32_32x32x16_bf16 v[132:147], v[160:163], a[232:235], v[132:147]
    s_add_u32 s53, s52, 0x98000
    s_add_u32 m0, s54, 0x4c00
    buffer_load_dwordx4 v1, s[36:39], s53 offen lds
    s_waitcnt lgkmcnt(6)
    v_mfma_f32_32x32x16_bf16 v[20:35], v[164:167], a[108:111], v[20:35]
    ds_read_b64_tr_b16 v[148:149], v12 offset:49152
    ds_read_b64_tr_b16 v[150:151], v12 offset:50176
    v_mfma_f32_32x32x16_bf16 v[84:99], v[164:167], a[236:239], v[84:99]
    ds_read_b64_tr_b16 v[152:153], v13 offset:49152
    ds_read_b64_tr_b16 v[154:155], v13 offset:50176
    s_waitcnt lgkmcnt(8)
    v_mfma_f32_32x32x16_bf16 v[36:51], v[168:171], a[108:111], v[36:51]
    ds_read_b64_tr_b16 v[156:157], v14 offset:49152
    ds_read_b64_tr_b16 v[158:159], v14 offset:50176
    v_mfma_f32_32x32x16_bf16 v[100:115], v[168:171], a[236:239], v[100:115]
    ds_read_b64_tr_b16 v[160:161], v15 offset:49152
    ds_read_b64_tr_b16 v[162:163], v15 offset:50176
    s_waitcnt lgkmcnt(10)
    v_mfma_f32_32x32x16_bf16 v[52:67], v[172:175], a[108:111], v[52:67]
    v_mfma_f32_32x32x16_bf16 v[116:131], v[172:175], a[236:239], v[116:131]
    s_waitcnt lgkmcnt(8)
    v_mfma_f32_32x32x16_bf16 v[68:83], v[176:179], a[108:111], v[68:83]
    v_mfma_f32_32x32x16_bf16 v[132:147], v[176:179], a[236:239], v[132:147]
    s_waitcnt vmcnt(4)
    s_barrier
    s_waitcnt lgkmcnt(6)
    v_mfma_f32_32x32x16_bf16 v[20:35], v[148:151], a[112:115], v[20:35]
    ds_read_b64_tr_b16 v[164:165], v12 offset:51200
    ds_read_b64_tr_b16 v[166:167], v12 offset:52224
    v_mfma_f32_32x32x16_bf16 v[84:99], v[148:151], a[240:243], v[84:99]
    ds_read_b64_tr_b16 v[168:169], v13 offset:51200
    ds_read_b64_tr_b16 v[170:171], v13 offset:52224
    s_waitcnt lgkmcnt(8)
    v_mfma_f32_32x32x16_bf16 v[36:51], v[152:155], a[112:115], v[36:51]
    ds_read_b64_tr_b16 v[172:173], v14 offset:51200
    ds_read_b64_tr_b16 v[174:175], v14 offset:52224
    v_mfma_f32_32x32x16_bf16 v[100:115], v[152:155], a[240:243], v[100:115]
    ds_read_b64_tr_b16 v[176:177], v15 offset:51200
    ds_read_b64_tr_b16 v[178:179], v15 offset:52224
    s_waitcnt lgkmcnt(10)
    v_mfma_f32_32x32x16_bf16 v[52:67], v[156:159], a[112:115], v[52:67]
    s_add_u32 s53, s52, 0x100000
    s_add_u32 m0, s54, 0x8000
    buffer_load_dwordx4 v1, s[36:39], s53 offen lds
    v_mfma_f32_32x32x16_bf16 v[116:131], v[156:159], a[240:243], v[116:131]
    s_add_u32 s53, s52, 0x108000
    s_add_u32 m0, s54, 0x8400
    buffer_load_dwordx4 v1, s[36:39], s53 offen lds
    s_waitcnt lgkmcnt(8)
    v_mfma_f32_32x32x16_bf16 v[68:83], v[160:163], a[112:115], v[68:83]
    s_add_u32 s53, s52, 0x110000
    s_add_u32 m0, s54, 0x8800
    buffer_load_dwordx4 v1, s[36:39], s53 offen lds
    v_mfma_f32_32x32x16_bf16 v[132:147], v[160:163], a[240:243], v[132:147]
    s_add_u32 s53, s52, 0x118000
    s_add_u32 m0, s54, 0x8c00
    buffer_load_dwordx4 v1, s[36:39], s53 offen lds
    s_waitcnt lgkmcnt(6)
    v_mfma_f32_32x32x16_bf16 v[20:35], v[164:167], a[116:119], v[20:35]
    ds_read_b64_tr_b16 v[148:149], v12 offset:53248
    ds_read_b64_tr_b16 v[150:151], v12 offset:54272
    v_mfma_f32_32x32x16_bf16 v[84:99], v[164:167], a[244:247], v[84:99]
    ds_read_b64_tr_b16 v[152:153], v13 offset:53248
    ds_read_b64_tr_b16 v[154:155], v13 offset:54272
    s_waitcnt lgkmcnt(8)
    v_mfma_f32_32x32x16_bf16 v[36:51], v[168:171], a[116:119], v[36:51]
    ds_read_b64_tr_b16 v[156:157], v14 offset:53248
    ds_read_b64_tr_b16 v[158:159], v14 offset:54272
    v_mfma_f32_32x32x16_bf16 v[100:115], v[168:171], a[244:247], v[100:115]
    ds_read_b64_tr_b16 v[160:161], v15 offset:53248
    ds_read_b64_tr_b16 v[162:163], v15 offset:54272
    s_waitcnt lgkmcnt(10)
    v_mfma_f32_32x32x16_bf16 v[52:67], v[172:175], a[116:119], v[52:67]
    v_mfma_f32_32x32x16_bf16 v[116:131], v[172:175], a[244:247], v[116:131]
    s_waitcnt lgkmcnt(8)
    v_mfma_f32_32x32x16_bf16 v[68:83], v[176:179], a[116:119], v[68:83]
    v_mfma_f32_32x32x16_bf16 v[132:147], v[176:179], a[244:247], v[132:147]
    s_waitcnt lgkmcnt(6)
    v_mfma_f32_32x32x16_bf16 v[20:35], v[148:151], a[120:123], v[20:35]
    ds_read_b64_tr_b16 v[164:165], v12 offset:55296
    ds_read_b64_tr_b16 v[166:167], v12 offset:56320
    v_mfma_f32_32x32x16_bf16 v[84:99], v[148:151], a[248:251], v[84:99]
    ds_read_b64_tr_b16 v[168:169], v13 offset:55296
    ds_read_b64_tr_b16 v[170:171], v13 offset:56320
    s_waitcnt lgkmcnt(8)
    v_mfma_f32_32x32x16_bf16 v[36:51], v[152:155], a[120:123], v[36:51]
    ds_read_b64_tr_b16 v[172:173], v14 offset:55296
    ds_read_b64_tr_b16 v[174:175], v14 offset:56320
    v_mfma_f32_32x32x16_bf16 v[100:115], v[152:155], a[248:251], v[100:115]
    ds_read_b64_tr_b16 v[176:177], v15 offset:55296
    ds_read_b64_tr_b16 v[178:179], v15 offset:56320
    s_waitcnt lgkmcnt(10)
    v_mfma_f32_32x32x16_bf16 v[52:67], v[156:159], a[120:123], v[52:67]
    v_mfma_f32_32x32x16_bf16 v[116:131], v[156:159], a[248:251], v[116:131]
    s_waitcnt lgkmcnt(8)
    v_mfma_f32_32x32x16_bf16 v[68:83], v[160:163], a[120:123], v[68:83]
    v_mfma_f32_32x32x16_bf16 v[132:147], v[160:163], a[248:251], v[132:147]
    s_waitcnt lgkmcnt(6)
    v_mfma_f32_32x32x16_bf16 v[20:35], v[164:167], a[124:127], v[20:35]
    ds_read_b64_tr_b16 v[148:149], v12 offset:0
    ds_read_b64_tr_b16 v[150:151], v12 offset:1024
    v_mfma_f32_32x32x16_bf16 v[84:99], v[164:167], a[252:255], v[84:99]
    ds_read_b64_tr_b16 v[152:153], v13 offset:0
    ds_read_b64_tr_b16 v[154:155], v13 offset:1024
    s_waitcnt lgkmcnt(8)
    v_mfma_f32_32x32x16_bf16 v[36:51], v[168:171], a[124:127], v[36:51]
    ds_read_b64_tr_b16 v[156:157], v14 offset:0
    ds_read_b64_tr_b16 v[158:159], v14 offset:1024
    v_mfma_f32_32x32x16_bf16 v[100:115], v[168:171], a[252:255], v[100:115]
    ds_read_b64_tr_b16 v[160:161], v15 offset:0
    ds_read_b64_tr_b16 v[162:163], v15 offset:1024
    s_waitcnt lgkmcnt(10)
    v_mfma_f32_32x32x16_bf16 v[52:67], v[172:175], a[124:127], v[52:67]
    v_mfma_f32_32x32x16_bf16 v[116:131], v[172:175], a[252:255], v[116:131]
    s_waitcnt lgkmcnt(8)
    v_mfma_f32_32x32x16_bf16 v[68:83], v[176:179], a[124:127], v[68:83]
    v_mfma_f32_32x32x16_bf16 v[132:147], v[176:179], a[252:255], v[132:147]
    s_nop 7
    s_waitcnt vmcnt(4)
    s_barrier
    v_cvt_pk_bf16_f32 v180, v20, v21
    v_cvt_pk_bf16_f32 v181, v22, v23
    v_cvt_pk_bf16_f32 v182, v24, v25
    v_cvt_pk_bf16_f32 v183, v26, v27
    s_nop 1
    v_permlane32_swap_b32 v180, v182
    v_permlane32_swap_b32 v181, v183
    v_cvt_pk_bf16_f32 v184, v28, v29
    v_cvt_pk_bf16_f32 v185, v30, v31
    v_cvt_pk_bf16_f32 v186, v32, v33
    v_cvt_pk_bf16_f32 v187, v34, v35
    s_nop 1
    v_permlane32_swap_b32 v184, v186
    v_permlane32_swap_b32 v185, v187
    s_waitcnt lgkmcnt(6)
    v_mfma_f32_32x32x16_bf16 v[20:35], a[0:3], v[148:151], 0
    ds_read_b64_tr_b16 v[164:165], v12 offset:2048
    ds_read_b64_tr_b16 v[166:167], v12 offset:3072
    v_cvt_pk_bf16_f32 v212, v84, v85
    v_cvt_pk_bf16_f32 v213, v86, v87
    v_cvt_pk_bf16_f32 v214, v88, v89
    v_cvt_pk_bf16_f32 v215, v90, v91
    s_nop 1
    v_permlane32_swap_b32 v212, v214
    v_permlane32_swap_b32 v213, v215
    v_cvt_pk_bf16_f32 v216, v92, v93
    v_cvt_pk_bf16_f32 v217, v94, v95
    v_cvt_pk_bf16_f32 v218, v96, v97
    v_cvt_pk_bf16_f32 v219, v98, v99
    s_nop 1
    v_permlane32_swap_b32 v216, v218
    v_permlane32_swap_b32 v217, v219
    v_mfma_f32_32x32x16_bf16 v[84:99], a[128:131], v[148:151], 0
    ds_read_b64_tr_b16 v[168:169], v13 offset:2048
    ds_read_b64_tr_b16 v[170:171], v13 offset:3072
    v_cvt_pk_bf16_f32 v188, v36, v37
    v_cvt_pk_bf16_f32 v189, v38, v39
    v_cvt_pk_bf16_f32 v190, v40, v41
    v_cvt_pk_bf16_f32 v191, v42, v43
    s_nop 1
    v_permlane32_swap_b32 v188, v190
    v_permlane32_swap_b32 v189, v191
    v_cvt_pk_bf16_f32 v192, v44, v45
    v_cvt_pk_bf16_f32 v193, v46, v47
    v_cvt_pk_bf16_f32 v194, v48, v49
    v_cvt_pk_bf16_f32 v195, v50, v51
    s_nop 1
    v_permlane32_swap_b32 v192, v194
    v_permlane32_swap_b32 v193, v195
    s_waitcnt lgkmcnt(8)
    v_mfma_f32_32x32x16_bf16 v[36:51], a[0:3], v[152:155], 0
    ds_read_b64_tr_b16 v[172:173], v14 offset:2048
    ds_read_b64_tr_b16 v[174:175], v14 offset:3072
    v_cvt_pk_bf16_f32 v220, v100, v101
    v_cvt_pk_bf16_f32 v221, v102, v103
    v_cvt_pk_bf16_f32 v222, v104, v105
    v_cvt_pk_bf16_f32 v223, v106, v107
    s_nop 1
    v_permlane32_swap_b32 v220, v222
    v_permlane32_swap_b32 v221, v223
    v_cvt_pk_bf16_f32 v224, v108, v109
    v_cvt_pk_bf16_f32 v225, v110, v111
    v_cvt_pk_bf16_f32 v226, v112, v113
    v_cvt_pk_bf16_f32 v227, v114, v115
    s_nop 1
    v_permlane32_swap_b32 v224, v226
    v_permlane32_swap_b32 v225, v227
    v_mfma_f32_32x32x16_bf16 v[100:115], a[128:131], v[152:155], 0
    ds_read_b64_tr_b16 v[176:177], v15 offset:2048
    ds_read_b64_tr_b16 v[178:179], v15 offset:3072
    v_cvt_pk_bf16_f32 v196, v52, v53
    v_cvt_pk_bf16_f32 v197, v54, v55
    v_cvt_pk_bf16_f32 v198, v56, v57
    v_cvt_pk_bf16_f32 v199, v58, v59
    s_nop 1
    v_permlane32_swap_b32 v196, v198
    v_permlane32_swap_b32 v197, v199
    v_cvt_pk_bf16_f32 v200, v60, v61
    v_cvt_pk_bf16_f32 v201, v62, v63
    v_cvt_pk_bf16_f32 v202, v64, v65
    v_cvt_pk_bf16_f32 v203, v66, v67
    s_nop 1
    v_permlane32_swap_b32 v200, v202
    v_permlane32_swap_b32 v201, v203
    s_waitcnt lgkmcnt(10)
    v_mfma_f32_32x32x16_bf16 v[52:67], a[0:3], v[156:159], 0
    s_add_u32 s53, s52, 0x180000
    s_add_u32 m0, s54, 0xc000
    buffer_load_dwordx4 v1, s[36:39], s53 offen lds
    v_cvt_pk_bf16_f32 v228, v116, v117
    v_cvt_pk_bf16_f32 v229, v118, v119
    v_cvt_pk_bf16_f32 v230, v120, v121
    v_cvt_pk_bf16_f32 v231, v122, v123
    s_nop 1
    v_permlane32_swap_b32 v228, v230
    v_permlane32_swap_b32 v229, v231
    v_cvt_pk_bf16_f32 v232, v124, v125
    v_cvt_pk_bf16_f32 v233, v126, v127
    v_cvt_pk_bf16_f32 v234, v128, v129
    v_cvt_pk_bf16_f32 v235, v130, v131
    s_nop 1
    v_permlane32_swap_b32 v232, v234
    v_permlane32_swap_b32 v233, v235
    v_mfma_f32_32x32x16_bf16 v[116:131], a[128:131], v[156:159], 0
    s_add_u32 s53, s52, 0x188000
    s_add_u32 m0, s54, 0xc400
    buffer_load_dwordx4 v1, s[36:39], s53 offen lds
    v_cvt_pk_bf16_f32 v204, v68, v69
    v_cvt_pk_bf16_f32 v205, v70, v71
    v_cvt_pk_bf16_f32 v206, v72, v73
    v_cvt_pk_bf16_f32 v207, v74, v75
    s_nop 1
    v_permlane32_swap_b32 v204, v206
    v_permlane32_swap_b32 v205, v207
    v_cvt_pk_bf16_f32 v208, v76, v77
    v_cvt_pk_bf16_f32 v209, v78, v79
    v_cvt_pk_bf16_f32 v210, v80, v81
    v_cvt_pk_bf16_f32 v211, v82, v83
    s_nop 1
    v_permlane32_swap_b32 v208, v210
    v_permlane32_swap_b32 v209, v211
    s_waitcnt lgkmcnt(8)
    v_mfma_f32_32x32x16_bf16 v[68:83], a[0:3], v[160:163], 0
    s_add_u32 s53, s52, 0x190000
    s_add_u32 m0, s54, 0xc800
    buffer_load_dwordx4 v1, s[36:39], s53 offen lds
    v_cvt_pk_bf16_f32 v236, v132, v133
    v_cvt_pk_bf16_f32 v237, v134, v135
    v_cvt_pk_bf16_f32 v238, v136, v137
    v_cvt_pk_bf16_f32 v239, v138, v139
    s_nop 1
    v_permlane32_swap_b32 v236, v238
    v_permlane32_swap_b32 v237, v239
    v_cvt_pk_bf16_f32 v240, v140, v141
    v_cvt_pk_bf16_f32 v241, v142, v143
    v_cvt_pk_bf16_f32 v242, v144, v145
    v_cvt_pk_bf16_f32 v243, v146, v147
    s_nop 1
    v_permlane32_swap_b32 v240, v242
    v_permlane32_swap_b32 v241, v243
    v_mfma_f32_32x32x16_bf16 v[132:147], a[128:131], v[160:163], 0
    s_add_u32 s53, s52, 0x198000
    s_add_u32 m0, s54, 0xcc00
    buffer_load_dwordx4 v1, s[36:39], s53 offen lds
    s_waitcnt lgkmcnt(6)
    v_mfma_f32_32x32x16_bf16 v[20:35], a[4:7], v[164:167], v[20:35]
    ds_read_b64_tr_b16 v[148:149], v12 offset:4096
    ds_read_b64_tr_b16 v[150:151], v12 offset:5120
    v_mfma_f32_32x32x16_bf16 v[84:99], a[132:135], v[164:167], v[84:99]
    ds_read_b64_tr_b16 v[152:153], v13 offset:4096
    ds_read_b64_tr_b16 v[154:155], v13 offset:5120
    s_waitcnt lgkmcnt(8)
    v_mfma_f32_32x32x16_bf16 v[36:51], a[4:7], v[168:171], v[36:51]
    ds_read_b64_tr_b16 v[156:157], v14 offset:4096
    ds_read_b64_tr_b16 v[158:159], v14 offset:5120
    v_mfma_f32_32x32x16_bf16 v[100:115], a[132:135], v[168:171], v[100:115]
    ds_read_b64_tr_b16 v[160:161], v15 offset:4096
    ds_read_b64_tr_b16 v[162:163], v15 offset:5120
    s_waitcnt lgkmcnt(10)
    v_mfma_f32_32x32x16_bf16 v[52:67], a[4:7], v[172:175], v[52:67]
    s_add_u32 s53, s57, 0x0
    buffer_store_dwordx4 v[180:183], v16, s[44:47], s53 offen
    v_mfma_f32_32x32x16_bf16 v[116:131], a[132:135], v[172:175], v[116:131]
    s_waitcnt lgkmcnt(8)
    v_mfma_f32_32x32x16_bf16 v[68:83], a[4:7], v[176:179], v[68:83]
    v_mfma_f32_32x32x16_bf16 v[132:147], a[132:135], v[176:179], v[132:147]
    s_waitcnt lgkmcnt(6)
    v_mfma_f32_32x32x16_bf16 v[20:35], a[8:11], v[148:151], v[20:35]
    ds_read_b64_tr_b16 v[164:165], v12 offset:6144
    ds_read_b64_tr_b16 v[166:167], v12 offset:7168
    v_mfma_f32_32x32x16_bf16 v[84:99], a[136:139], v[148:151], v[84:99]
    ds_read_b64_tr_b16 v[168:169], v13 offset:6144
    ds_read_b64_tr_b16 v[170:171], v13 offset:7168
    s_waitcnt lgkmcnt(8)
    v_mfma_f32_32x32x16_bf16 v[36:51], a[8:11], v[152:155], v[36:51]
    ds_read_b64_tr_b16 v[172:173], v14 offset:6144
    ds_read_b64_tr_b16 v[174:175], v14 offset:7168
    v_mfma_f32_32x32x16_bf16 v[100:115], a[136:139], v[152:155], v[100:115]
    ds_read_b64_tr_b16 v[176:177], v15 offset:6144
    ds_read_b64_tr_b16 v[178:179], v15 offset:7168
    s_waitcnt lgkmcnt(10)
    v_mfma_f32_32x32x16_bf16 v[52:67], a[8:11], v[156:159], v[52:67]
    s_add_u32 s53, s57, 0x400
    buffer_store_dwordx4 v[184:187], v16, s[44:47], s53 offen
    v_mfma_f32_32x32x16_bf16 v[116:131], a[136:139], v[156:159], v[116:131]
    s_waitcnt lgkmcnt(8)
    v_mfma_f32_32x32x16_bf16 v[68:83], a[8:11], v[160:163], v[68:83]
    v_mfma_f32_32x32x16_bf16 v[132:147], a[136:139], v[160:163], v[132:147]
    s_waitcnt lgkmcnt(6)
    v_mfma_f32_32x32x16_bf16 v[20:35], a[12:15], v[164:167], v[20:35]
    ds_read_b64_tr_b16 v[148:149], v12 offset:16384
    ds_read_b64_tr_b16 v[150:151], v12 offset:17408
    v_mfma_f32_32x32x16_bf16 v[84:99], a[140:143], v[164:167], v[84:99]
    ds_read_b64_tr_b16 v[152:153], v13 offset:16384
    ds_read_b64_tr_b16 v[154:155], v13 offset:17408
    s_waitcnt lgkmcnt(8)
    v_mfma_f32_32x32x16_bf16 v[36:51], a[12:15], v[168:171], v[36:51]
    ds_read_b64_tr_b16 v[156:157], v14 offset:16384
    ds_read_b64_tr_b16 v[158:159], v14 offset:17408
    v_mfma_f32_32x32x16_bf16 v[100:115], a[140:143], v[168:171], v[100:115]
    ds_read_b64_tr_b16 v[160:161], v15 offset:16384
    ds_read_b64_tr_b16 v[162:163], v15 offset:17408
    s_waitcnt lgkmcnt(10)
    v_mfma_f32_32x32x16_bf16 v[52:67], a[12:15], v[172:175], v[52:67]
    s_add_u32 s53, s57, 0x2000
    buffer_store_dwordx4 v[212:215], v16, s[44:47], s53 offen
    v_mfma_f32_32x32x16_bf16 v[116:131], a[140:143], v[172:175], v[116:131]
    s_waitcnt lgkmcnt(8)
    v_mfma_f32_32x32x16_bf16 v[68:83], a[12:15], v[176:179], v[68:83]
    v_mfma_f32_32x32x16_bf16 v[132:147], a[140:143], v[176:179], v[132:147]
    s_waitcnt vmcnt(7)
    s_barrier
    s_waitcnt lgkmcnt(6)
    v_mfma_f32_32x32x16_bf16 v[20:35], a[16:19], v[148:151], v[20:35]
    ds_read_b64_tr_b16 v[164:165], v12 offset:18432
    ds_read_b64_tr_b16 v[166:167], v12 offset:19456
    v_mfma_f32_32x32x16_bf16 v[84:99], a[144:147], v[148:151], v[84:99]
    ds_read_b64_tr_b16 v[168:169], v13 offset:18432
    ds_read_b64_tr_b16 v[170:171], v13 offset:19456
    s_waitcnt lgkmcnt(8)
    v_mfma_f32_32x32x16_bf16 v[36:51], a[16:19], v[152:155], v[36:51]
    ds_read_b64_tr_b16 v[172:173], v14 offset:18432
    ds_read_b64_tr_b16 v[174:175], v14 offset:19456
    v_mfma_f32_32x32x16_bf16 v[100:115], a[144:147], v[152:155], v[100:115]
    ds_read_b64_tr_b16 v[176:177], v15 offset:18432
    ds_read_b64_tr_b16 v[178:179], v15 offset:19456
    s_waitcnt lgkmcnt(10)
    v_mfma_f32_32x32x16_bf16 v[52:67], a[16:19], v[156:159], v[52:67]
    s_add_u32 s53, s57, 0x2400
    buffer_store_dwordx4 v[216:219], v16, s[44:47], s53 offen
    s_add_u32 s53, s52, 0x200000
    s_add_u32 m0, s54, 0x0
    buffer_load_dwordx4 v1, s[36:39], s53 offen lds
    v_mfma_f32_32x32x16_bf16 v[116:131], a[144:147], v[156:159], v[116:131]
    s_add_u32 s53, s52, 0x208000
    s_add_u32 m0, s54, 0x400
    buffer_load_dwordx4 v1, s[36:39], s53 offen lds
    s_waitcnt lgkmcnt(8)
    v_mfma_f32_32x32x16_bf16 v[68:83], a[16:19], v[160:163], v[68:83]
    s_add_u32 s53, s52, 0x210000
    s_add_u32 m0, s54, 0x800
    buffer_load_dwordx4 v1, s[36:39], s53 offen lds
    v_mfma_f32_32x32x16_bf16 v[132:147], a[144:147], v[160:163], v[132:147]
    s_add_u32 s53, s52, 0x218000
    s_add_u32 m0, s54, 0xc00
    buffer_load_dwordx4 v1, s[36:39], s53 offen lds
    s_waitcnt lgkmcnt(6)
    v_mfma_f32_32x32x16_bf16 v[20:35], a[20:23], v[164:167], v[20:35]
    ds_read_b64_tr_b16 v[148:149], v12 offset:20480
    ds_read_b64_tr_b16 v[150:151], v12 offset:21504
    v_mfma_f32_32x32x16_bf16 v[84:99], a[148:151], v[164:167], v[84:99]
    ds_read_b64_tr_b16 v[152:153], v13 offset:20480
    ds_read_b64_tr_b16 v[154:155], v13 offset:21504
    s_waitcnt lgkmcnt(8)
    v_mfma_f32_32x32x16_bf16 v[36:51], a[20:23], v[168:171], v[36:51]
    ds_read_b64_tr_b16 v[156:157], v14 offset:20480
    ds_read_b64_tr_b16 v[158:159], v14 offset:21504
    v_mfma_f32_32x32x16_bf16 v[100:115], a[148:151], v[168:171], v[100:115]
    ds_read_b64_tr_b16 v[160:161], v15 offset:20480
    ds_read_b64_tr_b16 v[162:163], v15 offset:21504
    s_waitcnt lgkmcnt(10)
    v_mfma_f32_32x32x16_bf16 v[52:67], a[20:23], v[172:175], v[52:67]
    s_add_u32 s53, s57, 0x800
    buffer_store_dwordx4 v[188:191], v16, s[44:47], s53 offen
    v_mfma_f32_32x32x16_bf16 v[116:131], a[148:151], v[172:175], v[116:131]
    s_waitcnt lgkmcnt(8)
    v_mfma_f32_32x32x16_bf16 v[68:83], a[20:23], v[176:179], v[68:83]
    v_mfma_f32_32x32x16_bf16 v[132:147], a[148:151], v[176:179], v[132:147]
    s_waitcnt lgkmcnt(6)
    v_mfma_f32_32x32x16_bf16 v[20:35], a[24:27], v[148:151], v[20:35]
    ds_read_b64_tr_b16 v[164:165], v12 offset:22528
    ds_read_b64_tr_b16 v[166:167], v12 offset:23552
    v_mfma_f32_32x32x16_bf16 v[84:99], a[152:155], v[148:151], v[84:99]
    ds_read_b64_tr_b16 v[168:169], v13 offset:22528
    ds_read_b64_tr_b16 v[170:171], v13 offset:23552
    s_waitcnt lgkmcnt(8)
    v_mfma_f32_32x32x16_bf16 v[36:51], a[24:27], v[152:155], v[36:51]
    ds_read_b64_tr_b16 v[172:173], v14 offset:22528
    ds_read_b64_tr_b16 v[174:175], v14 offset:23552
    v_mfma_f32_32x32x16_bf16 v[100:115], a[152:155], v[152:155], v[100:115]
    ds_read_b64_tr_b16 v[176:177], v15 offset:22528
    ds_read_b64_tr_b16 v[178:179], v15 offset:23552
    s_waitcnt lgkmcnt(10)
    v_mfma_f32_32x32x16_bf16 v[52:67], a[24:27], v[156:159], v[52:67]
    s_add_u32 s53, s57, 0xc00
    buffer_store_dwordx4 v[192:195], v16, s[44:47], s53 offen
    v_mfma_f32_32x32x16_bf16 v[116:131], a[152:155], v[156:159], v[116:131]
    s_waitcnt lgkmcnt(8)
    v_mfma_f32_32x32x16_bf16 v[68:83], a[24:27], v[160:163], v[68:83]
    v_mfma_f32_32x32x16_bf16 v[132:147], a[152:155], v[160:163], v[132:147]
    s_waitcnt lgkmcnt(6)
    v_mfma_f32_32x32x16_bf16 v[20:35], a[28:31], v[164:167], v[20:35]
    ds_read_b64_tr_b16 v[148:149], v12 offset:32768
    ds_read_b64_tr_b16 v[150:151], v12 offset:33792
    v_mfma_f32_32x32x16_bf16 v[84:99], a[156:159], v[164:167], v[84:99]
    ds_read_b64_tr_b16 v[152:153], v13 offset:32768
    ds_read_b64_tr_b16 v[154:155], v13 offset:33792
    s_waitcnt lgkmcnt(8)
    v_mfma_f32_32x32x16_bf16 v[36:51], a[28:31], v[168:171], v[36:51]
    ds_read_b64_tr_b16 v[156:157], v14 offset:32768
    ds_read_b64_tr_b16 v[158:159], v14 offset:33792
    v_mfma_f32_32x32x16_bf16 v[100:115], a[156:159], v[168:171], v[100:115]
    ds_read_b64_tr_b16 v[160:161], v15 offset:32768
    ds_read_b64_tr_b16 v[162:163], v15 offset:33792
    s_waitcnt lgkmcnt(10)
    v_mfma_f32_32x32x16_bf16 v[52:67], a[28:31], v[172:175], v[52:67]
    s_add_u32 s53, s57, 0x2800
    buffer_store_dwordx4 v[220:223], v16, s[44:47], s53 offen
    v_mfma_f32_32x32x16_bf16 v[116:131], a[156:159], v[172:175], v[116:131]
    s_waitcnt lgkmcnt(8)
    v_mfma_f32_32x32x16_bf16 v[68:83], a[28:31], v[176:179], v[68:83]
    v_mfma_f32_32x32x16_bf16 v[132:147], a[156:159], v[176:179], v[132:147]
    s_waitcnt vmcnt(11)
    s_barrier
    s_waitcnt lgkmcnt(6)
    v_mfma_f32_32x32x16_bf16 v[20:35], a[32:35], v[148:151], v[20:35]
    ds_read_b64_tr_b16 v[164:165], v12 offset:34816
    ds_read_b64_tr_b16 v[166:167], v12 offset:35840
    v_mfma_f32_32x32x16_bf16 v[84:99], a[160:163], v[148:151], v[84:99]
    ds_read_b64_tr_b16 v[168:169], v13 offset:34816
    ds_read_b64_tr_b16 v[170:171], v13 offset:35840
    s_waitcnt lgkmcnt(8)
    v_mfma_f32_32x32x16_bf16 v[36:51], a[32:35], v[152:155], v[36:51]
    ds_read_b64_tr_b16 v[172:173], v14 offset:34816
    ds_read_b64_tr_b16 v[174:175], v14 offset:35840
    v_mfma_f32_32x32x16_bf16 v[100:115], a[160:163], v[152:155], v[100:115]
    ds_read_b64_tr_b16 v[176:177], v15 offset:34816
    ds_read_b64_tr_b16 v[178:179], v15 offset:35840
    s_waitcnt lgkmcnt(10)
    v_mfma_f32_32x32x16_bf16 v[52:67], a[32:35], v[156:159], v[52:67]
    s_add_u32 s53, s57, 0x2c00
    buffer_store_dwordx4 v[224:227], v16, s[44:47], s53 offen
    s_add_u32 s53, s52, 0x280000
    s_add_u32 m0, s54, 0x4000
    buffer_load_dwordx4 v1, s[36:39], s53 offen lds
    v_mfma_f32_32x32x16_bf16 v[116:131], a[160:163], v[156:159], v[116:131]
    s_add_u32 s53, s52, 0x288000
    s_add_u32 m0, s54, 0x4400
    buffer_load_dwordx4 v1, s[36:39], s53 offen lds
    s_waitcnt lgkmcnt(8)
    v_mfma_f32_32x32x16_bf16 v[68:83], a[32:35], v[160:163], v[68:83]
    s_add_u32 s53, s52, 0x290000
    s_add_u32 m0, s54, 0x4800
    buffer_load_dwordx4 v1, s[36:39], s53 offen lds
    v_mfma_f32_32x32x16_bf16 v[132:147], a[160:163], v[160:163], v[132:147]
    s_add_u32 s53, s52, 0x298000
    s_add_u32 m0, s54, 0x4c00
    buffer_load_dwordx4 v1, s[36:39], s53 offen lds
    s_waitcnt lgkmcnt(6)
    v_mfma_f32_32x32x16_bf16 v[20:35], a[36:39], v[164:167], v[20:35]
    ds_read_b64_tr_b16 v[148:149], v12 offset:36864
    ds_read_b64_tr_b16 v[150:151], v12 offset:37888
    v_mfma_f32_32x32x16_bf16 v[84:99], a[164:167], v[164:167], v[84:99]
    ds_read_b64_tr_b16 v[152:153], v13 offset:36864
    ds_read_b64_tr_b16 v[154:155], v13 offset:37888
    s_waitcnt lgkmcnt(8)
    v_mfma_f32_32x32x16_bf16 v[36:51], a[36:39], v[168:171], v[36:51]
    ds_read_b64_tr_b16 v[156:157], v14 offset:36864
    ds_read_b64_tr_b16 v[158:159], v14 offset:37888
    v_mfma_f32_32x32x16_bf16 v[100:115], a[164:167], v[168:171], v[100:115]
    ds_read_b64_tr_b16 v[160:161], v15 offset:36864
    ds_read_b64_tr_b16 v[162:163], v15 offset:37888
    s_waitcnt lgkmcnt(10)
    v_mfma_f32_32x32x16_bf16 v[52:67], a[36:39], v[172:175], v[52:67]
    s_add_u32 s53, s57, 0x1000
    buffer_store_dwordx4 v[196:199], v16, s[44:47], s53 offen
    v_mfma_f32_32x32x16_bf16 v[116:131], a[164:167], v[172:175], v[116:131]
    s_waitcnt lgkmcnt(8)
    v_mfma_f32_32x32x16_bf16 v[68:83], a[36:39], v[176:179], v[68:83]
    v_mfma_f32_32x32x16_bf16 v[132:147], a[164:167], v[176:179], v[132:147]
    s_waitcnt lgkmcnt(6)
    v_mfma_f32_32x32x16_bf16 v[20:35], a[40:43], v[148:151], v[20:35]
    ds_read_b64_tr_b16 v[164:165], v12 offset:38912
    ds_read_b64_tr_b16 v[166:167], v12 offset:39936
    v_mfma_f32_32x32x16_bf16 v[84:99], a[168:171], v[148:151], v[84:99]
    ds_read_b64_tr_b16 v[168:169], v13 offset:38912
    ds_read_b64_tr_b16 v[170:171], v13 offset:39936
    s_waitcnt lgkmcnt(8)
    v_mfma_f32_32x32x16_bf16 v[36:51], a[40:43], v[152:155], v[36:51]
    ds_read_b64_tr_b16 v[172:173], v14 offset:38912
    ds_read_b64_tr_b16 v[174:175], v14 offset:39936
    v_mfma_f32_32x32x16_bf16 v[100:115], a[168:171], v[152:155], v[100:115]
    ds_read_b64_tr_b16 v[176:177], v15 offset:38912
    ds_read_b64_tr_b16 v[178:179], v15 offset:39936
    s_waitcnt lgkmcnt(10)
    v_mfma_f32_32x32x16_bf16 v[52:67], a[40:43], v[156:159], v[52:67]
    s_add_u32 s53, s57, 0x1400
    buffer_store_dwordx4 v[200:203], v16, s[44:47], s53 offen
    v_mfma_f32_32x32x16_bf16 v[116:131], a[168:171], v[156:159], v[116:131]
    s_waitcnt lgkmcnt(8)
    v_mfma_f32_32x32x16_bf16 v[68:83], a[40:43], v[160:163], v[68:83]
    v_mfma_f32_32x32x16_bf16 v[132:147], a[168:171], v[160:163], v[132:147]
    s_waitcnt lgkmcnt(6)
    v_mfma_f32_32x32x16_bf16 v[20:35], a[44:47], v[164:167], v[20:35]
    ds_read_b64_tr_b16 v[148:149], v12 offset:49152
    ds_read_b64_tr_b16 v[150:151], v12 offset:50176
    v_mfma_f32_32x32x16_bf16 v[84:99], a[172:175], v[164:167], v[84:99]
    ds_read_b64_tr_b16 v[152:153], v13 offset:49152
    ds_read_b64_tr_b16 v[154:155], v13 offset:50176
    s_waitcnt lgkmcnt(8)
    v_mfma_f32_32x32x16_bf16 v[36:51], a[44:47], v[168:171], v[36:51]
    ds_read_b64_tr_b16 v[156:157], v14 offset:49152
    ds_read_b64_tr_b16 v[158:159], v14 offset:50176
    v_mfma_f32_32x32x16_bf16 v[100:115], a[172:175], v[168:171], v[100:115]
    ds_read_b64_tr_b16 v[160:161], v15 offset:49152
    ds_read_b64_tr_b16 v[162:163], v15 offset:50176
    s_waitcnt lgkmcnt(10)
    v_mfma_f32_32x32x16_bf16 v[52:67], a[44:47], v[172:175], v[52:67]
    s_add_u32 s53, s57, 0x3000
    buffer_store_dwordx4 v[228:231], v16, s[44:47], s53 offen
    v_mfma_f32_32x32x16_bf16 v[116:131], a[172:175], v[172:175], v[116:131]
    s_waitcnt lgkmcnt(8)
    v_mfma_f32_32x32x16_bf16 v[68:83], a[44:47], v[176:179], v[68:83]
    v_mfma_f32_32x32x16_bf16 v[132:147], a[172:175], v[176:179], v[132:147]
    s_waitcnt vmcnt(11)
    s_barrier
    s_waitcnt lgkmcnt(6)
    v_mfma_f32_32x32x16_bf16 v[20:35], a[48:51], v[148:151], v[20:35]
    ds_read_b64_tr_b16 v[164:165], v12 offset:51200
    ds_read_b64_tr_b16 v[166:167], v12 offset:52224
    v_mfma_f32_32x32x16_bf16 v[84:99], a[176:179], v[148:151], v[84:99]
    ds_read_b64_tr_b16 v[168:169], v13 offset:51200
    ds_read_b64_tr_b16 v[170:171], v13 offset:52224
    s_waitcnt lgkmcnt(8)
    v_mfma_f32_32x32x16_bf16 v[36:51], a[48:51], v[152:155], v[36:51]
    ds_read_b64_tr_b16 v[172:173], v14 offset:51200
    ds_read_b64_tr_b16 v[174:175], v14 offset:52224
    v_mfma_f32_32x32x16_bf16 v[100:115], a[176:179], v[152:155], v[100:115]
    ds_read_b64_tr_b16 v[176:177], v15 offset:51200
    ds_read_b64_tr_b16 v[178:179], v15 offset:52224
    s_waitcnt lgkmcnt(10)
    v_mfma_f32_32x32x16_bf16 v[52:67], a[48:51], v[156:159], v[52:67]
    s_add_u32 s53, s57, 0x3400
    buffer_store_dwordx4 v[232:235], v16, s[44:47], s53 offen
    s_add_u32 s53, s52, 0x300000
    s_add_u32 m0, s54, 0x8000
    buffer_load_dwordx4 v1, s[36:39], s53 offen lds
    v_mfma_f32_32x32x16_bf16 v[116:131], a[176:179], v[156:159], v[116:131]
    s_add_u32 s53, s52, 0x308000
    s_add_u32 m0, s54, 0x8400
    buffer_load_dwordx4 v1, s[36:39], s53 offen lds
    s_waitcnt lgkmcnt(8)
    v_mfma_f32_32x32x16_bf16 v[68:83], a[48:51], v[160:163], v[68:83]
    s_add_u32 s53, s52, 0x310000
    s_add_u32 m0, s54, 0x8800
    buffer_load_dwordx4 v1, s[36:39], s53 offen lds
    v_mfma_f32_32x32x16_bf16 v[132:147], a[176:179], v[160:163], v[132:147]
    s_add_u32 s53, s52, 0x318000
    s_add_u32 m0, s54, 0x8c00
    buffer_load_dwordx4 v1, s[36:39], s53 offen lds
    s_waitcnt lgkmcnt(6)
    v_mfma_f32_32x32x16_bf16 v[20:35], a[52:55], v[164:167], v[20:35]
    ds_read_b64_tr_b16 v[148:149], v12 offset:53248
    ds_read_b64_tr_b16 v[150:151], v12 offset:54272
    v_mfma_f32_32x32x16_bf16 v[84:99], a[180:183], v[164:167], v[84:99]
    ds_read_b64_tr_b16 v[152:153], v13 offset:53248
    ds_read_b64_tr_b16 v[154:155], v13 offset:54272
    s_waitcnt lgkmcnt(8)
    v_mfma_f32_32x32x16_bf16 v[36:51], a[52:55], v[168:171], v[36:51]
    ds_read_b64_tr_b16 v[156:157], v14 offset:53248
    ds_read_b64_tr_b16 v[158:159], v14 offset:54272
    v_mfma_f32_32x32x16_bf16 v[100:115], a[180:183], v[168:171], v[100:115]
    ds_read_b64_tr_b16 v[160:161], v15 offset:53248
    ds_read_b64_tr_b16 v[162:163], v15 offset:54272
    s_waitcnt lgkmcnt(10)
    v_mfma_f32_32x32x16_bf16 v[52:67], a[52:55], v[172:175], v[52:67]
    s_add_u32 s53, s57, 0x1800
    buffer_store_dwordx4 v[204:207], v16, s[44:47], s53 offen
    v_mfma_f32_32x32x16_bf16 v[116:131], a[180:183], v[172:175], v[116:131]
    s_waitcnt lgkmcnt(8)
    v_mfma_f32_32x32x16_bf16 v[68:83], a[52:55], v[176:179], v[68:83]
    v_mfma_f32_32x32x16_bf16 v[132:147], a[180:183], v[176:179], v[132:147]
    s_waitcnt lgkmcnt(6)
    v_mfma_f32_32x32x16_bf16 v[20:35], a[56:59], v[148:151], v[20:35]
    ds_read_b64_tr_b16 v[164:165], v12 offset:55296
    ds_read_b64_tr_b16 v[166:167], v12 offset:56320
    v_mfma_f32_32x32x16_bf16 v[84:99], a[184:187], v[148:151], v[84:99]
    ds_read_b64_tr_b16 v[168:169], v13 offset:55296
    ds_read_b64_tr_b16 v[170:171], v13 offset:56320
    s_waitcnt lgkmcnt(8)
    v_mfma_f32_32x32x16_bf16 v[36:51], a[56:59], v[152:155], v[36:51]
    ds_read_b64_tr_b16 v[172:173], v14 offset:55296
    ds_read_b64_tr_b16 v[174:175], v14 offset:56320
    v_mfma_f32_32x32x16_bf16 v[100:115], a[184:187], v[152:155], v[100:115]
    ds_read_b64_tr_b16 v[176:177], v15 offset:55296
    ds_read_b64_tr_b16 v[178:179], v15 offset:56320
    s_waitcnt lgkmcnt(10)
    v_mfma_f32_32x32x16_bf16 v[52:67], a[56:59], v[156:159], v[52:67]
    s_add_u32 s53, s57, 0x1c00
    buffer_store_dwordx4 v[208:211], v16, s[44:47], s53 offen
    v_mfma_f32_32x32x16_bf16 v[116:131], a[184:187], v[156:159], v[116:131]
    s_waitcnt lgkmcnt(8)
    v_mfma_f32_32x32x16_bf16 v[68:83], a[56:59], v[160:163], v[68:83]
    v_mfma_f32_32x32x16_bf16 v[132:147], a[184:187], v[160:163], v[132:147]
    s_waitcnt lgkmcnt(6)
    v_mfma_f32_32x32x16_bf16 v[20:35], a[60:63], v[164:167], v[20:35]
    ds_read_b64_tr_b16 v[148:149], v12 offset:0
    ds_read_b64_tr_b16 v[150:151], v12 offset:1024
    v_mfma_f32_32x32x16_bf16 v[84:99], a[188:191], v[164:167], v[84:99]
    ds_read_b64_tr_b16 v[152:153], v13 offset:0
    ds_read_b64_tr_b16 v[154:155], v13 offset:1024
    s_waitcnt lgkmcnt(8)
    v_mfma_f32_32x32x16_bf16 v[36:51], a[60:63], v[168:171], v[36:51]
    ds_read_b64_tr_b16 v[156:157], v14 offset:0
    ds_read_b64_tr_b16 v[158:159], v14 offset:1024
    v_mfma_f32_32x32x16_bf16 v[100:115], a[188:191], v[168:171], v[100:115]
    ds_read_b64_tr_b16 v[160:161], v15 offset:0
    ds_read_b64_tr_b16 v[162:163], v15 offset:1024
    s_waitcnt lgkmcnt(10)
    v_mfma_f32_32x32x16_bf16 v[52:67], a[60:63], v[172:175], v[52:67]
    s_add_u32 s53, s57, 0x3800
    buffer_store_dwordx4 v[236:239], v16, s[44:47], s53 offen
    v_mfma_f32_32x32x16_bf16 v[116:131], a[188:191], v[172:175], v[116:131]
    s_waitcnt lgkmcnt(8)
    v_mfma_f32_32x32x16_bf16 v[68:83], a[60:63], v[176:179], v[68:83]
    v_mfma_f32_32x32x16_bf16 v[132:147], a[188:191], v[176:179], v[132:147]
    s_waitcnt vmcnt(11)
    s_barrier
    s_waitcnt lgkmcnt(6)
    v_mfma_f32_32x32x16_bf16 v[20:35], a[64:67], v[148:151], v[20:35]
    ds_read_b64_tr_b16 v[164:165], v12 offset:2048
    ds_read_b64_tr_b16 v[166:167], v12 offset:3072
    v_mfma_f32_32x32x16_bf16 v[84:99], a[192:195], v[148:151], v[84:99]
    ds_read_b64_tr_b16 v[168:169], v13 offset:2048
    ds_read_b64_tr_b16 v[170:171], v13 offset:3072
    s_waitcnt lgkmcnt(8)
    v_mfma_f32_32x32x16_bf16 v[36:51], a[64:67], v[152:155], v[36:51]
    ds_read_b64_tr_b16 v[172:173], v14 offset:2048
    ds_read_b64_tr_b16 v[174:175], v14 offset:3072
    v_mfma_f32_32x32x16_bf16 v[100:115], a[192:195], v[152:155], v[100:115]
    ds_read_b64_tr_b16 v[176:177], v15 offset:2048
    ds_read_b64_tr_b16 v[178:179], v15 offset:3072
    s_waitcnt lgkmcnt(10)
    v_mfma_f32_32x32x16_bf16 v[52:67], a[64:67], v[156:159], v[52:67]
    s_add_u32 s53, s57, 0x3c00
    buffer_store_dwordx4 v[240:243], v16, s[44:47], s53 offen
    s_add_u32 s53, s52, 0x380000
    s_add_u32 m0, s54, 0xc000
    buffer_load_dwordx4 v1, s[36:39], s53 offen lds
    v_mfma_f32_32x32x16_bf16 v[116:131], a[192:195], v[156:159], v[116:131]
    s_add_u32 s53, s52, 0x388000
    s_add_u32 m0, s54, 0xc400
    buffer_load_dwordx4 v1, s[36:39], s53 offen lds
    s_waitcnt lgkmcnt(8)
    v_mfma_f32_32x32x16_bf16 v[68:83], a[64:67], v[160:163], v[68:83]
    s_add_u32 s53, s52, 0x390000
    s_add_u32 m0, s54, 0xc800
    buffer_load_dwordx4 v1, s[36:39], s53 offen lds
    v_mfma_f32_32x32x16_bf16 v[132:147], a[192:195], v[160:163], v[132:147]
    s_add_u32 s53, s52, 0x398000
    s_add_u32 m0, s54, 0xcc00
    buffer_load_dwordx4 v1, s[36:39], s53 offen lds
    s_waitcnt lgkmcnt(6)
    v_mfma_f32_32x32x16_bf16 v[20:35], a[68:71], v[164:167], v[20:35]
    ds_read_b64_tr_b16 v[148:149], v12 offset:4096
    ds_read_b64_tr_b16 v[150:151], v12 offset:5120
    v_mfma_f32_32x32x16_bf16 v[84:99], a[196:199], v[164:167], v[84:99]
    ds_read_b64_tr_b16 v[152:153], v13 offset:4096
    ds_read_b64_tr_b16 v[154:155], v13 offset:5120
    s_waitcnt lgkmcnt(8)
    v_mfma_f32_32x32x16_bf16 v[36:51], a[68:71], v[168:171], v[36:51]
    ds_read_b64_tr_b16 v[156:157], v14 offset:4096
    ds_read_b64_tr_b16 v[158:159], v14 offset:5120
    v_mfma_f32_32x32x16_bf16 v[100:115], a[196:199], v[168:171], v[100:115]
    ds_read_b64_tr_b16 v[160:161], v15 offset:4096
    ds_read_b64_tr_b16 v[162:163], v15 offset:5120
    s_waitcnt lgkmcnt(10)
    v_mfma_f32_32x32x16_bf16 v[52:67], a[68:71], v[172:175], v[52:67]
    v_mfma_f32_32x32x16_bf16 v[116:131], a[196:199], v[172:175], v[116:131]
    s_waitcnt lgkmcnt(8)
    v_mfma_f32_32x32x16_bf16 v[68:83], a[68:71], v[176:179], v[68:83]
    v_mfma_f32_32x32x16_bf16 v[132:147], a[196:199], v[176:179], v[132:147]
    s_waitcnt lgkmcnt(6)
    v_mfma_f32_32x32x16_bf16 v[20:35], a[72:75], v[148:151], v[20:35]
    ds_read_b64_tr_b16 v[164:165], v12 offset:6144
    ds_read_b64_tr_b16 v[166:167], v12 offset:7168
    v_mfma_f32_32x32x16_bf16 v[84:99], a[200:203], v[148:151], v[84:99]
    ds_read_b64_tr_b16 v[168:169], v13 offset:6144
    ds_read_b64_tr_b16 v[170:171], v13 offset:7168
    s_waitcnt lgkmcnt(8)
    v_mfma_f32_32x32x16_bf16 v[36:51], a[72:75], v[152:155], v[36:51]
    ds_read_b64_tr_b16 v[172:173], v14 offset:6144
    ds_read_b64_tr_b16 v[174:175], v14 offset:7168
    v_mfma_f32_32x32x16_bf16 v[100:115], a[200:203], v[152:155], v[100:115]
    ds_read_b64_tr_b16 v[176:177], v15 offset:6144
    ds_read_b64_tr_b16 v[178:179], v15 offset:7168
    s_waitcnt lgkmcnt(10)
    v_mfma_f32_32x32x16_bf16 v[52:67], a[72:75], v[156:159], v[52:67]
    v_mfma_f32_32x32x16_bf16 v[116:131], a[200:203], v[156:159], v[116:131]
    s_waitcnt lgkmcnt(8)
    v_mfma_f32_32x32x16_bf16 v[68:83], a[72:75], v[160:163], v[68:83]
    v_mfma_f32_32x32x16_bf16 v[132:147], a[200:203], v[160:163], v[132:147]
    s_waitcnt lgkmcnt(6)
    v_mfma_f32_32x32x16_bf16 v[20:35], a[76:79], v[164:167], v[20:35]
    ds_read_b64_tr_b16 v[148:149], v12 offset:16384
    ds_read_b64_tr_b16 v[150:151], v12 offset:17408
    v_mfma_f32_32x32x16_bf16 v[84:99], a[204:207], v[164:167], v[84:99]
    ds_read_b64_tr_b16 v[152:153], v13 offset:16384
    ds_read_b64_tr_b16 v[154:155], v13 offset:17408
    s_waitcnt lgkmcnt(8)
    v_mfma_f32_32x32x16_bf16 v[36:51], a[76:79], v[168:171], v[36:51]
    ds_read_b64_tr_b16 v[156:157], v14 offset:16384
    ds_read_b64_tr_b16 v[158:159], v14 offset:17408
    v_mfma_f32_32x32x16_bf16 v[100:115], a[204:207], v[168:171], v[100:115]
    ds_read_b64_tr_b16 v[160:161], v15 offset:16384
    ds_read_b64_tr_b16 v[162:163], v15 offset:17408
    s_waitcnt lgkmcnt(10)
    v_mfma_f32_32x32x16_bf16 v[52:67], a[76:79], v[172:175], v[52:67]
    v_mfma_f32_32x32x16_bf16 v[116:131], a[204:207], v[172:175], v[116:131]
    s_waitcnt lgkmcnt(8)
    v_mfma_f32_32x32x16_bf16 v[68:83], a[76:79], v[176:179], v[68:83]
    v_mfma_f32_32x32x16_bf16 v[132:147], a[204:207], v[176:179], v[132:147]
    s_waitcnt vmcnt(8)
    s_barrier
    s_waitcnt lgkmcnt(6)
    v_mfma_f32_32x32x16_bf16 v[20:35], a[80:83], v[148:151], v[20:35]
    ds_read_b64_tr_b16 v[164:165], v12 offset:18432
    ds_read_b64_tr_b16 v[166:167], v12 offset:19456
    v_mfma_f32_32x32x16_bf16 v[84:99], a[208:211], v[148:151], v[84:99]
    ds_read_b64_tr_b16 v[168:169], v13 offset:18432
    ds_read_b64_tr_b16 v[170:171], v13 offset:19456
    s_waitcnt lgkmcnt(8)
    v_mfma_f32_32x32x16_bf16 v[36:51], a[80:83], v[152:155], v[36:51]
    ds_read_b64_tr_b16 v[172:173], v14 offset:18432
    ds_read_b64_tr_b16 v[174:175], v14 offset:19456
    v_mfma_f32_32x32x16_bf16 v[100:115], a[208:211], v[152:155], v[100:115]
    ds_read_b64_tr_b16 v[176:177], v15 offset:18432
    ds_read_b64_tr_b16 v[178:179], v15 offset:19456
    s_waitcnt lgkmcnt(10)
    v_mfma_f32_32x32x16_bf16 v[52:67], a[80:83], v[156:159], v[52:67]
    v_mfma_f32_32x32x16_bf16 v[116:131], a[208:211], v[156:159], v[116:131]
    s_waitcnt lgkmcnt(8)
    v_mfma_f32_32x32x16_bf16 v[68:83], a[80:83], v[160:163], v[68:83]
    v_mfma_f32_32x32x16_bf16 v[132:147], a[208:211], v[160:163], v[132:147]
    s_waitcnt lgkmcnt(6)
    v_mfma_f32_32x32x16_bf16 v[20:35], a[84:87], v[164:167], v[20:35]
    ds_read_b64_tr_b16 v[148:149], v12 offset:20480
    ds_read_b64_tr_b16 v[150:151], v12 offset:21504
    v_mfma_f32_32x32x16_bf16 v[84:99], a[212:215], v[164:167], v[84:99]
    ds_read_b64_tr_b16 v[152:153], v13 offset:20480
    ds_read_b64_tr_b16 v[154:155], v13 offset:21504
    s_waitcnt lgkmcnt(8)
    v_mfma_f32_32x32x16_bf16 v[36:51], a[84:87], v[168:171], v[36:51]
    ds_read_b64_tr_b16 v[156:157], v14 offset:20480
    ds_read_b64_tr_b16 v[158:159], v14 offset:21504
    v_mfma_f32_32x32x16_bf16 v[100:115], a[212:215], v[168:171], v[100:115]
    ds_read_b64_tr_b16 v[160:161], v15 offset:20480
    ds_read_b64_tr_b16 v[162:163], v15 offset:21504
    s_waitcnt lgkmcnt(10)
    v_mfma_f32_32x32x16_bf16 v[52:67], a[84:87], v[172:175], v[52:67]
    v_mfma_f32_32x32x16_bf16 v[116:131], a[212:215], v[172:175], v[116:131]
    s_waitcnt lgkmcnt(8)
    v_mfma_f32_32x32x16_bf16 v[68:83], a[84:87], v[176:179], v[68:83]
    v_mfma_f32_32x32x16_bf16 v[132:147], a[212:215], v[176:179], v[132:147]
    s_waitcnt lgkmcnt(6)
    v_mfma_f32_32x32x16_bf16 v[20:35], a[88:91], v[148:151], v[20:35]
    ds_read_b64_tr_b16 v[164:165], v12 offset:22528
    ds_read_b64_tr_b16 v[166:167], v12 offset:23552
    v_mfma_f32_32x32x16_bf16 v[84:99], a[216:219], v[148:151], v[84:99]
    ds_read_b64_tr_b16 v[168:169], v13 offset:22528
    ds_read_b64_tr_b16 v[170:171], v13 offset:23552
    s_waitcnt lgkmcnt(8)
    v_mfma_f32_32x32x16_bf16 v[36:51], a[88:91], v[152:155], v[36:51]
    ds_read_b64_tr_b16 v[172:173], v14 offset:22528
    ds_read_b64_tr_b16 v[174:175], v14 offset:23552
    v_mfma_f32_32x32x16_bf16 v[100:115], a[216:219], v[152:155], v[100:115]
    ds_read_b64_tr_b16 v[176:177], v15 offset:22528
    ds_read_b64_tr_b16 v[178:179], v15 offset:23552
    s_waitcnt lgkmcnt(10)
    v_mfma_f32_32x32x16_bf16 v[52:67], a[88:91], v[156:159], v[52:67]
    v_mfma_f32_32x32x16_bf16 v[116:131], a[216:219], v[156:159], v[116:131]
    s_waitcnt lgkmcnt(8)
    v_mfma_f32_32x32x16_bf16 v[68:83], a[88:91], v[160:163], v[68:83]
    v_mfma_f32_32x32x16_bf16 v[132:147], a[216:219], v[160:163], v[132:147]
    s_waitcnt lgkmcnt(6)
    v_mfma_f32_32x32x16_bf16 v[20:35], a[92:95], v[164:167], v[20:35]
    ds_read_b64_tr_b16 v[148:149], v12 offset:32768
    ds_read_b64_tr_b16 v[150:151], v12 offset:33792
    v_mfma_f32_32x32x16_bf16 v[84:99], a[220:223], v[164:167], v[84:99]
    ds_read_b64_tr_b16 v[152:153], v13 offset:32768
    ds_read_b64_tr_b16 v[154:155], v13 offset:33792
    s_waitcnt lgkmcnt(8)
    v_mfma_f32_32x32x16_bf16 v[36:51], a[92:95], v[168:171], v[36:51]
    ds_read_b64_tr_b16 v[156:157], v14 offset:32768
    ds_read_b64_tr_b16 v[158:159], v14 offset:33792
    v_mfma_f32_32x32x16_bf16 v[100:115], a[220:223], v[168:171], v[100:115]
    ds_read_b64_tr_b16 v[160:161], v15 offset:32768
    ds_read_b64_tr_b16 v[162:163], v15 offset:33792
    s_waitcnt lgkmcnt(10)
    v_mfma_f32_32x32x16_bf16 v[52:67], a[92:95], v[172:175], v[52:67]
    v_mfma_f32_32x32x16_bf16 v[116:131], a[220:223], v[172:175], v[116:131]
    s_waitcnt lgkmcnt(8)
    v_mfma_f32_32x32x16_bf16 v[68:83], a[92:95], v[176:179], v[68:83]
    v_mfma_f32_32x32x16_bf16 v[132:147], a[220:223], v[176:179], v[132:147]
    s_waitcnt vmcnt(0)
    s_barrier
    s_waitcnt lgkmcnt(6)
    v_mfma_f32_32x32x16_bf16 v[20:35], a[96:99], v[148:151], v[20:35]
    ds_read_b64_tr_b16 v[164:165], v12 offset:34816
    ds_read_b64_tr_b16 v[166:167], v12 offset:35840
    v_mfma_f32_32x32x16_bf16 v[84:99], a[224:227], v[148:151], v[84:99]
    ds_read_b64_tr_b16 v[168:169], v13 offset:34816
    ds_read_b64_tr_b16 v[170:171], v13 offset:35840
    s_waitcnt lgkmcnt(8)
    v_mfma_f32_32x32x16_bf16 v[36:51], a[96:99], v[152:155], v[36:51]
    ds_read_b64_tr_b16 v[172:173], v14 offset:34816
    ds_read_b64_tr_b16 v[174:175], v14 offset:35840
    v_mfma_f32_32x32x16_bf16 v[100:115], a[224:227], v[152:155], v[100:115]
    ds_read_b64_tr_b16 v[176:177], v15 offset:34816
    ds_read_b64_tr_b16 v[178:179], v15 offset:35840
    s_waitcnt lgkmcnt(10)
    v_mfma_f32_32x32x16_bf16 v[52:67], a[96:99], v[156:159], v[52:67]
    v_mfma_f32_32x32x16_bf16 v[116:131], a[224:227], v[156:159], v[116:131]
    s_waitcnt lgkmcnt(8)
    v_mfma_f32_32x32x16_bf16 v[68:83], a[96:99], v[160:163], v[68:83]
    v_mfma_f32_32x32x16_bf16 v[132:147], a[224:227], v[160:163], v[132:147]
    s_waitcnt lgkmcnt(6)
    v_mfma_f32_32x32x16_bf16 v[20:35], a[100:103], v[164:167], v[20:35]
    ds_read_b64_tr_b16 v[148:149], v12 offset:36864
    ds_read_b64_tr_b16 v[150:151], v12 offset:37888
    v_mfma_f32_32x32x16_bf16 v[84:99], a[228:231], v[164:167], v[84:99]
    ds_read_b64_tr_b16 v[152:153], v13 offset:36864
    ds_read_b64_tr_b16 v[154:155], v13 offset:37888
    s_waitcnt lgkmcnt(8)
    v_mfma_f32_32x32x16_bf16 v[36:51], a[100:103], v[168:171], v[36:51]
    ds_read_b64_tr_b16 v[156:157], v14 offset:36864
    ds_read_b64_tr_b16 v[158:159], v14 offset:37888
    v_mfma_f32_32x32x16_bf16 v[100:115], a[228:231], v[168:171], v[100:115]
    ds_read_b64_tr_b16 v[160:161], v15 offset:36864
    ds_read_b64_tr_b16 v[162:163], v15 offset:37888
    s_waitcnt lgkmcnt(10)
    v_mfma_f32_32x32x16_bf16 v[52:67], a[100:103], v[172:175], v[52:67]
    v_mfma_f32_32x32x16_bf16 v[116:131], a[228:231], v[172:175], v[116:131]
    s_waitcnt lgkmcnt(8)
    v_mfma_f32_32x32x16_bf16 v[68:83], a[100:103], v[176:179], v[68:83]
    v_mfma_f32_32x32x16_bf16 v[132:147], a[228:231], v[176:179], v[132:147]
    s_waitcnt lgkmcnt(6)
    v_mfma_f32_32x32x16_bf16 v[20:35], a[104:107], v[148:151], v[20:35]
    ds_read_b64_tr_b16 v[164:165], v12 offset:38912
    ds_read_b64_tr_b16 v[166:167], v12 offset:39936
    v_mfma_f32_32x32x16_bf16 v[84:99], a[232:235], v[148:151], v[84:99]
    ds_read_b64_tr_b16 v[168:169], v13 offset:38912
    ds_read_b64_tr_b16 v[170:171], v13 offset:39936
    s_waitcnt lgkmcnt(8)
    v_mfma_f32_32x32x16_bf16 v[36:51], a[104:107], v[152:155], v[36:51]
    ds_read_b64_tr_b16 v[172:173], v14 offset:38912
    ds_read_b64_tr_b16 v[174:175], v14 offset:39936
    v_mfma_f32_32x32x16_bf16 v[100:115], a[232:235], v[152:155], v[100:115]
    ds_read_b64_tr_b16 v[176:177], v15 offset:38912
    ds_read_b64_tr_b16 v[178:179], v15 offset:39936
    s_waitcnt lgkmcnt(10)
    v_mfma_f32_32x32x16_bf16 v[52:67], a[104:107], v[156:159], v[52:67]
    v_mfma_f32_32x32x16_bf16 v[116:131], a[232:235], v[156:159], v[116:131]
    s_waitcnt lgkmcnt(8)
    v_mfma_f32_32x32x16_bf16 v[68:83], a[104:107], v[160:163], v[68:83]
    v_mfma_f32_32x32x16_bf16 v[132:147], a[232:235], v[160:163], v[132:147]
    s_waitcnt lgkmcnt(6)
    v_mfma_f32_32x32x16_bf16 v[20:35], a[108:111], v[164:167], v[20:35]
    ds_read_b64_tr_b16 v[148:149], v12 offset:49152
    ds_read_b64_tr_b16 v[150:151], v12 offset:50176
    v_mfma_f32_32x32x16_bf16 v[84:99], a[236:239], v[164:167], v[84:99]
    ds_read_b64_tr_b16 v[152:153], v13 offset:49152
    ds_read_b64_tr_b16 v[154:155], v13 offset:50176
    s_waitcnt lgkmcnt(8)
    v_mfma_f32_32x32x16_bf16 v[36:51], a[108:111], v[168:171], v[36:51]
    ds_read_b64_tr_b16 v[156:157], v14 offset:49152
    ds_read_b64_tr_b16 v[158:159], v14 offset:50176
    v_mfma_f32_32x32x16_bf16 v[100:115], a[236:239], v[168:171], v[100:115]
    ds_read_b64_tr_b16 v[160:161], v15 offset:49152
    ds_read_b64_tr_b16 v[162:163], v15 offset:50176
    s_waitcnt lgkmcnt(10)
    v_mfma_f32_32x32x16_bf16 v[52:67], a[108:111], v[172:175], v[52:67]
    v_mfma_f32_32x32x16_bf16 v[116:131], a[236:239], v[172:175], v[116:131]
    s_waitcnt lgkmcnt(8)
    v_mfma_f32_32x32x16_bf16 v[68:83], a[108:111], v[176:179], v[68:83]
    v_mfma_f32_32x32x16_bf16 v[132:147], a[236:239], v[176:179], v[132:147]
    s_waitcnt lgkmcnt(6)
    v_mfma_f32_32x32x16_bf16 v[20:35], a[112:115], v[148:151], v[20:35]
    ds_read_b64_tr_b16 v[164:165], v12 offset:51200
    ds_read_b64_tr_b16 v[166:167], v12 offset:52224
    v_mfma_f32_32x32x16_bf16 v[84:99], a[240:243], v[148:151], v[84:99]
    ds_read_b64_tr_b16 v[168:169], v13 offset:51200
    ds_read_b64_tr_b16 v[170:171], v13 offset:52224
    s_waitcnt lgkmcnt(8)
    v_mfma_f32_32x32x16_bf16 v[36:51], a[112:115], v[152:155], v[36:51]
    ds_read_b64_tr_b16 v[172:173], v14 offset:51200
    ds_read_b64_tr_b16 v[174:175], v14 offset:52224
    v_mfma_f32_32x32x16_bf16 v[100:115], a[240:243], v[152:155], v[100:115]
    ds_read_b64_tr_b16 v[176:177], v15 offset:51200
    ds_read_b64_tr_b16 v[178:179], v15 offset:52224
    s_waitcnt lgkmcnt(10)
    v_mfma_f32_32x32x16_bf16 v[52:67], a[112:115], v[156:159], v[52:67]
    v_mfma_f32_32x32x16_bf16 v[116:131], a[240:243], v[156:159], v[116:131]
    s_waitcnt lgkmcnt(8)
    v_mfma_f32_32x32x16_bf16 v[68:83], a[112:115], v[160:163], v[68:83]
    v_mfma_f32_32x32x16_bf16 v[132:147], a[240:243], v[160:163], v[132:147]
    s_waitcnt lgkmcnt(6)
    v_mfma_f32_32x32x16_bf16 v[20:35], a[116:119], v[164:167], v[20:35]
    ds_read_b64_tr_b16 v[148:149], v12 offset:53248
    ds_read_b64_tr_b16 v[150:151], v12 offset:54272
    v_mfma_f32_32x32x16_bf16 v[84:99], a[244:247], v[164:167], v[84:99]
    ds_read_b64_tr_b16 v[152:153], v13 offset:53248
    ds_read_b64_tr_b16 v[154:155], v13 offset:54272
    s_waitcnt lgkmcnt(8)
    v_mfma_f32_32x32x16_bf16 v[36:51], a[116:119], v[168:171], v[36:51]
    ds_read_b64_tr_b16 v[156:157], v14 offset:53248
    ds_read_b64_tr_b16 v[158:159], v14 offset:54272
    v_mfma_f32_32x32x16_bf16 v[100:115], a[244:247], v[168:171], v[100:115]
    ds_read_b64_tr_b16 v[160:161], v15 offset:53248
    ds_read_b64_tr_b16 v[162:163], v15 offset:54272
    s_waitcnt lgkmcnt(10)
    v_mfma_f32_32x32x16_bf16 v[52:67], a[116:119], v[172:175], v[52:67]
    v_mfma_f32_32x32x16_bf16 v[116:131], a[244:247], v[172:175], v[116:131]
    s_waitcnt lgkmcnt(8)
    v_mfma_f32_32x32x16_bf16 v[68:83], a[116:119], v[176:179], v[68:83]
    v_mfma_f32_32x32x16_bf16 v[132:147], a[244:247], v[176:179], v[132:147]
    s_waitcnt lgkmcnt(6)
    v_mfma_f32_32x32x16_bf16 v[20:35], a[120:123], v[148:151], v[20:35]
    ds_read_b64_tr_b16 v[164:165], v12 offset:55296
    ds_read_b64_tr_b16 v[166:167], v12 offset:56320
    v_mfma_f32_32x32x16_bf16 v[84:99], a[248:251], v[148:151], v[84:99]
    ds_read_b64_tr_b16 v[168:169], v13 offset:55296
    ds_read_b64_tr_b16 v[170:171], v13 offset:56320
    s_waitcnt lgkmcnt(8)
    v_mfma_f32_32x32x16_bf16 v[36:51], a[120:123], v[152:155], v[36:51]
    ds_read_b64_tr_b16 v[172:173], v14 offset:55296
    ds_read_b64_tr_b16 v[174:175], v14 offset:56320
    v_mfma_f32_32x32x16_bf16 v[100:115], a[248:251], v[152:155], v[100:115]
    ds_read_b64_tr_b16 v[176:177], v15 offset:55296
    ds_read_b64_tr_b16 v[178:179], v15 offset:56320
    s_waitcnt lgkmcnt(10)
    v_mfma_f32_32x32x16_bf16 v[52:67], a[120:123], v[156:159], v[52:67]
    v_mfma_f32_32x32x16_bf16 v[116:131], a[248:251], v[156:159], v[116:131]
    s_waitcnt lgkmcnt(8)
    v_mfma_f32_32x32x16_bf16 v[68:83], a[120:123], v[160:163], v[68:83]
    v_mfma_f32_32x32x16_bf16 v[132:147], a[248:251], v[160:163], v[132:147]
    s_waitcnt lgkmcnt(6)
    v_mfma_f32_32x32x16_bf16 v[20:35], a[124:127], v[164:167], v[20:35]
    v_mfma_f32_32x32x16_bf16 v[84:99], a[252:255], v[164:167], v[84:99]
    s_waitcnt lgkmcnt(4)
    v_mfma_f32_32x32x16_bf16 v[36:51], a[124:127], v[168:171], v[36:51]
    v_mfma_f32_32x32x16_bf16 v[100:115], a[252:255], v[168:171], v[100:115]
    s_waitcnt lgkmcnt(2)
    v_mfma_f32_32x32x16_bf16 v[52:67], a[124:127], v[172:175], v[52:67]
    v_mfma_f32_32x32x16_bf16 v[116:131], a[252:255], v[172:175], v[116:131]
    s_waitcnt lgkmcnt(0)
    v_mfma_f32_32x32x16_bf16 v[68:83], a[124:127], v[176:179], v[68:83]
    v_mfma_f32_32x32x16_bf16 v[132:147], a[252:255], v[176:179], v[132:147]
    s_nop 7
    s_nop 15
    v_cvt_pk_bf16_f32 v180, v20, v21
    v_cvt_pk_bf16_f32 v181, v22, v23
    v_cvt_pk_bf16_f32 v182, v24, v25
    v_cvt_pk_bf16_f32 v183, v26, v27
    s_nop 1
    v_permlane32_swap_b32 v180, v182
    v_permlane32_swap_b32 v181, v183
    s_add_u32 s53, s58, 0x0
    buffer_store_dwordx4 v[180:183], v16, s[48:51], s53 offen
    v_cvt_pk_bf16_f32 v184, v28, v29
    v_cvt_pk_bf16_f32 v185, v30, v31
    v_cvt_pk_bf16_f32 v186, v32, v33
    v_cvt_pk_bf16_f32 v187, v34, v35
    s_nop 1
    v_permlane32_swap_b32 v184, v186
    v_permlane32_swap_b32 v185, v187
    s_add_u32 s53, s58, 0x400
    buffer_store_dwordx4 v[184:187], v16, s[48:51], s53 offen
    v_cvt_pk_bf16_f32 v212, v84, v85
    v_cvt_pk_bf16_f32 v213, v86, v87
    v_cvt_pk_bf16_f32 v214, v88, v89
    v_cvt_pk_bf16_f32 v215, v90, v91
    s_nop 1
    v_permlane32_swap_b32 v212, v214
    v_permlane32_swap_b32 v213, v215
    s_add_u32 s53, s58, 0x800
    buffer_store_dwordx4 v[212:215], v16, s[48:51], s53 offen
    v_cvt_pk_bf16_f32 v216, v92, v93
    v_cvt_pk_bf16_f32 v217, v94, v95
    v_cvt_pk_bf16_f32 v218, v96, v97
    v_cvt_pk_bf16_f32 v219, v98, v99
    s_nop 1
    v_permlane32_swap_b32 v216, v218
    v_permlane32_swap_b32 v217, v219
    s_add_u32 s53, s58, 0xc00
    buffer_store_dwordx4 v[216:219], v16, s[48:51], s53 offen
    v_cvt_pk_bf16_f32 v188, v36, v37
    v_cvt_pk_bf16_f32 v189, v38, v39
    v_cvt_pk_bf16_f32 v190, v40, v41
    v_cvt_pk_bf16_f32 v191, v42, v43
    s_nop 1
    v_permlane32_swap_b32 v188, v190
    v_permlane32_swap_b32 v189, v191
    s_add_u32 s53, s58, 0x20000
    buffer_store_dwordx4 v[188:191], v16, s[48:51], s53 offen
    v_cvt_pk_bf16_f32 v192, v44, v45
    v_cvt_pk_bf16_f32 v193, v46, v47
    v_cvt_pk_bf16_f32 v194, v48, v49
    v_cvt_pk_bf16_f32 v195, v50, v51
    s_nop 1
    v_permlane32_swap_b32 v192, v194
    v_permlane32_swap_b32 v193, v195
    s_add_u32 s53, s58, 0x20400
    buffer_store_dwordx4 v[192:195], v16, s[48:51], s53 offen
    v_cvt_pk_bf16_f32 v220, v100, v101
    v_cvt_pk_bf16_f32 v221, v102, v103
    v_cvt_pk_bf16_f32 v222, v104, v105
    v_cvt_pk_bf16_f32 v223, v106, v107
    s_nop 1
    v_permlane32_swap_b32 v220, v222
    v_permlane32_swap_b32 v221, v223
    s_add_u32 s53, s58, 0x20800
    buffer_store_dwordx4 v[220:223], v16, s[48:51], s53 offen
    v_cvt_pk_bf16_f32 v224, v108, v109
    v_cvt_pk_bf16_f32 v225, v110, v111
    v_cvt_pk_bf16_f32 v226, v112, v113
    v_cvt_pk_bf16_f32 v227, v114, v115
    s_nop 1
    v_permlane32_swap_b32 v224, v226
    v_permlane32_swap_b32 v225, v227
    s_add_u32 s53, s58, 0x20c00
    buffer_store_dwordx4 v[224:227], v16, s[48:51], s53 offen
    v_cvt_pk_bf16_f32 v196, v52, v53
    v_cvt_pk_bf16_f32 v197, v54, v55
    v_cvt_pk_bf16_f32 v198, v56, v57
    v_cvt_pk_bf16_f32 v199, v58, v59
    s_nop 1
    v_permlane32_swap_b32 v196, v198
    v_permlane32_swap_b32 v197, v199
    s_add_u32 s53, s58, 0x40000
    buffer_store_dwordx4 v[196:199], v16, s[48:51], s53 offen
    v_cvt_pk_bf16_f32 v200, v60, v61
    v_cvt_pk_bf16_f32 v201, v62, v63
    v_cvt_pk_bf16_f32 v202, v64, v65
    v_cvt_pk_bf16_f32 v203, v66, v67
    s_nop 1
    v_permlane32_swap_b32 v200, v202
    v_permlane32_swap_b32 v201, v203
    s_add_u32 s53, s58, 0x40400
    buffer_store_dwordx4 v[200:203], v16, s[48:51], s53 offen
    v_cvt_pk_bf16_f32 v228, v116, v117
    v_cvt_pk_bf16_f32 v229, v118, v119
    v_cvt_pk_bf16_f32 v230, v120, v121
    v_cvt_pk_bf16_f32 v231, v122, v123
    s_nop 1
    v_permlane32_swap_b32 v228, v230
    v_permlane32_swap_b32 v229, v231
    s_add_u32 s53, s58, 0x40800
    buffer_store_dwordx4 v[228:231], v16, s[48:51], s53 offen
    v_cvt_pk_bf16_f32 v232, v124, v125
    v_cvt_pk_bf16_f32 v233, v126, v127
    v_cvt_pk_bf16_f32 v234, v128, v129
    v_cvt_pk_bf16_f32 v235, v130, v131
    s_nop 1
    v_permlane32_swap_b32 v232, v234
    v_permlane32_swap_b32 v233, v235
    s_add_u32 s53, s58, 0x40c00
    buffer_store_dwordx4 v[232:235], v16, s[48:51], s53 offen
    v_cvt_pk_bf16_f32 v204, v68, v69
    v_cvt_pk_bf16_f32 v205, v70, v71
    v_cvt_pk_bf16_f32 v206, v72, v73
    v_cvt_pk_bf16_f32 v207, v74, v75
    s_nop 1
    v_permlane32_swap_b32 v204, v206
    v_permlane32_swap_b32 v205, v207
    s_add_u32 s53, s58, 0x60000
    buffer_store_dwordx4 v[204:207], v16, s[48:51], s53 offen
    v_cvt_pk_bf16_f32 v208, v76, v77
    v_cvt_pk_bf16_f32 v209, v78, v79
    v_cvt_pk_bf16_f32 v210, v80, v81
    v_cvt_pk_bf16_f32 v211, v82, v83
    s_nop 1
    v_permlane32_swap_b32 v208, v210
    v_permlane32_swap_b32 v209, v211
    s_add_u32 s53, s58, 0x60400
    buffer_store_dwordx4 v[208:211], v16, s[48:51], s53 offen
    v_cvt_pk_bf16_f32 v236, v132, v133
    v_cvt_pk_bf16_f32 v237, v134, v135
    v_cvt_pk_bf16_f32 v238, v136, v137
    v_cvt_pk_bf16_f32 v239, v138, v139
    s_nop 1
    v_permlane32_swap_b32 v236, v238
    v_permlane32_swap_b32 v237, v239
    s_add_u32 s53, s58, 0x60800
    buffer_store_dwordx4 v[236:239], v16, s[48:51], s53 offen
    v_cvt_pk_bf16_f32 v240, v140, v141
    v_cvt_pk_bf16_f32 v241, v142, v143
    v_cvt_pk_bf16_f32 v242, v144, v145
    v_cvt_pk_bf16_f32 v243, v146, v147
    s_nop 1
    v_permlane32_swap_b32 v240, v242
    v_permlane32_swap_b32 v241, v243
    s_add_u32 s53, s58, 0x60c00
    buffer_store_dwordx4 v[240:243], v16, s[48:51], s53 offen
proj_kernel_end:
    s_endpgm

.globl projb_kernel
.p2align 8
.type projb_kernel,@function
projb_kernel:
    s_cmp_ge_u32 s2, 32
    s_cbranch_scc1 projb_kernel_pre0
    s_load_dwordx2 s[4:5], s[0:1], 0
    s_load_dwordx2 s[6:7], s[0:1], 8
    s_load_dwordx2 s[8:9], s[0:1], 56
    s_load_dwordx2 s[10:11], s[0:1], 24
    s_load_dwordx2 s[12:13], s[0:1], 32
    s_load_dwordx2 s[14:15], s[0:1], 112
    s_lshr_b32 s16, s2, 2
    s_and_b32 s17, s2, 3
    v_lshrrev_b32 v180, 6, v0
    v_and_b32 v183, 63, v0
    v_and_b32 v181, 31, v0
    v_lshrrev_b32 v182, 5, v183
    s_nop 1
    v_readfirstlane_b32 s18, v180
    s_waitcnt lgkmcnt(0)
    s_mov_b32 s20, s4
    s_mov_b32 s21, s5
    s_mov_b32 s22, 0x200000
    s_mov_b32 s23, 0x00020000
    s_mov_b32 s24, s6
    s_mov_b32 s25, s7
    s_mov_b32 s26, 0x200000
    s_mov_b32 s27, 0x00020000
    s_mov_b32 s28, s8
    s_mov_b32 s29, s9
    s_mov_b32 s30, 0x80000
    s_mov_b32 s31, 0x00020000
    s_mov_b32 s32, s10
    s_mov_b32 s33, s11
    s_mov_b32 s34, 0x80000
    s_mov_b32 s35, 0x00020000
    s_mov_b32 s36, s12
    s_mov_b32 s37, s13
    s_mov_b32 s38, 0x80000
    s_mov_b32 s39, 0x00020000
    s_add_u32 s40, s14, 0x4000000
    s_addc_u32 s41, s15, 0x0
    s_mov_b32 s42, 0x200000
    s_mov_b32 s43, 0x00020000
    s_add_u32 s44, s14, 0x4000000
    s_addc_u32 s45, s15, 0x0
    s_mov_b32 s46, 0x200000
    s_mov_b32 s47, 0x00020000
    s_add_u32 s48, s14, 0x4000000
    s_addc_u32 s49, s15, 0x0
    s_mov_b32 s50, 0x200000
    s_mov_b32 s51, 0x00020000
    v_lshrrev_b32 v184, 4, v183
    v_lshlrev_b32 v185, 2, v184
    v_and_b32 v1, 15, v183
    v_xor_b32 v1, v1, v185
    v_lshlrev_b32 v1, 4, v1
    v_lshlrev_b32 v184, 10, v184
    v_add_u32 v1, v1, v184
    v_lshrrev_b32 v184, 4, v183
    v_add_u32 v184, 0, v184
    v_and_b32 v184, 7, v184
    v_and_b32 v185, 7, v183
    v_xor_b32 v184, v184, v185
    v_lshlrev_b32 v184, 4, v184
    v_lshrrev_b32 v185, 3, v183
    v_lshlrev_b32 v185, 10, v185
    v_add_u32 v2, v184, v185
    v_lshrrev_b32 v184, 4, v183
    v_add_u32 v184, 4, v184
    v_and_b32 v184, 7, v184
    v_and_b32 v185, 7, v183
    v_xor_b32 v184, v184, v185
    v_lshlrev_b32 v184, 4, v184
    v_lshrrev_b32 v185, 3, v183
    v_lshlrev_b32 v185, 10, v185
    v_add_u32 v3, v184, v185
    v_lshlrev_b32 v184, 6, v180
    v_add_u32 v184, v184, v181
    v_lshlrev_b32 v184, 7, v184
    v_lshrrev_b32 v185, 1, v181
    v_and_b32 v185, 7, v185
    v_lshlrev_b32 v186, 2, v182
    v_add_u32 v4, 0, v186
    v_xor_b32 v4, v4, v185
    v_lshlrev_b32 v4, 4, v4
    v_add_u32 v4, v4, v184
    v_add_u32 v4, 65536, v4
    v_add_u32 v5, 1, v186
    v_xor_b32 v5, v5, v185
    v_lshlrev_b32 v5, 4, v5
    v_add_u32 v5, v5, v184
    v_add_u32 v5, 65536, v5
    v_add_u32 v6, 2, v186
    v_xor_b32 v6, v6, v185
    v_lshlrev_b32 v6, 4, v6
    v_add_u32 v6, v6, v184
    v_add_u32 v6, 65536, v6
    v_add_u32 v7, 3, v186
    v_xor_b32 v7, v7, v185
    v_lshlrev_b32 v7, 4, v7
    v_add_u32 v7, v7, v184
    v_add_u32 v7, 65536, v7
    v_add_u32 v8, 65536, v4
    v_add_u32 v9, 65536, v5
    v_add_u32 v10, 65536, v6
    v_add_u32 v11, 65536, v7
    s_lshl_b32 s52, s18, 14
    s_lshl_b32 s53, s17, 8
    s_add_u32 s52, s52, s53
    s_lshl_b32 s54, s18, 12
    s_lshl_b32 s55, s16, 8
    s_lshl_b32 s53, s18, 6
    s_add_u32 s55, s55, s53
    s_lshl_b32 s55, s55, 10
    s_lshl_b32 s56, s18, 13
    s_lshl_b32 s57, s17, 9
    s_lshl_b32 s53, s16, 3
    s_add_u32 s57, s57, s53
    s_lshl_b32 s53, s18, 1
    s_add_u32 s57, s57, s53
    s_lshl_b32 s57, s57, 10
    s_lshl_b32 s58, s17, 9
    s_lshl_b32 s53, s16, 4
    s_add_u32 s58, s58, s53
    s_lshl_b32 s53, s18, 2
    s_add_u32 s58, s58, s53
    s_lshl_b32 s58, s58, 10
    v_lshrrev_b32 v187, 4, v183
    v_and_b32 v188, 15, v183
    v_lshrrev_b32 v188, 2, v188
    v_lshrrev_b32 v184, 1, v187
    v_lshlrev_b32 v184, 5, v184
    v_add_u32 v184, v184, v188
    v_lshlrev_b32 v184, 8, v184
    v_and_b32 v185, 1, v187
    v_lshlrev_b32 v185, 5, v185
    v_add_u32 v184, v184, v185
    v_and_b32 v185, 3, v183
    v_lshlrev_b32 v185, 3, v185
    v_add_u32 v184, v184, v185
    v_xor_b32 v185, 0, v188
    v_lshlrev_b32 v185, 6, v185
    v_add_u32 v12, v184, v185
    v_xor_b32 v185, 1, v188
    v_lshlrev_b32 v185, 6, v185
    v_add_u32 v13, v184, v185
    v_xor_b32 v185, 2, v188
    v_lshlrev_b32 v185, 6, v185
    v_add_u32 v14, v184, v185
    v_xor_b32 v185, 3, v188
    v_lshlrev_b32 v185, 6, v185
    v_add_u32 v15, v184, v185
    v_lshlrev_b32 v16, 4, v183
    s_add_u32 s53, s55, 0x0
    s_add_u32 m0, s56, 0x10000
    buffer_load_dwordx4 v2, s[20:23], s53 offen lds
    s_add_u32 s53, s55, 0x2000
    s_add_u32 m0, s56, 0x10400
    buffer_load_dwordx4 v3, s[20:23], s53 offen lds
    s_add_u32 s53, s55, 0x4000
    s_add_u32 m0, s56, 0x10800
    buffer_load_dwordx4 v2, s[20:23], s53 offen lds
    s_add_u32 s53, s55, 0x6000
    s_add_u32 m0, s56, 0x10c00
    buffer_load_dwordx4 v3, s[20:23], s53 offen lds
    s_add_u32 s53, s55, 0x8000
    s_add_u32 m0, s56, 0x11000
    buffer_load_dwordx4 v2, s[20:23], s53 offen lds
    s_add_u32 s53, s55, 0xa000
    s_add_u32 m0, s56, 0x11400
    buffer_load_dwordx4 v3, s[20:23], s53 offen lds
    s_add_u32 s53, s55, 0xc000
    s_add_u32 m0, s56, 0x11800
    buffer_load_dwordx4 v2, s[20:23], s53 offen lds
    s_add_u32 s53, s55, 0xe000
    s_add_u32 m0, s56, 0x11c00
    buffer_load_dwordx4 v3, s[20:23], s53 offen lds
    s_add_u32 s53, s52, 0x0
    s_add_u32 m0, s54, 0x0
    buffer_load_dwordx4 v1, s[28:31], s53 offen lds
    s_add_u32 s53, s52, 0x1000
    s_add_u32 m0, s54, 0x400
    buffer_load_dwordx4 v1, s[28:31], s53 offen lds
    s_add_u32 s53, s52, 0x2000
    s_add_u32 m0, s54, 0x800
    buffer_load_dwordx4 v1, s[28:31], s53 offen lds
    s_add_u32 s53, s52, 0x3000
    s_add_u32 m0, s54, 0xc00
    buffer_load_dwordx4 v1, s[28:31], s53 offen lds
    s_add_u32 s53, s55, 0x80
    s_add_u32 m0, s56, 0x18000
    buffer_load_dwordx4 v2, s[20:23], s53 offen lds
    s_add_u32 s53, s55, 0x2080
    s_add_u32 m0, s56, 0x18400
    buffer_load_dwordx4 v3, s[20:23], s53 offen lds
    s_add_u32 s53, s55, 0x4080
    s_add_u32 m0, s56, 0x18800
    buffer_load_dwordx4 v2, s[20:23], s53 offen lds
    s_add_u32 s53, s55, 0x6080
    s_add_u32 m0, s56, 0x18c00
    buffer_load_dwordx4 v3, s[20:23], s53 offen lds
    s_add_u32 s53, s55, 0x8080
    s_add_u32 m0, s56, 0x19000
    buffer_load_dwordx4 v2, s[20:23], s53 offen lds
    s_add_u32 s53, s55, 0xa080
    s_add_u32 m0, s56, 0x19400
    buffer_load_dwordx4 v3, s[20:23], s53 offen lds
    s_add_u32 s53, s55, 0xc080
    s_add_u32 m0, s56, 0x19800
    buffer_load_dwordx4 v2, s[20:23], s53 offen lds
    s_add_u32 s53, s55, 0xe080
    s_add_u32 m0, s56, 0x19c00
    buffer_load_dwordx4 v3, s[20:23], s53 offen lds
    s_add_u32 s53, s52, 0x10000
    s_add_u32 m0, s54, 0x4000
    buffer_load_dwordx4 v1, s[28:31], s53 offen lds
    s_add_u32 s53, s52, 0x11000
    s_add_u32 m0, s54, 0x4400
    buffer_load_dwordx4 v1, s[28:31], s53 offen lds
    s_add_u32 s53, s52, 0x12000
    s_add_u32 m0, s54, 0x4800
    buffer_load_dwordx4 v1, s[28:31], s53 offen lds
    s_add_u32 s53, s52, 0x13000
    s_add_u32 m0, s54, 0x4c00
    buffer_load_dwordx4 v1, s[28:31], s53 offen lds
    s_add_u32 s53, s55, 0x100
    s_add_u32 m0, s56, 0x20000
    buffer_load_dwordx4 v2, s[20:23], s53 offen lds
    s_add_u32 s53, s55, 0x2100
    s_add_u32 m0, s56, 0x20400
    buffer_load_dwordx4 v3, s[20:23], s53 offen lds
    s_add_u32 s53, s55, 0x4100
    s_add_u32 m0, s56, 0x20800
    buffer_load_dwordx4 v2, s[20:23], s53 offen lds
    s_add_u32 s53, s55, 0x6100
    s_add_u32 m0, s56, 0x20c00
    buffer_load_dwordx4 v3, s[20:23], s53 offen lds
    s_add_u32 s53, s55, 0x8100
    s_add_u32 m0, s56, 0x21000
    buffer_load_dwordx4 v2, s[20:23], s53 offen lds
    s_add_u32 s53, s55, 0xa100
    s_add_u32 m0, s56, 0x21400
    buffer_load_dwordx4 v3, s[20:23], s53 offen lds
    s_add_u32 s53, s55, 0xc100
    s_add_u32 m0, s56, 0x21800
    buffer_load_dwordx4 v2, s[20:23], s53 offen lds
    s_add_u32 s53, s55, 0xe100
    s_add_u32 m0, s56, 0x21c00
    buffer_load_dwordx4 v3, s[20:23], s53 offen lds
    s_add_u32 s53, s52, 0x20000
    s_add_u32 m0, s54, 0x8000
    buffer_load_dwordx4 v1, s[28:31], s53 offen lds
    s_add_u32 s53, s52, 0x21000
    s_add_u32 m0, s54, 0x8400
    buffer_load_dwordx4 v1, s[28:31], s53 offen lds
    s_add_u32 s53, s52, 0x22000
    s_add_u32 m0, s54, 0x8800
    buffer_load_dwordx4 v1, s[28:31], s53 offen lds
    s_add_u32 s53, s52, 0x23000
    s_add_u32 m0, s54, 0x8c00
    buffer_load_dwordx4 v1, s[28:31], s53 offen lds
    s_waitcnt vmcnt(24)
    s_barrier
    ds_read_b64_tr_b16 v[148:149], v12 offset:0
    ds_read_b64_tr_b16 v[150:151], v12 offset:1024
    ds_read_b64_tr_b16 v[152:153], v13 offset:0
    ds_read_b64_tr_b16 v[154:155], v13 offset:1024
    ds_read_b64_tr_b16 v[156:157], v14 offset:0
    ds_read_b64_tr_b16 v[158:159], v14 offset:1024
    ds_read_b64_tr_b16 v[160:161], v15 offset:0
    ds_read_b64_tr_b16 v[162:163], v15 offset:1024
    ds_read_b128 a[0:3], v4 offset:0
    ds_read_b128 a[4:7], v5 offset:0
    ds_read_b128 a[8:11], v6 offset:0
    ds_read_b128 a[12:15], v7 offset:0
    ds_read_b128 a[128:131], v4 offset:4096
    ds_read_b128 a[132:135], v5 offset:4096
    ds_read_b128 a[136:139], v6 offset:4096
    ds_read_b128 a[140:143], v7 offset:4096
    s_waitcnt lgkmcnt(11)
    s_waitcnt vmcnt(12)
    s_barrier
    s_waitcnt lgkmcnt(7)
    v_mfma_f32_32x32x16_bf16 v[20:35], v[148:151], a[0:3], 0
    ds_read_b64_tr_b16 v[164:165], v12 offset:2048
    ds_read_b64_tr_b16 v[166:167], v12 offset:3072
    s_waitcnt lgkmcnt(5)
    v_mfma_f32_32x32x16_bf16 v[84:99], v[148:151], a[128:131], 0
    ds_read_b64_tr_b16 v[168:169], v13 offset:2048
    ds_read_b64_tr_b16 v[170:171], v13 offset:3072
    v_mfma_f32_32x32x16_bf16 v[36:51], v[152:155], a[0:3], 0
    ds_read_b64_tr_b16 v[172:173], v14 offset:2048
    ds_read_b64_tr_b16 v[174:175], v14 offset:3072
    v_mfma_f32_32x32x16_bf16 v[100:115], v[152:155], a[128:131], 0
    ds_read_b64_tr_b16 v[176:177], v15 offset:2048
    ds_read_b64_tr_b16 v[178:179], v15 offset:3072
    v_mfma_f32_32x32x16_bf16 v[52:67], v[156:159], a[0:3], 0
    ds_read_b128 a[16:19], v4 offset:32768
    v_mfma_f32_32x32x16_bf16 v[116:131], v[156:159], a[128:131], 0
    ds_read_b128 a[20:23], v5 offset:32768
    v_mfma_f32_32x32x16_bf16 v[68:83], v[160:163], a[0:3], 0
    ds_read_b128 a[24:27], v6 offset:32768
    v_mfma_f32_32x32x16_bf16 v[132:147], v[160:163], a[128:131], 0
    ds_read_b128 a[28:31], v7 offset:32768
    s_waitcnt lgkmcnt(10)
    v_mfma_f32_32x32x16_bf16 v[20:35], v[164:167], a[4:7], v[20:35]
    ds_read_b64_tr_b16 v[148:149], v12 offset:4096
    ds_read_b64_tr_b16 v[150:151], v12 offset:5120
    v_mfma_f32_32x32x16_bf16 v[84:99], v[164:167], a[132:135], v[84:99]
    ds_read_b64_tr_b16 v[152:153], v13 offset:4096
    ds_read_b64_tr_b16 v[154:155], v13 offset:5120
    s_waitcnt lgkmcnt(12)
    v_mfma_f32_32x32x16_bf16 v[36:51], v[168:171], a[4:7], v[36:51]
    ds_read_b64_tr_b16 v[156:157], v14 offset:4096
    ds_read_b64_tr_b16 v[158:159], v14 offset:5120
    v_mfma_f32_32x32x16_bf16 v[100:115], v[168:171], a[132:135], v[100:115]
    ds_read_b64_tr_b16 v[160:161], v15 offset:4096
    ds_read_b64_tr_b16 v[162:163], v15 offset:5120
    s_waitcnt lgkmcnt(11)
    v_mfma_f32_32x32x16_bf16 v[52:67], v[172:175], a[4:7], v[52:67]
    ds_read_b128 a[144:147], v4 offset:36864
    v_mfma_f32_32x32x16_bf16 v[116:131], v[172:175], a[132:135], v[116:131]
    ds_read_b128 a[148:151], v5 offset:36864
    v_mfma_f32_32x32x16_bf16 v[68:83], v[176:179], a[4:7], v[68:83]
    ds_read_b128 a[152:155], v6 offset:36864
    v_mfma_f32_32x32x16_bf16 v[132:147], v[176:179], a[132:135], v[132:147]
    ds_read_b128 a[156:159], v7 offset:36864
    s_waitcnt lgkmcnt(11)
    s_waitcnt lgkmcnt(10)
    v_mfma_f32_32x32x16_bf16 v[20:35], v[148:151], a[8:11], v[20:35]
    ds_read_b64_tr_b16 v[164:165], v12 offset:6144
    ds_read_b64_tr_b16 v[166:167], v12 offset:7168
    ds_read_b64_tr_b16 v[168:169], v13 offset:6144
    ds_read_b64_tr_b16 v[170:171], v13 offset:7168
    v_mfma_f32_32x32x16_bf16 v[84:99], v[148:151], a[136:139], v[84:99]
    ds_read_b64_tr_b16 v[172:173], v14 offset:6144
    ds_read_b64_tr_b16 v[174:175], v14 offset:7168
    s_waitcnt lgkmcnt(11)
    v_mfma_f32_32x32x16_bf16 v[36:51], v[152:155], a[8:11], v[36:51]
    ds_read_b64_tr_b16 v[176:177], v15 offset:6144
    ds_read_b64_tr_b16 v[178:179], v15 offset:7168
    v_mfma_f32_32x32x16_bf16 v[100:115], v[152:155], a[136:139], v[100:115]
    s_add_u32 s53, s55, 0x180
    s_add_u32 m0, s56, 0x10000
    buffer_load_dwordx4 v2, s[20:23], s53 offen lds
    v_mfma_f32_32x32x16_bf16 v[52:67], v[156:159], a[8:11], v[52:67]
    s_add_u32 s53, s55, 0x2180
    s_add_u32 m0, s56, 0x10400
    buffer_load_dwordx4 v3, s[20:23], s53 offen lds
    v_mfma_f32_32x32x16_bf16 v[116:131], v[156:159], a[136:139], v[116:131]
    s_add_u32 s53, s55, 0x4180
    s_add_u32 m0, s56, 0x10800
    buffer_load_dwordx4 v2, s[20:23], s53 offen lds
    s_waitcnt lgkmcnt(12)
    v_mfma_f32_32x32x16_bf16 v[68:83], v[160:163], a[8:11], v[68:83]
    s_add_u32 s53, s55, 0x6180
    s_add_u32 m0, s56, 0x10c00
    buffer_load_dwordx4 v3, s[20:23], s53 offen lds
    v_mfma_f32_32x32x16_bf16 v[132:147], v[160:163], a[136:139], v[132:147]
    s_add_u32 s53, s55, 0x8180
    s_add_u32 m0, s56, 0x11000
    buffer_load_dwordx4 v2, s[20:23], s53 offen lds
    s_waitcnt lgkmcnt(6)
    v_mfma_f32_32x32x16_bf16 v[20:35], v[164:167], a[12:15], v[20:35]
    ds_read_b64_tr_b16 v[148:149], v12 offset:16384
    ds_read_b64_tr_b16 v[150:151], v12 offset:17408
    ds_read_b64_tr_b16 v[152:153], v13 offset:16384
    ds_read_b64_tr_b16 v[154:155], v13 offset:17408
    v_mfma_f32_32x32x16_bf16 v[84:99], v[164:167], a[140:143], v[84:99]
    ds_read_b64_tr_b16 v[156:157], v14 offset:16384
    ds_read_b64_tr_b16 v[158:159], v14 offset:17408
    ds_read_b64_tr_b16 v[160:161], v15 offset:16384
    ds_read_b64_tr_b16 v[162:163], v15 offset:17408
    s_waitcnt lgkmcnt(12)
    v_mfma_f32_32x32x16_bf16 v[36:51], v[168:171], a[12:15], v[36:51]
    s_add_u32 s53, s55, 0xa180
    s_add_u32 m0, s56, 0x11400
    buffer_load_dwordx4 v3, s[20:23], s53 offen lds
    s_add_u32 s53, s55, 0xc180
    s_add_u32 m0, s56, 0x11800
    buffer_load_dwordx4 v2, s[20:23], s53 offen lds
    v_mfma_f32_32x32x16_bf16 v[100:115], v[168:171], a[140:143], v[100:115]
    s_add_u32 s53, s55, 0xe180
    s_add_u32 m0, s56, 0x11c00
    buffer_load_dwordx4 v3, s[20:23], s53 offen lds
    s_add_u32 s53, s52, 0x30000
    s_add_u32 m0, s54, 0xc000
    buffer_load_dwordx4 v1, s[28:31], s53 offen lds
    s_waitcnt lgkmcnt(10)
    v_mfma_f32_32x32x16_bf16 v[52:67], v[172:175], a[12:15], v[52:67]
    s_add_u32 s53, s52, 0x31000
    s_add_u32 m0, s54, 0xc400
    buffer_load_dwordx4 v1, s[28:31], s53 offen lds
    v_mfma_f32_32x32x16_bf16 v[116:131], v[172:175], a[140:143], v[116:131]
    s_add_u32 s53, s52, 0x32000
    s_add_u32 m0, s54, 0xc800
    buffer_load_dwordx4 v1, s[28:31], s53 offen lds
    s_waitcnt lgkmcnt(8)
    v_mfma_f32_32x32x16_bf16 v[68:83], v[176:179], a[12:15], v[68:83]
    s_add_u32 s53, s52, 0x33000
    s_add_u32 m0, s54, 0xcc00
    buffer_load_dwordx4 v1, s[28:31], s53 offen lds
    v_mfma_f32_32x32x16_bf16 v[132:147], v[176:179], a[140:143], v[132:147]
    s_waitcnt vmcnt(12)
    s_barrier
    s_waitcnt lgkmcnt(6)
    v_mfma_f32_32x32x16_bf16 v[20:35], v[148:151], a[16:19], v[20:35]
    ds_read_b64_tr_b16 v[164:165], v12 offset:18432
    ds_read_b64_tr_b16 v[166:167], v12 offset:19456
    v_mfma_f32_32x32x16_bf16 v[84:99], v[148:151], a[144:147], v[84:99]
    ds_read_b64_tr_b16 v[168:169], v13 offset:18432
    ds_read_b64_tr_b16 v[170:171], v13 offset:19456
    s_waitcnt lgkmcnt(8)
    v_mfma_f32_32x32x16_bf16 v[36:51], v[152:155], a[16:19], v[36:51]
    ds_read_b64_tr_b16 v[172:173], v14 offset:18432
    ds_read_b64_tr_b16 v[174:175], v14 offset:19456
    v_mfma_f32_32x32x16_bf16 v[100:115], v[152:155], a[144:147], v[100:115]
    ds_read_b64_tr_b16 v[176:177], v15 offset:18432
    ds_read_b64_tr_b16 v[178:179], v15 offset:19456
    s_waitcnt lgkmcnt(10)
    v_mfma_f32_32x32x16_bf16 v[52:67], v[156:159], a[16:19], v[52:67]
    ds_read_b128 a[32:35], v8 offset:0
    v_mfma_f32_32x32x16_bf16 v[116:131], v[156:159], a[144:147], v[116:131]
    ds_read_b128 a[36:39], v9 offset:0
    s_waitcnt lgkmcnt(10)
    v_mfma_f32_32x32x16_bf16 v[68:83], v[160:163], a[16:19], v[68:83]
    ds_read_b128 a[40:43], v10 offset:0
    v_mfma_f32_32x32x16_bf16 v[132:147], v[160:163], a[144:147], v[132:147]
    ds_read_b128 a[44:47], v11 offset:0
    s_waitcnt lgkmcnt(10)
    v_mfma_f32_32x32x16_bf16 v[20:35], v[164:167], a[20:23], v[20:35]
    ds_read_b64_tr_b16 v[148:149], v12 offset:20480
    ds_read_b64_tr_b16 v[150:151], v12 offset:21504
    v_mfma_f32_32x32x16_bf16 v[84:99], v[164:167], a[148:151], v[84:99]
    ds_read_b64_tr_b16 v[152:153], v13 offset:20480
    ds_read_b64_tr_b16 v[154:155], v13 offset:21504
    s_waitcnt lgkmcnt(12)
    v_mfma_f32_32x32x16_bf16 v[36:51], v[168:171], a[20:23], v[36:51]
    ds_read_b64_tr_b16 v[156:157], v14 offset:20480
    ds_read_b64_tr_b16 v[158:159], v14 offset:21504
    v_mfma_f32_32x32x16_bf16 v[100:115], v[168:171], a[148:151], v[100:115]
    ds_read_b64_tr_b16 v[160:161], v15 offset:20480
    ds_read_b64_tr_b16 v[162:163], v15 offset:21504
    s_waitcnt lgkmcnt(11)
    v_mfma_f32_32x32x16_bf16 v[52:67], v[172:175], a[20:23], v[52:67]
    ds_read_b128 a[160:163], v8 offset:4096
    v_mfma_f32_32x32x16_bf16 v[116:131], v[172:175], a[148:151], v[116:131]
    ds_read_b128 a[164:167], v9 offset:4096
    v_mfma_f32_32x32x16_bf16 v[68:83], v[176:179], a[20:23], v[68:83]
    ds_read_b128 a[168:171], v10 offset:4096
    v_mfma_f32_32x32x16_bf16 v[132:147], v[176:179], a[148:151], v[132:147]
    ds_read_b128 a[172:175], v11 offset:4096
    s_waitcnt lgkmcnt(11)
    s_waitcnt lgkmcnt(10)
    v_mfma_f32_32x32x16_bf16 v[20:35], v[148:151], a[24:27], v[20:35]
    ds_read_b64_tr_b16 v[164:165], v12 offset:22528
    ds_read_b64_tr_b16 v[166:167], v12 offset:23552
    ds_read_b64_tr_b16 v[168:169], v13 offset:22528
    ds_read_b64_tr_b16 v[170:171], v13 offset:23552
    v_mfma_f32_32x32x16_bf16 v[84:99], v[148:151], a[152:155], v[84:99]
    ds_read_b64_tr_b16 v[172:173], v14 offset:22528
    ds_read_b64_tr_b16 v[174:175], v14 offset:23552
    s_waitcnt lgkmcnt(11)
    v_mfma_f32_32x32x16_bf16 v[36:51], v[152:155], a[24:27], v[36:51]
    ds_read_b64_tr_b16 v[176:177], v15 offset:22528
    ds_read_b64_tr_b16 v[178:179], v15 offset:23552
    v_mfma_f32_32x32x16_bf16 v[100:115], v[152:155], a[152:155], v[100:115]
    s_add_u32 s53, s55, 0x200
    s_add_u32 m0, s56, 0x18000
    buffer_load_dwordx4 v2, s[20:23], s53 offen lds
    v_mfma_f32_32x32x16_bf16 v[52:67], v[156:159], a[24:27], v[52:67]
    s_add_u32 s53, s55, 0x2200
    s_add_u32 m0, s56, 0x18400
    buffer_load_dwordx4 v3, s[20:23], s53 offen lds
    v_mfma_f32_32x32x16_bf16 v[116:131], v[156:159], a[152:155], v[116:131]
    s_add_u32 s53, s55, 0x4200
    s_add_u32 m0, s56, 0x18800
    buffer_load_dwordx4 v2, s[20:23], s53 offen lds
    s_waitcnt lgkmcnt(12)
    v_mfma_f32_32x32x16_bf16 v[68:83], v[160:163], a[24:27], v[68:83]
    s_add_u32 s53, s55, 0x6200
    s_add_u32 m0, s56, 0x18c00
    buffer_load_dwordx4 v3, s[20:23], s53 offen lds
    v_mfma_f32_32x32x16_bf16 v[132:147], v[160:163], a[152:155], v[132:147]
    s_add_u32 s53, s55, 0x8200
    s_add_u32 m0, s56, 0x19000
    buffer_load_dwordx4 v2, s[20:23], s53 offen lds
    s_waitcnt lgkmcnt(6)
    v_mfma_f32_32x32x16_bf16 v[20:35], v[164:167], a[28:31], v[20:35]
    ds_read_b64_tr_b16 v[148:149], v12 offset:32768
    ds_read_b64_tr_b16 v[150:151], v12 offset:33792
    ds_read_b64_tr_b16 v[152:153], v13 offset:32768
    ds_read_b64_tr_b16 v[154:155], v13 offset:33792
    v_mfma_f32_32x32x16_bf16 v[84:99], v[164:167], a[156:159], v[84:99]
    ds_read_b64_tr_b16 v[156:157], v14 offset:32768
    ds_read_b64_tr_b16 v[158:159], v14 offset:33792
    ds_read_b64_tr_b16 v[160:161], v15 offset:32768
    ds_read_b64_tr_b16 v[162:163], v15 offset:33792
    s_waitcnt lgkmcnt(12)
    v_mfma_f32_32x32x16_bf16 v[36:51], v[168:171], a[28:31], v[36:51]
    s_add_u32 s53, s55, 0xa200
    s_add_u32 m0, s56, 0x19400
    buffer_load_dwordx4 v3, s[20:23], s53 offen lds
    s_add_u32 s53, s55, 0xc200
    s_add_u32 m0, s56, 0x19800
    buffer_load_dwordx4 v2, s[20:23], s53 offen lds
    v_mfma_f32_32x32x16_bf16 v[100:115], v[168:171], a[156:159], v[100:115]
    s_add_u32 s53, s55, 0xe200
    s_add_u32 m0, s56, 0x19c00
    buffer_load_dwordx4 v3, s[20:23], s53 offen lds
    s_add_u32 s53, s52, 0x40000
    s_add_u32 m0, s54, 0x0
    buffer_load_dwordx4 v1, s[28:31], s53 offen lds
    s_waitcnt lgkmcnt(10)
    v_mfma_f32_32x32x16_bf16 v[52:67], v[172:175], a[28:31], v[52:67]
    s_add_u32 s53, s52, 0x41000
    s_add_u32 m0, s54, 0x400
    buffer_load_dwordx4 v1, s[28:31], s53 offen lds
    v_mfma_f32_32x32x16_bf16 v[116:131], v[172:175], a[156:159], v[116:131]
    s_add_u32 s53, s52, 0x42000
    s_add_u32 m0, s54, 0x800
    buffer_load_dwordx4 v1, s[28:31], s53 offen lds
    s_waitcnt lgkmcnt(8)
    v_mfma_f32_32x32x16_bf16 v[68:83], v[176:179], a[28:31], v[68:83]
    s_add_u32 s53, s52, 0x43000
    s_add_u32 m0, s54, 0xc00
    buffer_load_dwordx4 v1, s[28:31], s53 offen lds
    v_mfma_f32_32x32x16_bf16 v[132:147], v[176:179], a[156:159], v[132:147]
    s_waitcnt vmcnt(12)
    s_barrier
    s_waitcnt lgkmcnt(6)
    v_mfma_f32_32x32x16_bf16 v[20:35], v[148:151], a[32:35], v[20:35]
    ds_read_b64_tr_b16 v[164:165], v12 offset:34816
    ds_read_b64_tr_b16 v[166:167], v12 offset:35840
    v_mfma_f32_32x32x16_bf16 v[84:99], v[148:151], a[160:163], v[84:99]
    ds_read_b64_tr_b16 v[168:169], v13 offset:34816
    ds_read_b64_tr_b16 v[170:171], v13 offset:35840
    s_waitcnt lgkmcnt(8)
    v_mfma_f32_32x32x16_bf16 v[36:51], v[152:155], a[32:35], v[36:51]
    ds_read_b64_tr_b16 v[172:173], v14 offset:34816
    ds_read_b64_tr_b16 v[174:175], v14 offset:35840
    v_mfma_f32_32x32x16_bf16 v[100:115], v[152:155], a[160:163], v[100:115]
    ds_read_b64_tr_b16 v[176:177], v15 offset:34816
    ds_read_b64_tr_b16 v[178:179], v15 offset:35840
    s_waitcnt lgkmcnt(10)
    v_mfma_f32_32x32x16_bf16 v[52:67], v[156:159], a[32:35], v[52:67]
    ds_read_b128 a[48:51], v4 offset:0
    v_mfma_f32_32x32x16_bf16 v[116:131], v[156:159], a[160:163], v[116:131]
    ds_read_b128 a[52:55], v5 offset:0
    s_waitcnt lgkmcnt(10)
    v_mfma_f32_32x32x16_bf16 v[68:83], v[160:163], a[32:35], v[68:83]
    ds_read_b128 a[56:59], v6 offset:0
    v_mfma_f32_32x32x16_bf16 v[132:147], v[160:163], a[160:163], v[132:147]
    ds_read_b128 a[60:63], v7 offset:0
    s_waitcnt lgkmcnt(10)
    v_mfma_f32_32x32x16_bf16 v[20:35], v[164:167], a[36:39], v[20:35]
    ds_read_b64_tr_b16 v[148:149], v12 offset:36864
    ds_read_b64_tr_b16 v[150:151], v12 offset:37888
    v_mfma_f32_32x32x16_bf16 v[84:99], v[164:167], a[164:167], v[84:99]
    ds_read_b64_tr_b16 v[152:153], v13 offset:36864
    ds_read_b64_tr_b16 v[154:155], v13 offset:37888
    s_waitcnt lgkmcnt(12)
    v_mfma_f32_32x32x16_bf16 v[36:51], v[168:171], a[36:39], v[36:51]
    ds_read_b64_tr_b16 v[156:157], v14 offset:36864
    ds_read_b64_tr_b16 v[158:159], v14 offset:37888
    v_mfma_f32_32x32x16_bf16 v[100:115], v[168:171], a[164:167], v[100:115]
    ds_read_b64_tr_b16 v[160:161], v15 offset:36864
    ds_read_b64_tr_b16 v[162:163], v15 offset:37888
    s_waitcnt lgkmcnt(11)
    v_mfma_f32_32x32x16_bf16 v[52:67], v[172:175], a[36:39], v[52:67]
    ds_read_b128 a[176:179], v4 offset:4096
    v_mfma_f32_32x32x16_bf16 v[116:131], v[172:175], a[164:167], v[116:131]
    ds_read_b128 a[180:183], v5 offset:4096
    v_mfma_f32_32x32x16_bf16 v[68:83], v[176:179], a[36:39], v[68:83]
    ds_read_b128 a[184:187], v6 offset:4096
    v_mfma_f32_32x32x16_bf16 v[132:147], v[176:179], a[164:167], v[132:147]
    ds_read_b128 a[188:191], v7 offset:4096
    s_waitcnt lgkmcnt(11)
    s_waitcnt lgkmcnt(10)
    v_mfma_f32_32x32x16_bf16 v[20:35], v[148:151], a[40:43], v[20:35]
    ds_read_b64_tr_b16 v[164:165], v12 offset:38912
    ds_read_b64_tr_b16 v[166:167], v12 offset:39936
    ds_read_b64_tr_b16 v[168:169], v13 offset:38912
    ds_read_b64_tr_b16 v[170:171], v13 offset:39936
    v_mfma_f32_32x32x16_bf16 v[84:99], v[148:151], a[168:171], v[84:99]
    ds_read_b64_tr_b16 v[172:173], v14 offset:38912
    ds_read_b64_tr_b16 v[174:175], v14 offset:39936
    s_waitcnt lgkmcnt(11)
    v_mfma_f32_32x32x16_bf16 v[36:51], v[152:155], a[40:43], v[36:51]
    ds_read_b64_tr_b16 v[176:177], v15 offset:38912
    ds_read_b64_tr_b16 v[178:179], v15 offset:39936
    v_mfma_f32_32x32x16_bf16 v[100:115], v[152:155], a[168:171], v[100:115]
    s_add_u32 s53, s55, 0x280
    s_add_u32 m0, s56, 0x20000
    buffer_load_dwordx4 v2, s[20:23], s53 offen lds
    v_mfma_f32_32x32x16_bf16 v[52:67], v[156:159], a[40:43], v[52:67]
    s_add_u32 s53, s55, 0x2280
    s_add_u32 m0, s56, 0x20400
    buffer_load_dwordx4 v3, s[20:23], s53 offen lds
    v_mfma_f32_32x32x16_bf16 v[116:131], v[156:159], a[168:171], v[116:131]
    s_add_u32 s53, s55, 0x4280
    s_add_u32 m0, s56, 0x20800
    buffer_load_dwordx4 v2, s[20:23], s53 offen lds
    s_waitcnt lgkmcnt(12)
    v_mfma_f32_32x32x16_bf16 v[68:83], v[160:163], a[40:43], v[68:83]
    s_add_u32 s53, s55, 0x6280
    s_add_u32 m0, s56, 0x20c00
    buffer_load_dwordx4 v3, s[20:23], s53 offen lds
    v_mfma_f32_32x32x16_bf16 v[132:147], v[160:163], a[168:171], v[132:147]
    s_add_u32 s53, s55, 0x8280
    s_add_u32 m0, s56, 0x21000
    buffer_load_dwordx4 v2, s[20:23], s53 offen lds
    s_waitcnt lgkmcnt(6)
    v_mfma_f32_32x32x16_bf16 v[20:35], v[164:167], a[44:47], v[20:35]
    ds_read_b64_tr_b16 v[148:149], v12 offset:49152
    ds_read_b64_tr_b16 v[150:151], v12 offset:50176
    ds_read_b64_tr_b16 v[152:153], v13 offset:49152
    ds_read_b64_tr_b16 v[154:155], v13 offset:50176
    v_mfma_f32_32x32x16_bf16 v[84:99], v[164:167], a[172:175], v[84:99]
    ds_read_b64_tr_b16 v[156:157], v14 offset:49152
    ds_read_b64_tr_b16 v[158:159], v14 offset:50176
    ds_read_b64_tr_b16 v[160:161], v15 offset:49152
    ds_read_b64_tr_b16 v[162:163], v15 offset:50176
    s_waitcnt lgkmcnt(12)
    v_mfma_f32_32x32x16_bf16 v[36:51], v[168:171], a[44:47], v[36:51]
    s_add_u32 s53, s55, 0xa280
    s_add_u32 m0, s56, 0x21400
    buffer_load_dwordx4 v3, s[20:23], s53 offen lds
    s_add_u32 s53, s55, 0xc280
    s_add_u32 m0, s56, 0x21800
    buffer_load_dwordx4 v2, s[20:23], s53 offen lds
    v_mfma_f32_32x32x16_bf16 v[100:115], v[168:171], a[172:175], v[100:115]
    s_add_u32 s53, s55, 0xe280
    s_add_u32 m0, s56, 0x21c00
    buffer_load_dwordx4 v3, s[20:23], s53 offen lds
    s_add_u32 s53, s52, 0x50000
    s_add_u32 m0, s54, 0x4000
    buffer_load_dwordx4 v1, s[28:31], s53 offen lds
    s_waitcnt lgkmcnt(10)
    v_mfma_f32_32x32x16_bf16 v[52:67], v[172:175], a[44:47], v[52:67]
    s_add_u32 s53, s52, 0x51000
    s_add_u32 m0, s54, 0x4400
    buffer_load_dwordx4 v1, s[28:31], s53 offen lds
    v_mfma_f32_32x32x16_bf16 v[116:131], v[172:175], a[172:175], v[116:131]
    s_add_u32 s53, s52, 0x52000
    s_add_u32 m0, s54, 0x4800
    buffer_load_dwordx4 v1, s[28:31], s53 offen lds
    s_waitcnt lgkmcnt(8)
    v_mfma_f32_32x32x16_bf16 v[68:83], v[176:179], a[44:47], v[68:83]
    s_add_u32 s53, s52, 0x53000
    s_add_u32 m0, s54, 0x4c00
    buffer_load_dwordx4 v1, s[28:31], s53 offen lds
    v_mfma_f32_32x32x16_bf16 v[132:147], v[176:179], a[172:175], v[132:147]
    s_waitcnt vmcnt(12)
    s_barrier
    s_waitcnt lgkmcnt(6)
    v_mfma_f32_32x32x16_bf16 v[20:35], v[148:151], a[48:51], v[20:35]
    ds_read_b64_tr_b16 v[164:165], v12 offset:51200
    ds_read_b64_tr_b16 v[166:167], v12 offset:52224
    v_mfma_f32_32x32x16_bf16 v[84:99], v[148:151], a[176:179], v[84:99]
    ds_read_b64_tr_b16 v[168:169], v13 offset:51200
    ds_read_b64_tr_b16 v[170:171], v13 offset:52224
    s_waitcnt lgkmcnt(8)
    v_mfma_f32_32x32x16_bf16 v[36:51], v[152:155], a[48:51], v[36:51]
    ds_read_b64_tr_b16 v[172:173], v14 offset:51200
    ds_read_b64_tr_b16 v[174:175], v14 offset:52224
    v_mfma_f32_32x32x16_bf16 v[100:115], v[152:155], a[176:179], v[100:115]
    ds_read_b64_tr_b16 v[176:177], v15 offset:51200
    ds_read_b64_tr_b16 v[178:179], v15 offset:52224
    s_waitcnt lgkmcnt(10)
    v_mfma_f32_32x32x16_bf16 v[52:67], v[156:159], a[48:51], v[52:67]
    ds_read_b128 a[64:67], v4 offset:32768
    v_mfma_f32_32x32x16_bf16 v[116:131], v[156:159], a[176:179], v[116:131]
    ds_read_b128 a[68:71], v5 offset:32768
    s_waitcnt lgkmcnt(10)
    v_mfma_f32_32x32x16_bf16 v[68:83], v[160:163], a[48:51], v[68:83]
    ds_read_b128 a[72:75], v6 offset:32768
    v_mfma_f32_32x32x16_bf16 v[132:147], v[160:163], a[176:179], v[132:147]
    ds_read_b128 a[76:79], v7 offset:32768
    s_waitcnt lgkmcnt(10)
    v_mfma_f32_32x32x16_bf16 v[20:35], v[164:167], a[52:55], v[20:35]
    ds_read_b64_tr_b16 v[148:149], v12 offset:53248
    ds_read_b64_tr_b16 v[150:151], v12 offset:54272
    v_mfma_f32_32x32x16_bf16 v[84:99], v[164:167], a[180:183], v[84:99]
    ds_read_b64_tr_b16 v[152:153], v13 offset:53248
    ds_read_b64_tr_b16 v[154:155], v13 offset:54272
    s_waitcnt lgkmcnt(12)
    v_mfma_f32_32x32x16_bf16 v[36:51], v[168:171], a[52:55], v[36:51]
    ds_read_b64_tr_b16 v[156:157], v14 offset:53248
    ds_read_b64_tr_b16 v[158:159], v14 offset:54272
    v_mfma_f32_32x32x16_bf16 v[100:115], v[168:171], a[180:183], v[100:115]
    ds_read_b64_tr_b16 v[160:161], v15 offset:53248
    ds_read_b64_tr_b16 v[162:163], v15 offset:54272
    s_waitcnt lgkmcnt(11)
    v_mfma_f32_32x32x16_bf16 v[52:67], v[172:175], a[52:55], v[52:67]
    ds_read_b128 a[192:195], v4 offset:36864
    v_mfma_f32_32x32x16_bf16 v[116:131], v[172:175], a[180:183], v[116:131]
    ds_read_b128 a[196:199], v5 offset:36864
    v_mfma_f32_32x32x16_bf16 v[68:83], v[176:179], a[52:55], v[68:83]
    ds_read_b128 a[200:203], v6 offset:36864
    v_mfma_f32_32x32x16_bf16 v[132:147], v[176:179], a[180:183], v[132:147]
    ds_read_b128 a[204:207], v7 offset:36864
    s_waitcnt lgkmcnt(11)
    s_waitcnt lgkmcnt(10)
    v_mfma_f32_32x32x16_bf16 v[20:35], v[148:151], a[56:59], v[20:35]
    ds_read_b64_tr_b16 v[164:165], v12 offset:55296
    ds_read_b64_tr_b16 v[166:167], v12 offset:56320
    ds_read_b64_tr_b16 v[168:169], v13 offset:55296
    ds_read_b64_tr_b16 v[170:171], v13 offset:56320
    v_mfma_f32_32x32x16_bf16 v[84:99], v[148:151], a[184:187], v[84:99]
    ds_read_b64_tr_b16 v[172:173], v14 offset:55296
    ds_read_b64_tr_b16 v[174:175], v14 offset:56320
    s_waitcnt lgkmcnt(11)
    v_mfma_f32_32x32x16_bf16 v[36:51], v[152:155], a[56:59], v[36:51]
    ds_read_b64_tr_b16 v[176:177], v15 offset:55296
    ds_read_b64_tr_b16 v[178:179], v15 offset:56320
    v_mfma_f32_32x32x16_bf16 v[100:115], v[152:155], a[184:187], v[100:115]
    s_add_u32 s53, s55, 0x300
    s_add_u32 m0, s56, 0x10000
    buffer_load_dwordx4 v2, s[20:23], s53 offen lds
    v_mfma_f32_32x32x16_bf16 v[52:67], v[156:159], a[56:59], v[52:67]
    s_add_u32 s53, s55, 0x2300
    s_add_u32 m0, s56, 0x10400
    buffer_load_dwordx4 v3, s[20:23], s53 offen lds
    v_mfma_f32_32x32x16_bf16 v[116:131], v[156:159], a[184:187], v[116:131]
    s_add_u32 s53, s55, 0x4300
    s_add_u32 m0, s56, 0x10800
    buffer_load_dwordx4 v2, s[20:23], s53 offen lds
    s_waitcnt lgkmcnt(12)
    v_mfma_f32_32x32x16_bf16 v[68:83], v[160:163], a[56:59], v[68:83]
    s_add_u32 s53, s55, 0x6300
    s_add_u32 m0, s56, 0x10c00
    buffer_load_dwordx4 v3, s[20:23], s53 offen lds
    v_mfma_f32_32x32x16_bf16 v[132:147], v[160:163], a[184:187], v[132:147]
    s_add_u32 s53, s55, 0x8300
    s_add_u32 m0, s56, 0x11000
    buffer_load_dwordx4 v2, s[20:23], s53 offen lds
    s_waitcnt lgkmcnt(6)
    v_mfma_f32_32x32x16_bf16 v[20:35], v[164:167], a[60:63], v[20:35]
    ds_read_b64_tr_b16 v[148:149], v12 offset:0
    ds_read_b64_tr_b16 v[150:151], v12 offset:1024
    ds_read_b64_tr_b16 v[152:153], v13 offset:0
    ds_read_b64_tr_b16 v[154:155], v13 offset:1024
    v_mfma_f32_32x32x16_bf16 v[84:99], v[164:167], a[188:191], v[84:99]
    ds_read_b64_tr_b16 v[156:157], v14 offset:0
    ds_read_b64_tr_b16 v[158:159], v14 offset:1024
    ds_read_b64_tr_b16 v[160:161], v15 offset:0
    ds_read_b64_tr_b16 v[162:163], v15 offset:1024
    s_waitcnt lgkmcnt(12)
    v_mfma_f32_32x32x16_bf16 v[36:51], v[168:171], a[60:63], v[36:51]
    s_add_u32 s53, s55, 0xa300
    s_add_u32 m0, s56, 0x11400
    buffer_load_dwordx4 v3, s[20:23], s53 offen lds
    s_add_u32 s53, s55, 0xc300
    s_add_u32 m0, s56, 0x11800
    buffer_load_dwordx4 v2, s[20:23], s53 offen lds
    v_mfma_f32_32x32x16_bf16 v[100:115], v[168:171], a[188:191], v[100:115]
    s_add_u32 s53, s55, 0xe300
    s_add_u32 m0, s56, 0x11c00
    buffer_load_dwordx4 v3, s[20:23], s53 offen lds
    s_add_u32 s53, s52, 0x60000
    s_add_u32 m0, s54, 0x8000
    buffer_load_dwordx4 v1, s[28:31], s53 offen lds
    s_waitcnt lgkmcnt(10)
    v_mfma_f32_32x32x16_bf16 v[52:67], v[172:175], a[60:63], v[52:67]
    s_add_u32 s53, s52, 0x61000
    s_add_u32 m0, s54, 0x8400
    buffer_load_dwordx4 v1, s[28:31], s53 offen lds
    v_mfma_f32_32x32x16_bf16 v[116:131], v[172:175], a[188:191], v[116:131]
    s_add_u32 s53, s52, 0x62000
    s_add_u32 m0, s54, 0x8800
    buffer_load_dwordx4 v1, s[28:31], s53 offen lds
    s_waitcnt lgkmcnt(8)
    v_mfma_f32_32x32x16_bf16 v[68:83], v[176:179], a[60:63], v[68:83]
    s_add_u32 s53, s52, 0x63000
    s_add_u32 m0, s54, 0x8c00
    buffer_load_dwordx4 v1, s[28:31], s53 offen lds
    v_mfma_f32_32x32x16_bf16 v[132:147], v[176:179], a[188:191], v[132:147]
    s_waitcnt vmcnt(12)
    s_barrier
    s_waitcnt lgkmcnt(6)
    v_mfma_f32_32x32x16_bf16 v[20:35], v[148:151], a[64:67], v[20:35]
    ds_read_b64_tr_b16 v[164:165], v12 offset:2048
    ds_read_b64_tr_b16 v[166:167], v12 offset:3072
    v_mfma_f32_32x32x16_bf16 v[84:99], v[148:151], a[192:195], v[84:99]
    ds_read_b64_tr_b16 v[168:169], v13 offset:2048
    ds_read_b64_tr_b16 v[170:171], v13 offset:3072
    s_waitcnt lgkmcnt(8)
    v_mfma_f32_32x32x16_bf16 v[36:51], v[152:155], a[64:67], v[36:51]
    ds_read_b64_tr_b16 v[172:173], v14 offset:2048
    ds_read_b64_tr_b16 v[174:175], v14 offset:3072
    v_mfma_f32_32x32x16_bf16 v[100:115], v[152:155], a[192:195], v[100:115]
    ds_read_b64_tr_b16 v[176:177], v15 offset:2048
    ds_read_b64_tr_b16 v[178:179], v15 offset:3072
    s_waitcnt lgkmcnt(10)
    v_mfma_f32_32x32x16_bf16 v[52:67], v[156:159], a[64:67], v[52:67]
    ds_read_b128 a[80:83], v8 offset:0
    v_mfma_f32_32x32x16_bf16 v[116:131], v[156:159], a[192:195], v[116:131]
    ds_read_b128 a[84:87], v9 offset:0
    s_waitcnt lgkmcnt(10)
    v_mfma_f32_32x32x16_bf16 v[68:83], v[160:163], a[64:67], v[68:83]
    ds_read_b128 a[88:91], v10 offset:0
    v_mfma_f32_32x32x16_bf16 v[132:147], v[160:163], a[192:195], v[132:147]
    ds_read_b128 a[92:95], v11 offset:0
    s_waitcnt lgkmcnt(10)
    v_mfma_f32_32x32x16_bf16 v[20:35], v[164:167], a[68:71], v[20:35]
    ds_read_b64_tr_b16 v[148:149], v12 offset:4096
    ds_read_b64_tr_b16 v[150:151], v12 offset:5120
    v_mfma_f32_32x32x16_bf16 v[84:99], v[164:167], a[196:199], v[84:99]
    ds_read_b64_tr_b16 v[152:153], v13 offset:4096
    ds_read_b64_tr_b16 v[154:155], v13 offset:5120
    s_waitcnt lgkmcnt(12)
    v_mfma_f32_32x32x16_bf16 v[36:51], v[168:171], a[68:71], v[36:51]
    ds_read_b64_tr_b16 v[156:157], v14 offset:4096
    ds_read_b64_tr_b16 v[158:159], v14 offset:5120
    v_mfma_f32_32x32x16_bf16 v[100:115], v[168:171], a[196:199], v[100:115]
    ds_read_b64_tr_b16 v[160:161], v15 offset:4096
    ds_read_b64_tr_b16 v[162:163], v15 offset:5120
    s_waitcnt lgkmcnt(11)
    v_mfma_f32_32x32x16_bf16 v[52:67], v[172:175], a[68:71], v[52:67]
    ds_read_b128 a[208:211], v8 offset:4096
    v_mfma_f32_32x32x16_bf16 v[116:131], v[172:175], a[196:199], v[116:131]
    ds_read_b128 a[212:215], v9 offset:4096
    v_mfma_f32_32x32x16_bf16 v[68:83], v[176:179], a[68:71], v[68:83]
    ds_read_b128 a[216:219], v10 offset:4096
    v_mfma_f32_32x32x16_bf16 v[132:147], v[176:179], a[196:199], v[132:147]
    ds_read_b128 a[220:223], v11 offset:4096
    s_waitcnt lgkmcnt(11)
    s_waitcnt lgkmcnt(10)
    v_mfma_f32_32x32x16_bf16 v[20:35], v[148:151], a[72:75], v[20:35]
    ds_read_b64_tr_b16 v[164:165], v12 offset:6144
    ds_read_b64_tr_b16 v[166:167], v12 offset:7168
    ds_read_b64_tr_b16 v[168:169], v13 offset:6144
    ds_read_b64_tr_b16 v[170:171], v13 offset:7168
    v_mfma_f32_32x32x16_bf16 v[84:99], v[148:151], a[200:203], v[84:99]
    ds_read_b64_tr_b16 v[172:173], v14 offset:6144
    ds_read_b64_tr_b16 v[174:175], v14 offset:7168
    s_waitcnt lgkmcnt(11)
    v_mfma_f32_32x32x16_bf16 v[36:51], v[152:155], a[72:75], v[36:51]
    ds_read_b64_tr_b16 v[176:177], v15 offset:6144
    ds_read_b64_tr_b16 v[178:179], v15 offset:7168
    v_mfma_f32_32x32x16_bf16 v[100:115], v[152:155], a[200:203], v[100:115]
    s_add_u32 s53, s55, 0x380
    s_add_u32 m0, s56, 0x18000
    buffer_load_dwordx4 v2, s[20:23], s53 offen lds
    v_mfma_f32_32x32x16_bf16 v[52:67], v[156:159], a[72:75], v[52:67]
    s_add_u32 s53, s55, 0x2380
    s_add_u32 m0, s56, 0x18400
    buffer_load_dwordx4 v3, s[20:23], s53 offen lds
    v_mfma_f32_32x32x16_bf16 v[116:131], v[156:159], a[200:203], v[116:131]
    s_add_u32 s53, s55, 0x4380
    s_add_u32 m0, s56, 0x18800
    buffer_load_dwordx4 v2, s[20:23], s53 offen lds
    s_waitcnt lgkmcnt(12)
    v_mfma_f32_32x32x16_bf16 v[68:83], v[160:163], a[72:75], v[68:83]
    s_add_u32 s53, s55, 0x6380
    s_add_u32 m0, s56, 0x18c00
    buffer_load_dwordx4 v3, s[20:23], s53 offen lds
    v_mfma_f32_32x32x16_bf16 v[132:147], v[160:163], a[200:203], v[132:147]
    s_add_u32 s53, s55, 0x8380
    s_add_u32 m0, s56, 0x19000
    buffer_load_dwordx4 v2, s[20:23], s53 offen lds
    s_waitcnt lgkmcnt(6)
    v_mfma_f32_32x32x16_bf16 v[20:35], v[164:167], a[76:79], v[20:35]
    ds_read_b64_tr_b16 v[148:149], v12 offset:16384
    ds_read_b64_tr_b16 v[150:151], v12 offset:17408
    ds_read_b64_tr_b16 v[152:153], v13 offset:16384
    ds_read_b64_tr_b16 v[154:155], v13 offset:17408
    v_mfma_f32_32x32x16_bf16 v[84:99], v[164:167], a[204:207], v[84:99]
    ds_read_b64_tr_b16 v[156:157], v14 offset:16384
    ds_read_b64_tr_b16 v[158:159], v14 offset:17408
    ds_read_b64_tr_b16 v[160:161], v15 offset:16384
    ds_read_b64_tr_b16 v[162:163], v15 offset:17408
    s_waitcnt lgkmcnt(12)
    v_mfma_f32_32x32x16_bf16 v[36:51], v[168:171], a[76:79], v[36:51]
    s_add_u32 s53, s55, 0xa380
    s_add_u32 m0, s56, 0x19400
    buffer_load_dwordx4 v3, s[20:23], s53 offen lds
    s_add_u32 s53, s55, 0xc380
    s_add_u32 m0, s56, 0x19800
    buffer_load_dwordx4 v2, s[20:23], s53 offen lds
    v_mfma_f32_32x32x16_bf16 v[100:115], v[168:171], a[204:207], v[100:115]
    s_add_u32 s53, s55, 0xe380
    s_add_u32 m0, s56, 0x19c00
    buffer_load_dwordx4 v3, s[20:23], s53 offen lds
    s_add_u32 s53, s52, 0x70000
    s_add_u32 m0, s54, 0xc000
    buffer_load_dwordx4 v1, s[28:31], s53 offen lds
    s_waitcnt lgkmcnt(10)
    v_mfma_f32_32x32x16_bf16 v[52:67], v[172:175], a[76:79], v[52:67]
    s_add_u32 s53, s52, 0x71000
    s_add_u32 m0, s54, 0xc400
    buffer_load_dwordx4 v1, s[28:31], s53 offen lds
    v_mfma_f32_32x32x16_bf16 v[116:131], v[172:175], a[204:207], v[116:131]
    s_add_u32 s53, s52, 0x72000
    s_add_u32 m0, s54, 0xc800
    buffer_load_dwordx4 v1, s[28:31], s53 offen lds
    s_waitcnt lgkmcnt(8)
    v_mfma_f32_32x32x16_bf16 v[68:83], v[176:179], a[76:79], v[68:83]
    s_add_u32 s53, s52, 0x73000
    s_add_u32 m0, s54, 0xcc00
    buffer_load_dwordx4 v1, s[28:31], s53 offen lds
    v_mfma_f32_32x32x16_bf16 v[132:147], v[176:179], a[204:207], v[132:147]
    s_waitcnt vmcnt(12)
    s_barrier
    s_waitcnt lgkmcnt(6)
    v_mfma_f32_32x32x16_bf16 v[20:35], v[148:151], a[80:83], v[20:35]
    ds_read_b64_tr_b16 v[164:165], v12 offset:18432
    ds_read_b64_tr_b16 v[166:167], v12 offset:19456
    v_mfma_f32_32x32x16_bf16 v[84:99], v[148:151], a[208:211], v[84:99]
    ds_read_b64_tr_b16 v[168:169], v13 offset:18432
    ds_read_b64_tr_b16 v[170:171], v13 offset:19456
    s_waitcnt lgkmcnt(8)
    v_mfma_f32_32x32x16_bf16 v[36:51], v[152:155], a[80:83], v[36:51]
    ds_read_b64_tr_b16 v[172:173], v14 offset:18432
    ds_read_b64_tr_b16 v[174:175], v14 offset:19456
    v_mfma_f32_32x32x16_bf16 v[100:115], v[152:155], a[208:211], v[100:115]
    ds_read_b64_tr_b16 v[176:177], v15 offset:18432
    ds_read_b64_tr_b16 v[178:179], v15 offset:19456
    s_waitcnt lgkmcnt(10)
    v_mfma_f32_32x32x16_bf16 v[52:67], v[156:159], a[80:83], v[52:67]
    ds_read_b128 a[96:99], v4 offset:0
    v_mfma_f32_32x32x16_bf16 v[116:131], v[156:159], a[208:211], v[116:131]
    ds_read_b128 a[100:103], v5 offset:0
    s_waitcnt lgkmcnt(10)
    v_mfma_f32_32x32x16_bf16 v[68:83], v[160:163], a[80:83], v[68:83]
    ds_read_b128 a[104:107], v6 offset:0
    v_mfma_f32_32x32x16_bf16 v[132:147], v[160:163], a[208:211], v[132:147]
    ds_read_b128 a[108:111], v7 offset:0
    s_waitcnt lgkmcnt(10)
    v_mfma_f32_32x32x16_bf16 v[20:35], v[164:167], a[84:87], v[20:35]
    ds_read_b64_tr_b16 v[148:149], v12 offset:20480
    ds_read_b64_tr_b16 v[150:151], v12 offset:21504
    v_mfma_f32_32x32x16_bf16 v[84:99], v[164:167], a[212:215], v[84:99]
    ds_read_b64_tr_b16 v[152:153], v13 offset:20480
    ds_read_b64_tr_b16 v[154:155], v13 offset:21504
    s_waitcnt lgkmcnt(12)
    v_mfma_f32_32x32x16_bf16 v[36:51], v[168:171], a[84:87], v[36:51]
    ds_read_b64_tr_b16 v[156:157], v14 offset:20480
    ds_read_b64_tr_b16 v[158:159], v14 offset:21504
    v_mfma_f32_32x32x16_bf16 v[100:115], v[168:171], a[212:215], v[100:115]
    ds_read_b64_tr_b16 v[160:161], v15 offset:20480
    ds_read_b64_tr_b16 v[162:163], v15 offset:21504
    s_waitcnt lgkmcnt(11)
    v_mfma_f32_32x32x16_bf16 v[52:67], v[172:175], a[84:87], v[52:67]
    ds_read_b128 a[224:227], v4 offset:4096
    v_mfma_f32_32x32x16_bf16 v[116:131], v[172:175], a[212:215], v[116:131]
    ds_read_b128 a[228:231], v5 offset:4096
    v_mfma_f32_32x32x16_bf16 v[68:83], v[176:179], a[84:87], v[68:83]
    ds_read_b128 a[232:235], v6 offset:4096
    v_mfma_f32_32x32x16_bf16 v[132:147], v[176:179], a[212:215], v[132:147]
    ds_read_b128 a[236:239], v7 offset:4096
    s_waitcnt lgkmcnt(11)
    s_waitcnt lgkmcnt(10)
    v_mfma_f32_32x32x16_bf16 v[20:35], v[148:151], a[88:91], v[20:35]
    ds_read_b64_tr_b16 v[164:165], v12 offset:22528
    ds_read_b64_tr_b16 v[166:167], v12 offset:23552
    v_mfma_f32_32x32x16_bf16 v[84:99], v[148:151], a[216:219], v[84:99]
    ds_read_b64_tr_b16 v[168:169], v13 offset:22528
    ds_read_b64_tr_b16 v[170:171], v13 offset:23552
    s_waitcnt lgkmcnt(12)
    v_mfma_f32_32x32x16_bf16 v[36:51], v[152:155], a[88:91], v[36:51]
    ds_read_b64_tr_b16 v[172:173], v14 offset:22528
    ds_read_b64_tr_b16 v[174:175], v14 offset:23552
    v_mfma_f32_32x32x16_bf16 v[100:115], v[152:155], a[216:219], v[100:115]
    ds_read_b64_tr_b16 v[176:177], v15 offset:22528
    ds_read_b64_tr_b16 v[178:179], v15 offset:23552
    s_waitcnt lgkmcnt(11)
    v_mfma_f32_32x32x16_bf16 v[52:67], v[156:159], a[88:91], v[52:67]
    v_mfma_f32_32x32x16_bf16 v[116:131], v[156:159], a[216:219], v[116:131]
    v_mfma_f32_32x32x16_bf16 v[68:83], v[160:163], a[88:91], v[68:83]
    v_mfma_f32_32x32x16_bf16 v[132:147], v[160:163], a[216:219], v[132:147]
    s_waitcnt lgkmcnt(6)
    v_mfma_f32_32x32x16_bf16 v[20:35], v[164:167], a[92:95], v[20:35]
    ds_read_b64_tr_b16 v[148:149], v12 offset:32768
    ds_read_b64_tr_b16 v[150:151], v12 offset:33792
    v_mfma_f32_32x32x16_bf16 v[84:99], v[164:167], a[220:223], v[84:99]
    ds_read_b64_tr_b16 v[152:153], v13 offset:32768
    ds_read_b64_tr_b16 v[154:155], v13 offset:33792
    s_waitcnt lgkmcnt(8)
    v_mfma_f32_32x32x16_bf16 v[36:51], v[168:171], a[92:95], v[36:51]
    ds_read_b64_tr_b16 v[156:157], v14 offset:32768
    ds_read_b64_tr_b16 v[158:159], v14 offset:33792
    v_mfma_f32_32x32x16_bf16 v[100:115], v[168:171], a[220:223], v[100:115]
    ds_read_b64_tr_b16 v[160:161], v15 offset:32768
    ds_read_b64_tr_b16 v[162:163], v15 offset:33792
    s_waitcnt lgkmcnt(10)
    v_mfma_f32_32x32x16_bf16 v[52:67], v[172:175], a[92:95], v[52:67]
    v_mfma_f32_32x32x16_bf16 v[116:131], v[172:175], a[220:223], v[116:131]
    s_waitcnt lgkmcnt(8)
    v_mfma_f32_32x32x16_bf16 v[68:83], v[176:179], a[92:95], v[68:83]
    v_mfma_f32_32x32x16_bf16 v[132:147], v[176:179], a[220:223], v[132:147]
    s_waitcnt vmcnt(0)
    s_barrier
    s_waitcnt lgkmcnt(6)
    v_mfma_f32_32x32x16_bf16 v[20:35], v[148:151], a[96:99], v[20:35]
    ds_read_b64_tr_b16 v[164:165], v12 offset:34816
    ds_read_b64_tr_b16 v[166:167], v12 offset:35840
    v_mfma_f32_32x32x16_bf16 v[84:99], v[148:151], a[224:227], v[84:99]
    ds_read_b64_tr_b16 v[168:169], v13 offset:34816
    ds_read_b64_tr_b16 v[170:171], v13 offset:35840
    s_waitcnt lgkmcnt(8)
    v_mfma_f32_32x32x16_bf16 v[36:51], v[152:155], a[96:99], v[36:51]
    ds_read_b64_tr_b16 v[172:173], v14 offset:34816
    ds_read_b64_tr_b16 v[174:175], v14 offset:35840
    v_mfma_f32_32x32x16_bf16 v[100:115], v[152:155], a[224:227], v[100:115]
    ds_read_b64_tr_b16 v[176:177], v15 offset:34816
    ds_read_b64_tr_b16 v[178:179], v15 offset:35840
    s_waitcnt lgkmcnt(10)
    v_mfma_f32_32x32x16_bf16 v[52:67], v[156:159], a[96:99], v[52:67]
    ds_read_b128 a[112:115], v4 offset:32768
    v_mfma_f32_32x32x16_bf16 v[116:131], v[156:159], a[224:227], v[116:131]
    ds_read_b128 a[116:119], v5 offset:32768
    s_waitcnt lgkmcnt(10)
    v_mfma_f32_32x32x16_bf16 v[68:83], v[160:163], a[96:99], v[68:83]
    ds_read_b128 a[120:123], v6 offset:32768
    v_mfma_f32_32x32x16_bf16 v[132:147], v[160:163], a[224:227], v[132:147]
    ds_read_b128 a[124:127], v7 offset:32768
    s_waitcnt lgkmcnt(10)
    v_mfma_f32_32x32x16_bf16 v[20:35], v[164:167], a[100:103], v[20:35]
    ds_read_b64_tr_b16 v[148:149], v12 offset:36864
    ds_read_b64_tr_b16 v[150:151], v12 offset:37888
    v_mfma_f32_32x32x16_bf16 v[84:99], v[164:167], a[228:231], v[84:99]
    ds_read_b64_tr_b16 v[152:153], v13 offset:36864
    ds_read_b64_tr_b16 v[154:155], v13 offset:37888
    s_waitcnt lgkmcnt(12)
    v_mfma_f32_32x32x16_bf16 v[36:51], v[168:171], a[100:103], v[36:51]
    ds_read_b64_tr_b16 v[156:157], v14 offset:36864
    ds_read_b64_tr_b16 v[158:159], v14 offset:37888
    v_mfma_f32_32x32x16_bf16 v[100:115], v[168:171], a[228:231], v[100:115]
    ds_read_b64_tr_b16 v[160:161], v15 offset:36864
    ds_read_b64_tr_b16 v[162:163], v15 offset:37888
    s_waitcnt lgkmcnt(11)
    v_mfma_f32_32x32x16_bf16 v[52:67], v[172:175], a[100:103], v[52:67]
    ds_read_b128 a[240:243], v4 offset:36864
    v_mfma_f32_32x32x16_bf16 v[116:131], v[172:175], a[228:231], v[116:131]
    ds_read_b128 a[244:247], v5 offset:36864
    v_mfma_f32_32x32x16_bf16 v[68:83], v[176:179], a[100:103], v[68:83]
    ds_read_b128 a[248:251], v6 offset:36864
    v_mfma_f32_32x32x16_bf16 v[132:147], v[176:179], a[228:231], v[132:147]
    ds_read_b128 a[252:255], v7 offset:36864
    s_waitcnt lgkmcnt(11)
    s_waitcnt lgkmcnt(10)
    v_mfma_f32_32x32x16_bf16 v[20:35], v[148:151], a[104:107], v[20:35]
    ds_read_b64_tr_b16 v[164:165], v12 offset:38912
    ds_read_b64_tr_b16 v[166:167], v12 offset:39936
    v_mfma_f32_32x32x16_bf16 v[84:99], v[148:151], a[232:235], v[84:99]
    ds_read_b64_tr_b16 v[168:169], v13 offset:38912
    ds_read_b64_tr_b16 v[170:171], v13 offset:39936
    s_waitcnt lgkmcnt(12)
    v_mfma_f32_32x32x16_bf16 v[36:51], v[152:155], a[104:107], v[36:51]
    ds_read_b64_tr_b16 v[172:173], v14 offset:38912
    ds_read_b64_tr_b16 v[174:175], v14 offset:39936
    v_mfma_f32_32x32x16_bf16 v[100:115], v[152:155], a[232:235], v[100:115]
    ds_read_b64_tr_b16 v[176:177], v15 offset:38912
    ds_read_b64_tr_b16 v[178:179], v15 offset:39936
    s_waitcnt lgkmcnt(11)
    v_mfma_f32_32x32x16_bf16 v[52:67], v[156:159], a[104:107], v[52:67]
    v_mfma_f32_32x32x16_bf16 v[116:131], v[156:159], a[232:235], v[116:131]
    v_mfma_f32_32x32x16_bf16 v[68:83], v[160:163], a[104:107], v[68:83]
    v_mfma_f32_32x32x16_bf16 v[132:147], v[160:163], a[232:235], v[132:147]
    s_waitcnt lgkmcnt(6)
    v_mfma_f32_32x32x16_bf16 v[20:35], v[164:167], a[108:111], v[20:35]
    ds_read_b64_tr_b16 v[148:149], v12 offset:49152
    ds_read_b64_tr_b16 v[150:151], v12 offset:50176
    v_mfma_f32_32x32x16_bf16 v[84:99], v[164:167], a[236:239], v[84:99]
    ds_read_b64_tr_b16 v[152:153], v13 offset:49152
    ds_read_b64_tr_b16 v[154:155], v13 offset:50176
    s_waitcnt lgkmcnt(8)
    v_mfma_f32_32x32x16_bf16 v[36:51], v[168:171], a[108:111], v[36:51]
    ds_read_b64_tr_b16 v[156:157], v14 offset:49152
    ds_read_b64_tr_b16 v[158:159], v14 offset:50176
    v_mfma_f32_32x32x16_bf16 v[100:115], v[168:171], a[236:239], v[100:115]
    ds_read_b64_tr_b16 v[160:161], v15 offset:49152
    ds_read_b64_tr_b16 v[162:163], v15 offset:50176
    s_waitcnt lgkmcnt(10)
    v_mfma_f32_32x32x16_bf16 v[52:67], v[172:175], a[108:111], v[52:67]
    v_mfma_f32_32x32x16_bf16 v[116:131], v[172:175], a[236:239], v[116:131]
    s_waitcnt lgkmcnt(8)
    v_mfma_f32_32x32x16_bf16 v[68:83], v[176:179], a[108:111], v[68:83]
    v_mfma_f32_32x32x16_bf16 v[132:147], v[176:179], a[236:239], v[132:147]
    s_waitcnt lgkmcnt(6)
    v_mfma_f32_32x32x16_bf16 v[20:35], v[148:151], a[112:115], v[20:35]
    ds_read_b64_tr_b16 v[164:165], v12 offset:51200
    ds_read_b64_tr_b16 v[166:167], v12 offset:52224
    v_mfma_f32_32x32x16_bf16 v[84:99], v[148:151], a[240:243], v[84:99]
    ds_read_b64_tr_b16 v[168:169], v13 offset:51200
    ds_read_b64_tr_b16 v[170:171], v13 offset:52224
    s_waitcnt lgkmcnt(8)
    v_mfma_f32_32x32x16_bf16 v[36:51], v[152:155], a[112:115], v[36:51]
    ds_read_b64_tr_b16 v[172:173], v14 offset:51200
    ds_read_b64_tr_b16 v[174:175], v14 offset:52224
    v_mfma_f32_32x32x16_bf16 v[100:115], v[152:155], a[240:243], v[100:115]
    ds_read_b64_tr_b16 v[176:177], v15 offset:51200
    ds_read_b64_tr_b16 v[178:179], v15 offset:52224
    s_waitcnt lgkmcnt(10)
    v_mfma_f32_32x32x16_bf16 v[52:67], v[156:159], a[112:115], v[52:67]
    v_mfma_f32_32x32x16_bf16 v[116:131], v[156:159], a[240:243], v[116:131]
    s_waitcnt lgkmcnt(8)
    v_mfma_f32_32x32x16_bf16 v[68:83], v[160:163], a[112:115], v[68:83]
    v_mfma_f32_32x32x16_bf16 v[132:147], v[160:163], a[240:243], v[132:147]
    s_waitcnt lgkmcnt(6)
    v_mfma_f32_32x32x16_bf16 v[20:35], v[164:167], a[116:119], v[20:35]
    ds_read_b64_tr_b16 v[148:149], v12 offset:53248
    ds_read_b64_tr_b16 v[150:151], v12 offset:54272
    v_mfma_f32_32x32x16_bf16 v[84:99], v[164:167], a[244:247], v[84:99]
    ds_read_b64_tr_b16 v[152:153], v13 offset:53248
    ds_read_b64_tr_b16 v[154:155], v13 offset:54272
    s_waitcnt lgkmcnt(8)
    v_mfma_f32_32x32x16_bf16 v[36:51], v[168:171], a[116:119], v[36:51]
    ds_read_b64_tr_b16 v[156:157], v14 offset:53248
    ds_read_b64_tr_b16 v[158:159], v14 offset:54272
    v_mfma_f32_32x32x16_bf16 v[100:115], v[168:171], a[244:247], v[100:115]
    ds_read_b64_tr_b16 v[160:161], v15 offset:53248
    ds_read_b64_tr_b16 v[162:163], v15 offset:54272
    s_waitcnt lgkmcnt(10)
    v_mfma_f32_32x32x16_bf16 v[52:67], v[172:175], a[116:119], v[52:67]
    v_mfma_f32_32x32x16_bf16 v[116:131], v[172:175], a[244:247], v[116:131]
    s_waitcnt lgkmcnt(8)
    v_mfma_f32_32x32x16_bf16 v[68:83], v[176:179], a[116:119], v[68:83]
    v_mfma_f32_32x32x16_bf16 v[132:147], v[176:179], a[244:247], v[132:147]
    s_waitcnt lgkmcnt(6)
    v_mfma_f32_32x32x16_bf16 v[20:35], v[148:151], a[120:123], v[20:35]
    ds_read_b64_tr_b16 v[164:165], v12 offset:55296
    ds_read_b64_tr_b16 v[166:167], v12 offset:56320
    v_mfma_f32_32x32x16_bf16 v[84:99], v[148:151], a[248:251], v[84:99]
    ds_read_b64_tr_b16 v[168:169], v13 offset:55296
    ds_read_b64_tr_b16 v[170:171], v13 offset:56320
    s_waitcnt lgkmcnt(8)
    v_mfma_f32_32x32x16_bf16 v[36:51], v[152:155], a[120:123], v[36:51]
    ds_read_b64_tr_b16 v[172:173], v14 offset:55296
    ds_read_b64_tr_b16 v[174:175], v14 offset:56320
    v_mfma_f32_32x32x16_bf16 v[100:115], v[152:155], a[248:251], v[100:115]
    ds_read_b64_tr_b16 v[176:177], v15 offset:55296
    ds_read_b64_tr_b16 v[178:179], v15 offset:56320
    s_waitcnt lgkmcnt(10)
    v_mfma_f32_32x32x16_bf16 v[52:67], v[156:159], a[120:123], v[52:67]
    v_mfma_f32_32x32x16_bf16 v[116:131], v[156:159], a[248:251], v[116:131]
    s_waitcnt lgkmcnt(8)
    v_mfma_f32_32x32x16_bf16 v[68:83], v[160:163], a[120:123], v[68:83]
    v_mfma_f32_32x32x16_bf16 v[132:147], v[160:163], a[248:251], v[132:147]
    s_waitcnt lgkmcnt(6)
    v_mfma_f32_32x32x16_bf16 v[20:35], v[164:167], a[124:127], v[20:35]
    v_mfma_f32_32x32x16_bf16 v[84:99], v[164:167], a[252:255], v[84:99]
    s_waitcnt lgkmcnt(4)
    v_mfma_f32_32x32x16_bf16 v[36:51], v[168:171], a[124:127], v[36:51]
    v_mfma_f32_32x32x16_bf16 v[100:115], v[168:171], a[252:255], v[100:115]
    s_waitcnt lgkmcnt(2)
    v_mfma_f32_32x32x16_bf16 v[52:67], v[172:175], a[124:127], v[52:67]
    v_mfma_f32_32x32x16_bf16 v[116:131], v[172:175], a[252:255], v[116:131]
    s_waitcnt lgkmcnt(0)
    v_mfma_f32_32x32x16_bf16 v[68:83], v[176:179], a[124:127], v[68:83]
    v_mfma_f32_32x32x16_bf16 v[132:147], v[176:179], a[252:255], v[132:147]
    s_nop 7
    s_nop 15
    v_cvt_pk_bf16_f32 v180, v20, v21
    v_cvt_pk_bf16_f32 v181, v22, v23
    v_cvt_pk_bf16_f32 v182, v24, v25
    v_cvt_pk_bf16_f32 v183, v26, v27
    s_nop 1
    v_permlane32_swap_b32 v180, v182
    v_permlane32_swap_b32 v181, v183
    s_add_u32 s53, s57, 0x0
    buffer_store_dwordx4 v[180:183], v16, s[40:43], s53 offen
    v_cvt_pk_bf16_f32 v184, v28, v29
    v_cvt_pk_bf16_f32 v185, v30, v31
    v_cvt_pk_bf16_f32 v186, v32, v33
    v_cvt_pk_bf16_f32 v187, v34, v35
    s_nop 1
    v_permlane32_swap_b32 v184, v186
    v_permlane32_swap_b32 v185, v187
    s_add_u32 s53, s57, 0x10000
    buffer_store_dwordx4 v[184:187], v16, s[40:43], s53 offen
    v_cvt_pk_bf16_f32 v212, v84, v85
    v_cvt_pk_bf16_f32 v213, v86, v87
    v_cvt_pk_bf16_f32 v214, v88, v89
    v_cvt_pk_bf16_f32 v215, v90, v91
    s_nop 1
    v_permlane32_swap_b32 v212, v214
    v_permlane32_swap_b32 v213, v215
    s_add_u32 s53, s57, 0x400
    buffer_store_dwordx4 v[212:215], v16, s[40:43], s53 offen
    v_cvt_pk_bf16_f32 v216, v92, v93
    v_cvt_pk_bf16_f32 v217, v94, v95
    v_cvt_pk_bf16_f32 v218, v96, v97
    v_cvt_pk_bf16_f32 v219, v98, v99
    s_nop 1
    v_permlane32_swap_b32 v216, v218
    v_permlane32_swap_b32 v217, v219
    s_add_u32 s53, s57, 0x10400
    buffer_store_dwordx4 v[216:219], v16, s[40:43], s53 offen
    v_cvt_pk_bf16_f32 v188, v36, v37
    v_cvt_pk_bf16_f32 v189, v38, v39
    v_cvt_pk_bf16_f32 v190, v40, v41
    v_cvt_pk_bf16_f32 v191, v42, v43
    s_nop 1
    v_permlane32_swap_b32 v188, v190
    v_permlane32_swap_b32 v189, v191
    s_add_u32 s53, s57, 0x20000
    buffer_store_dwordx4 v[188:191], v16, s[40:43], s53 offen
    v_cvt_pk_bf16_f32 v192, v44, v45
    v_cvt_pk_bf16_f32 v193, v46, v47
    v_cvt_pk_bf16_f32 v194, v48, v49
    v_cvt_pk_bf16_f32 v195, v50, v51
    s_nop 1
    v_permlane32_swap_b32 v192, v194
    v_permlane32_swap_b32 v193, v195
    s_add_u32 s53, s57, 0x30000
    buffer_store_dwordx4 v[192:195], v16, s[40:43], s53 offen
    v_cvt_pk_bf16_f32 v220, v100, v101
    v_cvt_pk_bf16_f32 v221, v102, v103
    v_cvt_pk_bf16_f32 v222, v104, v105
    v_cvt_pk_bf16_f32 v223, v106, v107
    s_nop 1
    v_permlane32_swap_b32 v220, v222
    v_permlane32_swap_b32 v221, v223
    s_add_u32 s53, s57, 0x20400
    buffer_store_dwordx4 v[220:223], v16, s[40:43], s53 offen
    v_cvt_pk_bf16_f32 v224, v108, v109
    v_cvt_pk_bf16_f32 v225, v110, v111
    v_cvt_pk_bf16_f32 v226, v112, v113
    v_cvt_pk_bf16_f32 v227, v114, v115
    s_nop 1
    v_permlane32_swap_b32 v224, v226
    v_permlane32_swap_b32 v225, v227
    s_add_u32 s53, s57, 0x30400
    buffer_store_dwordx4 v[224:227], v16, s[40:43], s53 offen
    v_cvt_pk_bf16_f32 v196, v52, v53
    v_cvt_pk_bf16_f32 v197, v54, v55
    v_cvt_pk_bf16_f32 v198, v56, v57
    v_cvt_pk_bf16_f32 v199, v58, v59
    s_nop 1
    v_permlane32_swap_b32 v196, v198
    v_permlane32_swap_b32 v197, v199
    s_add_u32 s53, s57, 0x40000
    buffer_store_dwordx4 v[196:199], v16, s[40:43], s53 offen
    v_cvt_pk_bf16_f32 v200, v60, v61
    v_cvt_pk_bf16_f32 v201, v62, v63
    v_cvt_pk_bf16_f32 v202, v64, v65
    v_cvt_pk_bf16_f32 v203, v66, v67
    s_nop 1
    v_permlane32_swap_b32 v200, v202
    v_permlane32_swap_b32 v201, v203
    s_add_u32 s53, s57, 0x50000
    buffer_store_dwordx4 v[200:203], v16, s[40:43], s53 offen
    v_cvt_pk_bf16_f32 v228, v116, v117
    v_cvt_pk_bf16_f32 v229, v118, v119
    v_cvt_pk_bf16_f32 v230, v120, v121
    v_cvt_pk_bf16_f32 v231, v122, v123
    s_nop 1
    v_permlane32_swap_b32 v228, v230
    v_permlane32_swap_b32 v229, v231
    s_add_u32 s53, s57, 0x40400
    buffer_store_dwordx4 v[228:231], v16, s[40:43], s53 offen
    v_cvt_pk_bf16_f32 v232, v124, v125
    v_cvt_pk_bf16_f32 v233, v126, v127
    v_cvt_pk_bf16_f32 v234, v128, v129
    v_cvt_pk_bf16_f32 v235, v130, v131
    s_nop 1
    v_permlane32_swap_b32 v232, v234
    v_permlane32_swap_b32 v233, v235
    s_add_u32 s53, s57, 0x50400
    buffer_store_dwordx4 v[232:235], v16, s[40:43], s53 offen
    v_cvt_pk_bf16_f32 v204, v68, v69
    v_cvt_pk_bf16_f32 v205, v70, v71
    v_cvt_pk_bf16_f32 v206, v72, v73
    v_cvt_pk_bf16_f32 v207, v74, v75
    s_nop 1
    v_permlane32_swap_b32 v204, v206
    v_permlane32_swap_b32 v205, v207
    s_add_u32 s53, s57, 0x60000
    buffer_store_dwordx4 v[204:207], v16, s[40:43], s53 offen
    v_cvt_pk_bf16_f32 v208, v76, v77
    v_cvt_pk_bf16_f32 v209, v78, v79
    v_cvt_pk_bf16_f32 v210, v80, v81
    v_cvt_pk_bf16_f32 v211, v82, v83
    s_nop 1
    v_permlane32_swap_b32 v208, v210
    v_permlane32_swap_b32 v209, v211
    s_add_u32 s53, s57, 0x70000
    buffer_store_dwordx4 v[208:211], v16, s[40:43], s53 offen
    v_cvt_pk_bf16_f32 v236, v132, v133
    v_cvt_pk_bf16_f32 v237, v134, v135
    v_cvt_pk_bf16_f32 v238, v136, v137
    v_cvt_pk_bf16_f32 v239, v138, v139
    s_nop 1
    v_permlane32_swap_b32 v236, v238
    v_permlane32_swap_b32 v237, v239
    s_add_u32 s53, s57, 0x60400
    buffer_store_dwordx4 v[236:239], v16, s[40:43], s53 offen
    v_cvt_pk_bf16_f32 v240, v140, v141
    v_cvt_pk_bf16_f32 v241, v142, v143
    v_cvt_pk_bf16_f32 v242, v144, v145
    v_cvt_pk_bf16_f32 v243, v146, v147
    s_nop 1
    v_permlane32_swap_b32 v240, v242
    v_permlane32_swap_b32 v241, v243
    s_add_u32 s53, s57, 0x70400
    buffer_store_dwordx4 v[240:243], v16, s[40:43], s53 offen
projb_kernel_end:
    s_endpgm
projb_kernel_pre0:
    s_sub_u32 s2, s2, 32
    s_cmp_ge_u32 s2, 16
    s_cbranch_scc1 pre0_end
    s_load_dwordx2 s[4:5], s[0:1], 0
    s_load_dwordx2 s[6:7], s[0:1], 64
    s_load_dwordx2 s[8:9], s[0:1], 72
    s_load_dwordx2 s[10:11], s[0:1], 88
    s_load_dwordx2 s[12:13], s[0:1], 112
    v_lshrrev_b32 v1, 6, v0
    v_and_b32 v4, 63, v0
    v_and_b32 v2, 31, v0
    v_lshrrev_b32 v3, 5, v4
    s_nop 1
    v_readfirstlane_b32 s14, v1
    s_waitcnt lgkmcnt(0)
    s_mov_b32 s16, s4
    s_mov_b32 s17, s5
    s_mov_b32 s18, 0x200000
    s_mov_b32 s19, 0x00020000
    s_mov_b32 s20, s6
    s_mov_b32 s21, s7
    s_mov_b32 s22, 0x4000
    s_mov_b32 s23, 0x00020000
    s_mov_b32 s24, s8
    s_mov_b32 s25, s9
    s_mov_b32 s26, 0x4000
    s_mov_b32 s27, 0x00020000
    s_mov_b32 s28, s10
    s_mov_b32 s29, s11
    s_mov_b32 s30, 0x400
    s_mov_b32 s31, 0x00020000
    s_add_u32 s32, s12, 0x4200000
    s_addc_u32 s33, s13, 0x0
    s_mov_b32 s34, 0x10000
    s_mov_b32 s35, 0x00020000
    s_add_u32 s36, s12, 0x4210000
    s_addc_u32 s37, s13, 0x0
    s_mov_b32 s38, 0x10000
    s_mov_b32 s39, 0x00020000
    s_add_u32 s40, s12, 0x4220000
    s_addc_u32 s41, s13, 0x0
    s_mov_b32 s42, 0x4000
    s_mov_b32 s43, 0x00020000
    s_lshl_b32 s15, s2, 2
    s_add_u32 s15, s15, s14
    v_lshlrev_b32 v5, 6, v0
    buffer_load_dwordx4 v[8:11], v5, s[20:23], 0 offen offset:0
    buffer_load_dwordx4 v[12:15], v5, s[20:23], 0 offen offset:16
    buffer_load_dwordx4 v[16:19], v5, s[20:23], 0 offen offset:32
    buffer_load_dwordx4 v[20:23], v5, s[20:23], 0 offen offset:48
    buffer_load_dwordx4 v[24:27], v5, s[24:27], 0 offen offset:0
    buffer_load_dwordx4 v[28:31], v5, s[24:27], 0 offen offset:16
    buffer_load_dwordx4 v[32:35], v5, s[24:27], 0 offen offset:32
    buffer_load_dwordx4 v[36:39], v5, s[24:27], 0 offen offset:48
    v_lshlrev_b32 v6, 7, v0
    s_waitcnt vmcnt(0)
    ds_write_b128 v6, v[8:11] offset:0
    ds_write_b128 v6, v[12:15] offset:16
    ds_write_b128 v6, v[24:27] offset:32
    ds_write_b128 v6, v[28:31] offset:48
    ds_write_b128 v6, v[16:19] offset:64
    ds_write_b128 v6, v[20:23] offset:80
    ds_write_b128 v6, v[32:35] offset:96
    ds_write_b128 v6, v[36:39] offset:112
    s_lshl_b32 s3, s15, 5
    v_add_u32 v5, s3, v2
    v_lshlrev_b32 v5, 10, v5
    v_lshlrev_b32 v7, 4, v3
    v_add_u32 v5, v5, v7
    buffer_load_dwordx4 v[40:43], v5, s[16:19], 0 offen offset:0
    buffer_load_dwordx4 v[44:47], v5, s[16:19], 0 offen offset:32
    buffer_load_dwordx4 v[48:51], v5, s[16:19], 0 offen offset:64
    buffer_load_dwordx4 v[52:55], v5, s[16:19], 0 offen offset:96
    buffer_load_dwordx4 v[56:59], v5, s[16:19], 0 offen offset:128
    buffer_load_dwordx4 v[60:63], v5, s[16:19], 0 offen offset:160
    buffer_load_dwordx4 v[64:67], v5, s[16:19], 0 offen offset:192
    buffer_load_dwordx4 v[68:71], v5, s[16:19], 0 offen offset:224
    buffer_load_dwordx4 v[72:75], v5, s[16:19], 0 offen offset:256
    buffer_load_dwordx4 v[76:79], v5, s[16:19], 0 offen offset:288
    buffer_load_dwordx4 v[80:83], v5, s[16:19], 0 offen offset:320
    buffer_load_dwordx4 v[84:87], v5, s[16:19], 0 offen offset:352
    buffer_load_dwordx4 v[88:91], v5, s[16:19], 0 offen offset:384
    buffer_load_dwordx4 v[92:95], v5, s[16:19], 0 offen offset:416
    buffer_load_dwordx4 v[96:99], v5, s[16:19], 0 offen offset:448
    buffer_load_dwordx4 v[100:103], v5, s[16:19], 0 offen offset:480
    buffer_load_dwordx4 v[104:107], v5, s[16:19], 0 offen offset:512
    buffer_load_dwordx4 v[108:111], v5, s[16:19], 0 offen offset:544
    buffer_load_dwordx4 v[112:115], v5, s[16:19], 0 offen offset:576
    buffer_load_dwordx4 v[116:119], v5, s[16:19], 0 offen offset:608
    buffer_load_dwordx4 v[120:123], v5, s[16:19], 0 offen offset:640
    buffer_load_dwordx4 v[124:127], v5, s[16:19], 0 offen offset:672
    buffer_load_dwordx4 v[128:131], v5, s[16:19], 0 offen offset:704
    buffer_load_dwordx4 v[132:135], v5, s[16:19], 0 offen offset:736
    buffer_load_dwordx4 v[136:139], v5, s[16:19], 0 offen offset:768
    buffer_load_dwordx4 v[140:143], v5, s[16:19], 0 offen offset:800
    buffer_load_dwordx4 v[144:147], v5, s[16:19], 0 offen offset:832
    buffer_load_dwordx4 v[148:151], v5, s[16:19], 0 offen offset:864
    buffer_load_dwordx4 v[152:155], v5, s[16:19], 0 offen offset:896
    buffer_load_dwordx4 v[156:159], v5, s[16:19], 0 offen offset:928
    buffer_load_dwordx4 v[160:163], v5, s[16:19], 0 offen offset:960
    buffer_load_dwordx4 v[164:167], v5, s[16:19], 0 offen offset:992
    buffer_load_dwordx4 a[0:3], v7, s[28:31], 0 offen offset:0
    buffer_load_dwordx4 a[4:7], v7, s[28:31], 0 offen offset:32
    buffer_load_dwordx4 a[8:11], v7, s[28:31], 0 offen offset:64
    buffer_load_dwordx4 a[12:15], v7, s[28:31], 0 offen offset:96
    buffer_load_dwordx4 a[16:19], v7, s[28:31], 0 offen offset:128
    buffer_load_dwordx4 a[20:23], v7, s[28:31], 0 offen offset:160
    buffer_load_dwordx4 a[24:27], v7, s[28:31], 0 offen offset:192
    buffer_load_dwordx4 a[28:31], v7, s[28:31], 0 offen offset:224
    buffer_load_dwordx4 a[32:35], v7, s[28:31], 0 offen offset:256
    buffer_load_dwordx4 a[36:39], v7, s[28:31], 0 offen offset:288
    buffer_load_dwordx4 a[40:43], v7, s[28:31], 0 offen offset:320
    buffer_load_dwordx4 a[44:47], v7, s[28:31], 0 offen offset:352
    buffer_load_dwordx4 a[48:51], v7, s[28:31], 0 offen offset:384
    buffer_load_dwordx4 a[52:55], v7, s[28:31], 0 offen offset:416
    buffer_load_dwordx4 a[56:59], v7, s[28:31], 0 offen offset:448
    buffer_load_dwordx4 a[60:63], v7, s[28:31], 0 offen offset:480
    buffer_load_dwordx4 a[64:67], v7, s[28:31], 0 offen offset:512
    buffer_load_dwordx4 a[68:71], v7, s[28:31], 0 offen offset:544
    buffer_load_dwordx4 a[72:75], v7, s[28:31], 0 offen offset:576
    buffer_load_dwordx4 a[76:79], v7, s[28:31], 0 offen offset:608
    buffer_load_dwordx4 a[80:83], v7, s[28:31], 0 offen offset:640
    buffer_load_dwordx4 a[84:87], v7, s[28:31], 0 offen offset:672
    buffer_load_dwordx4 a[88:91], v7, s[28:31], 0 offen offset:704
    buffer_load_dwordx4 a[92:95], v7, s[28:31], 0 offen offset:736
    buffer_load_dwordx4 a[96:99], v7, s[28:31], 0 offen offset:768
    buffer_load_dwordx4 a[100:103], v7, s[28:31], 0 offen offset:800
    buffer_load_dwordx4 a[104:107], v7, s[28:31], 0 offen offset:832
    buffer_load_dwordx4 a[108:111], v7, s[28:31], 0 offen offset:864
    buffer_load_dwordx4 a[112:115], v7, s[28:31], 0 offen offset:896
    buffer_load_dwordx4 a[116:119], v7, s[28:31], 0 offen offset:928
    buffer_load_dwordx4 a[120:123], v7, s[28:31], 0 offen offset:960
    buffer_load_dwordx4 a[124:127], v7, s[28:31], 0 offen offset:992
    s_waitcnt lgkmcnt(0)
    s_barrier
    v_lshrrev_b32 v168, 4, v4
    v_and_b32 v169, 15, v4
    v_lshrrev_b32 v169, 2, v169
    v_lshrrev_b32 v5, 1, v168
    v_lshlrev_b32 v5, 3, v5
    v_add_u32 v5, v5, v169
    v_lshlrev_b32 v5, 6, v5
    v_and_b32 v6, 1, v168
    v_lshlrev_b32 v6, 5, v6
    v_add_u32 v5, v5, v6
    v_and_b32 v6, 3, v4
    v_lshlrev_b32 v6, 3, v6
    v_add_u32 v170, v5, v6
    s_waitcnt vmcnt(0)
    ds_read_b64_tr_b16 v[204:205], v170 offset:0
    ds_read_b64_tr_b16 v[206:207], v170 offset:256
    s_waitcnt lgkmcnt(0)
    v_mfma_f32_32x32x16_bf16 v[172:187], v[204:207], v[40:43], 0
    v_mfma_f32_32x32x16_bf16 v[188:203], v[40:43], v[204:207], 0
    ds_read_b64_tr_b16 v[208:209], v170 offset:1024
    ds_read_b64_tr_b16 v[210:211], v170 offset:1280
    s_waitcnt lgkmcnt(0)
    v_mfma_f32_32x32x16_bf16 v[172:187], v[208:211], v[44:47], v[172:187]
    v_mfma_f32_32x32x16_bf16 v[188:203], v[44:47], v[208:211], v[188:203]
    ds_read_b64_tr_b16 v[204:205], v170 offset:2048
    ds_read_b64_tr_b16 v[206:207], v170 offset:2304
    s_waitcnt lgkmcnt(0)
    v_mfma_f32_32x32x16_bf16 v[172:187], v[204:207], v[48:51], v[172:187]
    v_mfma_f32_32x32x16_bf16 v[188:203], v[48:51], v[204:207], v[188:203]
    ds_read_b64_tr_b16 v[208:209], v170 offset:3072
    ds_read_b64_tr_b16 v[210:211], v170 offset:3328
    s_waitcnt lgkmcnt(0)
    v_mfma_f32_32x32x16_bf16 v[172:187], v[208:211], v[52:55], v[172:187]
    v_mfma_f32_32x32x16_bf16 v[188:203], v[52:55], v[208:211], v[188:203]
    ds_read_b64_tr_b16 v[204:205], v170 offset:4096
    ds_read_b64_tr_b16 v[206:207], v170 offset:4352
    s_waitcnt lgkmcnt(0)
    v_mfma_f32_32x32x16_bf16 v[172:187], v[204:207], v[56:59], v[172:187]
    v_mfma_f32_32x32x16_bf16 v[188:203], v[56:59], v[204:207], v[188:203]
    ds_read_b64_tr_b16 v[208:209], v170 offset:5120
    ds_read_b64_tr_b16 v[210:211], v170 offset:5376
    s_waitcnt lgkmcnt(0)
    v_mfma_f32_32x32x16_bf16 v[172:187], v[208:211], v[60:63], v[172:187]
    v_mfma_f32_32x32x16_bf16 v[188:203], v[60:63], v[208:211], v[188:203]
    ds_read_b64_tr_b16 v[204:205], v170 offset:6144
    ds_read_b64_tr_b16 v[206:207], v170 offset:6400
    s_waitcnt lgkmcnt(0)
    v_mfma_f32_32x32x16_bf16 v[172:187], v[204:207], v[64:67], v[172:187]
    v_mfma_f32_32x32x16_bf16 v[188:203], v[64:67], v[204:207], v[188:203]
    ds_read_b64_tr_b16 v[208:209], v170 offset:7168
    ds_read_b64_tr_b16 v[210:211], v170 offset:7424
    s_waitcnt lgkmcnt(0)
    v_mfma_f32_32x32x16_bf16 v[172:187], v[208:211], v[68:71], v[172:187]
    v_mfma_f32_32x32x16_bf16 v[188:203], v[68:71], v[208:211], v[188:203]
    ds_read_b64_tr_b16 v[204:205], v170 offset:8192
    ds_read_b64_tr_b16 v[206:207], v170 offset:8448
    s_waitcnt lgkmcnt(0)
    v_mfma_f32_32x32x16_bf16 v[172:187], v[204:207], v[72:75], v[172:187]
    v_mfma_f32_32x32x16_bf16 v[188:203], v[72:75], v[204:207], v[188:203]
    ds_read_b64_tr_b16 v[208:209], v170 offset:9216
    ds_read_b64_tr_b16 v[210:211], v170 offset:9472
    s_waitcnt lgkmcnt(0)
    v_mfma_f32_32x32x16_bf16 v[172:187], v[208:211], v[76:79], v[172:187]
    v_mfma_f32_32x32x16_bf16 v[188:203], v[76:79], v[208:211], v[188:203]
    ds_read_b64_tr_b16 v[204:205], v170 offset:10240
    ds_read_b64_tr_b16 v[206:207], v170 offset:10496
    s_waitcnt lgkmcnt(0)
    v_mfma_f32_32x32x16_bf16 v[172:187], v[204:207], v[80:83], v[172:187]
    v_mfma_f32_32x32x16_bf16 v[188:203], v[80:83], v[204:207], v[188:203]
    ds_read_b64_tr_b16 v[208:209], v170 offset:11264
    ds_read_b64_tr_b16 v[210:211], v170 offset:11520
    s_waitcnt lgkmcnt(0)
    v_mfma_f32_32x32x16_bf16 v[172:187], v[208:211], v[84:87], v[172:187]
    v_mfma_f32_32x32x16_bf16 v[188:203], v[84:87], v[208:211], v[188:203]
    ds_read_b64_tr_b16 v[204:205], v170 offset:12288
    ds_read_b64_tr_b16 v[206:207], v170 offset:12544
    s_waitcnt lgkmcnt(0)
    v_mfma_f32_32x32x16_bf16 v[172:187], v[204:207], v[88:91], v[172:187]
    v_mfma_f32_32x32x16_bf16 v[188:203], v[88:91], v[204:207], v[188:203]
    ds_read_b64_tr_b16 v[208:209], v170 offset:13312
    ds_read_b64_tr_b16 v[210:211], v170 offset:13568
    s_waitcnt lgkmcnt(0)
    v_mfma_f32_32x32x16_bf16 v[172:187], v[208:211], v[92:95], v[172:187]
    v_mfma_f32_32x32x16_bf16 v[188:203], v[92:95], v[208:211], v[188:203]
    ds_read_b64_tr_b16 v[204:205], v170 offset:14336
    ds_read_b64_tr_b16 v[206:207], v170 offset:14592
    s_waitcnt lgkmcnt(0)
    v_mfma_f32_32x32x16_bf16 v[172:187], v[204:207], v[96:99], v[172:187]
    v_mfma_f32_32x32x16_bf16 v[188:203], v[96:99], v[204:207], v[188:203]
    ds_read_b64_tr_b16 v[208:209], v170 offset:15360
    ds_read_b64_tr_b16 v[210:211], v170 offset:15616
    s_waitcnt lgkmcnt(0)
    v_mfma_f32_32x32x16_bf16 v[172:187], v[208:211], v[100:103], v[172:187]
    v_mfma_f32_32x32x16_bf16 v[188:203], v[100:103], v[208:211], v[188:203]
    ds_read_b64_tr_b16 v[204:205], v170 offset:16384
    ds_read_b64_tr_b16 v[206:207], v170 offset:16640
    s_waitcnt lgkmcnt(0)
    v_mfma_f32_32x32x16_bf16 v[172:187], v[204:207], v[104:107], v[172:187]
    v_mfma_f32_32x32x16_bf16 v[188:203], v[104:107], v[204:207], v[188:203]
    ds_read_b64_tr_b16 v[208:209], v170 offset:17408
    ds_read_b64_tr_b16 v[210:211], v170 offset:17664
    s_waitcnt lgkmcnt(0)
    v_mfma_f32_32x32x16_bf16 v[172:187], v[208:211], v[108:111], v[172:187]
    v_mfma_f32_32x32x16_bf16 v[188:203], v[108:111], v[208:211], v[188:203]
    ds_read_b64_tr_b16 v[204:205], v170 offset:18432
    ds_read_b64_tr_b16 v[206:207], v170 offset:18688
    s_waitcnt lgkmcnt(0)
    v_mfma_f32_32x32x16_bf16 v[172:187], v[204:207], v[112:115], v[172:187]
    v_mfma_f32_32x32x16_bf16 v[188:203], v[112:115], v[204:207], v[188:203]
    ds_read_b64_tr_b16 v[208:209], v170 offset:19456
    ds_read_b64_tr_b16 v[210:211], v170 offset:19712
    s_waitcnt lgkmcnt(0)
    v_mfma_f32_32x32x16_bf16 v[172:187], v[208:211], v[116:119], v[172:187]
    v_mfma_f32_32x32x16_bf16 v[188:203], v[116:119], v[208:211], v[188:203]
    ds_read_b64_tr_b16 v[204:205], v170 offset:20480
    ds_read_b64_tr_b16 v[206:207], v170 offset:20736
    s_waitcnt lgkmcnt(0)
    v_mfma_f32_32x32x16_bf16 v[172:187], v[204:207], v[120:123], v[172:187]
    v_mfma_f32_32x32x16_bf16 v[188:203], v[120:123], v[204:207], v[188:203]
    ds_read_b64_tr_b16 v[208:209], v170 offset:21504
    ds_read_b64_tr_b16 v[210:211], v170 offset:21760
    s_waitcnt lgkmcnt(0)
    v_mfma_f32_32x32x16_bf16 v[172:187], v[208:211], v[124:127], v[172:187]
    v_mfma_f32_32x32x16_bf16 v[188:203], v[124:127], v[208:211], v[188:203]
    ds_read_b64_tr_b16 v[204:205], v170 offset:22528
    ds_read_b64_tr_b16 v[206:207], v170 offset:22784
    s_waitcnt lgkmcnt(0)
    v_mfma_f32_32x32x16_bf16 v[172:187], v[204:207], v[128:131], v[172:187]
    v_mfma_f32_32x32x16_bf16 v[188:203], v[128:131], v[204:207], v[188:203]
    ds_read_b64_tr_b16 v[208:209], v170 offset:23552
    ds_read_b64_tr_b16 v[210:211], v170 offset:23808
    s_waitcnt lgkmcnt(0)
    v_mfma_f32_32x32x16_bf16 v[172:187], v[208:211], v[132:135], v[172:187]
    v_mfma_f32_32x32x16_bf16 v[188:203], v[132:135], v[208:211], v[188:203]
    ds_read_b64_tr_b16 v[204:205], v170 offset:24576
    ds_read_b64_tr_b16 v[206:207], v170 offset:24832
    s_waitcnt lgkmcnt(0)
    v_mfma_f32_32x32x16_bf16 v[172:187], v[204:207], v[136:139], v[172:187]
    v_mfma_f32_32x32x16_bf16 v[188:203], v[136:139], v[204:207], v[188:203]
    ds_read_b64_tr_b16 v[208:209], v170 offset:25600
    ds_read_b64_tr_b16 v[210:211], v170 offset:25856
    s_waitcnt lgkmcnt(0)
    v_mfma_f32_32x32x16_bf16 v[172:187], v[208:211], v[140:143], v[172:187]
    v_mfma_f32_32x32x16_bf16 v[188:203], v[140:143], v[208:211], v[188:203]
    ds_read_b64_tr_b16 v[204:205], v170 offset:26624
    ds_read_b64_tr_b16 v[206:207], v170 offset:26880
    s_waitcnt lgkmcnt(0)
    v_mfma_f32_32x32x16_bf16 v[172:187], v[204:207], v[144:147], v[172:187]
    v_mfma_f32_32x32x16_bf16 v[188:203], v[144:147], v[204:207], v[188:203]
    ds_read_b64_tr_b16 v[208:209], v170 offset:27648
    ds_read_b64_tr_b16 v[210:211], v170 offset:27904
    s_waitcnt lgkmcnt(0)
    v_mfma_f32_32x32x16_bf16 v[172:187], v[208:211], v[148:151], v[172:187]
    v_mfma_f32_32x32x16_bf16 v[188:203], v[148:151], v[208:211], v[188:203]
    ds_read_b64_tr_b16 v[204:205], v170 offset:28672
    ds_read_b64_tr_b16 v[206:207], v170 offset:28928
    s_waitcnt lgkmcnt(0)
    v_mfma_f32_32x32x16_bf16 v[172:187], v[204:207], v[152:155], v[172:187]
    v_mfma_f32_32x32x16_bf16 v[188:203], v[152:155], v[204:207], v[188:203]
    ds_read_b64_tr_b16 v[208:209], v170 offset:29696
    ds_read_b64_tr_b16 v[210:211], v170 offset:29952
    s_waitcnt lgkmcnt(0)
    v_mfma_f32_32x32x16_bf16 v[172:187], v[208:211], v[156:159], v[172:187]
    v_mfma_f32_32x32x16_bf16 v[188:203], v[156:159], v[208:211], v[188:203]
    ds_read_b64_tr_b16 v[204:205], v170 offset:30720
    ds_read_b64_tr_b16 v[206:207], v170 offset:30976
    s_waitcnt lgkmcnt(0)
    v_mfma_f32_32x32x16_bf16 v[172:187], v[204:207], v[160:163], v[172:187]
    v_mfma_f32_32x32x16_bf16 v[188:203], v[160:163], v[204:207], v[188:203]
    ds_read_b64_tr_b16 v[208:209], v170 offset:31744
    ds_read_b64_tr_b16 v[210:211], v170 offset:32000
    s_waitcnt lgkmcnt(0)
    v_mfma_f32_32x32x16_bf16 v[172:187], v[208:211], v[164:167], v[172:187]
    v_mfma_f32_32x32x16_bf16 v[188:203], v[164:167], v[208:211], v[188:203]
    v_mov_b32 v212, 0
    v_accvgpr_read_b32 v217, a0
    v_lshlrev_b32 v213, 16, v40
    v_lshlrev_b32 v214, 16, v217
    v_mul_f32 v213, v213, v214
    v_and_b32 v215, 0xffff0000, v40
    v_and_b32 v216, 0xffff0000, v217
    v_mul_f32 v215, v215, v216
    v_cvt_pk_bf16_f32 v213, v213, v215
    v_lshlrev_b32 v214, 16, v213
    v_and_b32 v215, 0xffff0000, v213
    v_add_f32 v212, v212, v214
    v_add_f32 v212, v212, v215
    v_accvgpr_read_b32 v217, a1
    v_lshlrev_b32 v213, 16, v41
    v_lshlrev_b32 v214, 16, v217
    v_mul_f32 v213, v213, v214
    v_and_b32 v215, 0xffff0000, v41
    v_and_b32 v216, 0xffff0000, v217
    v_mul_f32 v215, v215, v216
    v_cvt_pk_bf16_f32 v213, v213, v215
    v_lshlrev_b32 v214, 16, v213
    v_and_b32 v215, 0xffff0000, v213
    v_add_f32 v212, v212, v214
    v_add_f32 v212, v212, v215
    v_accvgpr_read_b32 v217, a2
    v_lshlrev_b32 v213, 16, v42
    v_lshlrev_b32 v214, 16, v217
    v_mul_f32 v213, v213, v214
    v_and_b32 v215, 0xffff0000, v42
    v_and_b32 v216, 0xffff0000, v217
    v_mul_f32 v215, v215, v216
    v_cvt_pk_bf16_f32 v213, v213, v215
    v_lshlrev_b32 v214, 16, v213
    v_and_b32 v215, 0xffff0000, v213
    v_add_f32 v212, v212, v214
    v_add_f32 v212, v212, v215
    v_accvgpr_read_b32 v217, a3
    v_lshlrev_b32 v213, 16, v43
    v_lshlrev_b32 v214, 16, v217
    v_mul_f32 v213, v213, v214
    v_and_b32 v215, 0xffff0000, v43
    v_and_b32 v216, 0xffff0000, v217
    v_mul_f32 v215, v215, v216
    v_cvt_pk_bf16_f32 v213, v213, v215
    v_lshlrev_b32 v214, 16, v213
    v_and_b32 v215, 0xffff0000, v213
    v_add_f32 v212, v212, v214
    v_add_f32 v212, v212, v215
    v_accvgpr_read_b32 v217, a4
    v_lshlrev_b32 v213, 16, v44
    v_lshlrev_b32 v214, 16, v217
    v_mul_f32 v213, v213, v214
    v_and_b32 v215, 0xffff0000, v44
    v_and_b32 v216, 0xffff0000, v217
    v_mul_f32 v215, v215, v216
    v_cvt_pk_bf16_f32 v213, v213, v215
    v_lshlrev_b32 v214, 16, v213
    v_and_b32 v215, 0xffff0000, v213
    v_add_f32 v212, v212, v214
    v_add_f32 v212, v212, v215
    v_accvgpr_read_b32 v217, a5
    v_lshlrev_b32 v213, 16, v45
    v_lshlrev_b32 v214, 16, v217
    v_mul_f32 v213, v213, v214
    v_and_b32 v215, 0xffff0000, v45
    v_and_b32 v216, 0xffff0000, v217
    v_mul_f32 v215, v215, v216
    v_cvt_pk_bf16_f32 v213, v213, v215
    v_lshlrev_b32 v214, 16, v213
    v_and_b32 v215, 0xffff0000, v213
    v_add_f32 v212, v212, v214
    v_add_f32 v212, v212, v215
    v_accvgpr_read_b32 v217, a6
    v_lshlrev_b32 v213, 16, v46
    v_lshlrev_b32 v214, 16, v217
    v_mul_f32 v213, v213, v214
    v_and_b32 v215, 0xffff0000, v46
    v_and_b32 v216, 0xffff0000, v217
    v_mul_f32 v215, v215, v216
    v_cvt_pk_bf16_f32 v213, v213, v215
    v_lshlrev_b32 v214, 16, v213
    v_and_b32 v215, 0xffff0000, v213
    v_add_f32 v212, v212, v214
    v_add_f32 v212, v212, v215
    v_accvgpr_read_b32 v217, a7
    v_lshlrev_b32 v213, 16, v47
    v_lshlrev_b32 v214, 16, v217
    v_mul_f32 v213, v213, v214
    v_and_b32 v215, 0xffff0000, v47
    v_and_b32 v216, 0xffff0000, v217
    v_mul_f32 v215, v215, v216
    v_cvt_pk_bf16_f32 v213, v213, v215
    v_lshlrev_b32 v214, 16, v213
    v_and_b32 v215, 0xffff0000, v213
    v_add_f32 v212, v212, v214
    v_add_f32 v212, v212, v215
    v_accvgpr_read_b32 v217, a8
    v_lshlrev_b32 v213, 16, v48
    v_lshlrev_b32 v214, 16, v217
    v_mul_f32 v213, v213, v214
    v_and_b32 v215, 0xffff0000, v48
    v_and_b32 v216, 0xffff0000, v217
    v_mul_f32 v215, v215, v216
    v_cvt_pk_bf16_f32 v213, v213, v215
    v_lshlrev_b32 v214, 16, v213
    v_and_b32 v215, 0xffff0000, v213
    v_add_f32 v212, v212, v214
    v_add_f32 v212, v212, v215
    v_accvgpr_read_b32 v217, a9
    v_lshlrev_b32 v213, 16, v49
    v_lshlrev_b32 v214, 16, v217
    v_mul_f32 v213, v213, v214
    v_and_b32 v215, 0xffff0000, v49
    v_and_b32 v216, 0xffff0000, v217
    v_mul_f32 v215, v215, v216
    v_cvt_pk_bf16_f32 v213, v213, v215
    v_lshlrev_b32 v214, 16, v213
    v_and_b32 v215, 0xffff0000, v213
    v_add_f32 v212, v212, v214
    v_add_f32 v212, v212, v215
    v_accvgpr_read_b32 v217, a10
    v_lshlrev_b32 v213, 16, v50
    v_lshlrev_b32 v214, 16, v217
    v_mul_f32 v213, v213, v214
    v_and_b32 v215, 0xffff0000, v50
    v_and_b32 v216, 0xffff0000, v217
    v_mul_f32 v215, v215, v216
    v_cvt_pk_bf16_f32 v213, v213, v215
    v_lshlrev_b32 v214, 16, v213
    v_and_b32 v215, 0xffff0000, v213
    v_add_f32 v212, v212, v214
    v_add_f32 v212, v212, v215
    v_accvgpr_read_b32 v217, a11
    v_lshlrev_b32 v213, 16, v51
    v_lshlrev_b32 v214, 16, v217
    v_mul_f32 v213, v213, v214
    v_and_b32 v215, 0xffff0000, v51
    v_and_b32 v216, 0xffff0000, v217
    v_mul_f32 v215, v215, v216
    v_cvt_pk_bf16_f32 v213, v213, v215
    v_lshlrev_b32 v214, 16, v213
    v_and_b32 v215, 0xffff0000, v213
    v_add_f32 v212, v212, v214
    v_add_f32 v212, v212, v215
    v_accvgpr_read_b32 v217, a12
    v_lshlrev_b32 v213, 16, v52
    v_lshlrev_b32 v214, 16, v217
    v_mul_f32 v213, v213, v214
    v_and_b32 v215, 0xffff0000, v52
    v_and_b32 v216, 0xffff0000, v217
    v_mul_f32 v215, v215, v216
    v_cvt_pk_bf16_f32 v213, v213, v215
    v_lshlrev_b32 v214, 16, v213
    v_and_b32 v215, 0xffff0000, v213
    v_add_f32 v212, v212, v214
    v_add_f32 v212, v212, v215
    v_accvgpr_read_b32 v217, a13
    v_lshlrev_b32 v213, 16, v53
    v_lshlrev_b32 v214, 16, v217
    v_mul_f32 v213, v213, v214
    v_and_b32 v215, 0xffff0000, v53
    v_and_b32 v216, 0xffff0000, v217
    v_mul_f32 v215, v215, v216
    v_cvt_pk_bf16_f32 v213, v213, v215
    v_lshlrev_b32 v214, 16, v213
    v_and_b32 v215, 0xffff0000, v213
    v_add_f32 v212, v212, v214
    v_add_f32 v212, v212, v215
    v_accvgpr_read_b32 v217, a14
    v_lshlrev_b32 v213, 16, v54
    v_lshlrev_b32 v214, 16, v217
    v_mul_f32 v213, v213, v214
    v_and_b32 v215, 0xffff0000, v54
    v_and_b32 v216, 0xffff0000, v217
    v_mul_f32 v215, v215, v216
    v_cvt_pk_bf16_f32 v213, v213, v215
    v_lshlrev_b32 v214, 16, v213
    v_and_b32 v215, 0xffff0000, v213
    v_add_f32 v212, v212, v214
    v_add_f32 v212, v212, v215
    v_accvgpr_read_b32 v217, a15
    v_lshlrev_b32 v213, 16, v55
    v_lshlrev_b32 v214, 16, v217
    v_mul_f32 v213, v213, v214
    v_and_b32 v215, 0xffff0000, v55
    v_and_b32 v216, 0xffff0000, v217
    v_mul_f32 v215, v215, v216
    v_cvt_pk_bf16_f32 v213, v213, v215
    v_lshlrev_b32 v214, 16, v213
    v_and_b32 v215, 0xffff0000, v213
    v_add_f32 v212, v212, v214
    v_add_f32 v212, v212, v215
    v_accvgpr_read_b32 v217, a16
    v_lshlrev_b32 v213, 16, v56
    v_lshlrev_b32 v214, 16, v217
    v_mul_f32 v213, v213, v214
    v_and_b32 v215, 0xffff0000, v56
    v_and_b32 v216, 0xffff0000, v217
    v_mul_f32 v215, v215, v216
    v_cvt_pk_bf16_f32 v213, v213, v215
    v_lshlrev_b32 v214, 16, v213
    v_and_b32 v215, 0xffff0000, v213
    v_add_f32 v212, v212, v214
    v_add_f32 v212, v212, v215
    v_accvgpr_read_b32 v217, a17
    v_lshlrev_b32 v213, 16, v57
    v_lshlrev_b32 v214, 16, v217
    v_mul_f32 v213, v213, v214
    v_and_b32 v215, 0xffff0000, v57
    v_and_b32 v216, 0xffff0000, v217
    v_mul_f32 v215, v215, v216
    v_cvt_pk_bf16_f32 v213, v213, v215
    v_lshlrev_b32 v214, 16, v213
    v_and_b32 v215, 0xffff0000, v213
    v_add_f32 v212, v212, v214
    v_add_f32 v212, v212, v215
    v_accvgpr_read_b32 v217, a18
    v_lshlrev_b32 v213, 16, v58
    v_lshlrev_b32 v214, 16, v217
    v_mul_f32 v213, v213, v214
    v_and_b32 v215, 0xffff0000, v58
    v_and_b32 v216, 0xffff0000, v217
    v_mul_f32 v215, v215, v216
    v_cvt_pk_bf16_f32 v213, v213, v215
    v_lshlrev_b32 v214, 16, v213
    v_and_b32 v215, 0xffff0000, v213
    v_add_f32 v212, v212, v214
    v_add_f32 v212, v212, v215
    v_accvgpr_read_b32 v217, a19
    v_lshlrev_b32 v213, 16, v59
    v_lshlrev_b32 v214, 16, v217
    v_mul_f32 v213, v213, v214
    v_and_b32 v215, 0xffff0000, v59
    v_and_b32 v216, 0xffff0000, v217
    v_mul_f32 v215, v215, v216
    v_cvt_pk_bf16_f32 v213, v213, v215
    v_lshlrev_b32 v214, 16, v213
    v_and_b32 v215, 0xffff0000, v213
    v_add_f32 v212, v212, v214
    v_add_f32 v212, v212, v215
    v_accvgpr_read_b32 v217, a20
    v_lshlrev_b32 v213, 16, v60
    v_lshlrev_b32 v214, 16, v217
    v_mul_f32 v213, v213, v214
    v_and_b32 v215, 0xffff0000, v60
    v_and_b32 v216, 0xffff0000, v217
    v_mul_f32 v215, v215, v216
    v_cvt_pk_bf16_f32 v213, v213, v215
    v_lshlrev_b32 v214, 16, v213
    v_and_b32 v215, 0xffff0000, v213
    v_add_f32 v212, v212, v214
    v_add_f32 v212, v212, v215
    v_accvgpr_read_b32 v217, a21
    v_lshlrev_b32 v213, 16, v61
    v_lshlrev_b32 v214, 16, v217
    v_mul_f32 v213, v213, v214
    v_and_b32 v215, 0xffff0000, v61
    v_and_b32 v216, 0xffff0000, v217
    v_mul_f32 v215, v215, v216
    v_cvt_pk_bf16_f32 v213, v213, v215
    v_lshlrev_b32 v214, 16, v213
    v_and_b32 v215, 0xffff0000, v213
    v_add_f32 v212, v212, v214
    v_add_f32 v212, v212, v215
    v_accvgpr_read_b32 v217, a22
    v_lshlrev_b32 v213, 16, v62
    v_lshlrev_b32 v214, 16, v217
    v_mul_f32 v213, v213, v214
    v_and_b32 v215, 0xffff0000, v62
    v_and_b32 v216, 0xffff0000, v217
    v_mul_f32 v215, v215, v216
    v_cvt_pk_bf16_f32 v213, v213, v215
    v_lshlrev_b32 v214, 16, v213
    v_and_b32 v215, 0xffff0000, v213
    v_add_f32 v212, v212, v214
    v_add_f32 v212, v212, v215
    v_accvgpr_read_b32 v217, a23
    v_lshlrev_b32 v213, 16, v63
    v_lshlrev_b32 v214, 16, v217
    v_mul_f32 v213, v213, v214
    v_and_b32 v215, 0xffff0000, v63
    v_and_b32 v216, 0xffff0000, v217
    v_mul_f32 v215, v215, v216
    v_cvt_pk_bf16_f32 v213, v213, v215
    v_lshlrev_b32 v214, 16, v213
    v_and_b32 v215, 0xffff0000, v213
    v_add_f32 v212, v212, v214
    v_add_f32 v212, v212, v215
    v_accvgpr_read_b32 v217, a24
    v_lshlrev_b32 v213, 16, v64
    v_lshlrev_b32 v214, 16, v217
    v_mul_f32 v213, v213, v214
    v_and_b32 v215, 0xffff0000, v64
    v_and_b32 v216, 0xffff0000, v217
    v_mul_f32 v215, v215, v216
    v_cvt_pk_bf16_f32 v213, v213, v215
    v_lshlrev_b32 v214, 16, v213
    v_and_b32 v215, 0xffff0000, v213
    v_add_f32 v212, v212, v214
    v_add_f32 v212, v212, v215
    v_accvgpr_read_b32 v217, a25
    v_lshlrev_b32 v213, 16, v65
    v_lshlrev_b32 v214, 16, v217
    v_mul_f32 v213, v213, v214
    v_and_b32 v215, 0xffff0000, v65
    v_and_b32 v216, 0xffff0000, v217
    v_mul_f32 v215, v215, v216
    v_cvt_pk_bf16_f32 v213, v213, v215
    v_lshlrev_b32 v214, 16, v213
    v_and_b32 v215, 0xffff0000, v213
    v_add_f32 v212, v212, v214
    v_add_f32 v212, v212, v215
    v_accvgpr_read_b32 v217, a26
    v_lshlrev_b32 v213, 16, v66
    v_lshlrev_b32 v214, 16, v217
    v_mul_f32 v213, v213, v214
    v_and_b32 v215, 0xffff0000, v66
    v_and_b32 v216, 0xffff0000, v217
    v_mul_f32 v215, v215, v216
    v_cvt_pk_bf16_f32 v213, v213, v215
    v_lshlrev_b32 v214, 16, v213
    v_and_b32 v215, 0xffff0000, v213
    v_add_f32 v212, v212, v214
    v_add_f32 v212, v212, v215
    v_accvgpr_read_b32 v217, a27
    v_lshlrev_b32 v213, 16, v67
    v_lshlrev_b32 v214, 16, v217
    v_mul_f32 v213, v213, v214
    v_and_b32 v215, 0xffff0000, v67
    v_and_b32 v216, 0xffff0000, v217
    v_mul_f32 v215, v215, v216
    v_cvt_pk_bf16_f32 v213, v213, v215
    v_lshlrev_b32 v214, 16, v213
    v_and_b32 v215, 0xffff0000, v213
    v_add_f32 v212, v212, v214
    v_add_f32 v212, v212, v215
    v_accvgpr_read_b32 v217, a28
    v_lshlrev_b32 v213, 16, v68
    v_lshlrev_b32 v214, 16, v217
    v_mul_f32 v213, v213, v214
    v_and_b32 v215, 0xffff0000, v68
    v_and_b32 v216, 0xffff0000, v217
    v_mul_f32 v215, v215, v216
    v_cvt_pk_bf16_f32 v213, v213, v215
    v_lshlrev_b32 v214, 16, v213
    v_and_b32 v215, 0xffff0000, v213
    v_add_f32 v212, v212, v214
    v_add_f32 v212, v212, v215
    v_accvgpr_read_b32 v217, a29
    v_lshlrev_b32 v213, 16, v69
    v_lshlrev_b32 v214, 16, v217
    v_mul_f32 v213, v213, v214
    v_and_b32 v215, 0xffff0000, v69
    v_and_b32 v216, 0xffff0000, v217
    v_mul_f32 v215, v215, v216
    v_cvt_pk_bf16_f32 v213, v213, v215
    v_lshlrev_b32 v214, 16, v213
    v_and_b32 v215, 0xffff0000, v213
    v_add_f32 v212, v212, v214
    v_add_f32 v212, v212, v215
    v_accvgpr_read_b32 v217, a30
    v_lshlrev_b32 v213, 16, v70
    v_lshlrev_b32 v214, 16, v217
    v_mul_f32 v213, v213, v214
    v_and_b32 v215, 0xffff0000, v70
    v_and_b32 v216, 0xffff0000, v217
    v_mul_f32 v215, v215, v216
    v_cvt_pk_bf16_f32 v213, v213, v215
    v_lshlrev_b32 v214, 16, v213
    v_and_b32 v215, 0xffff0000, v213
    v_add_f32 v212, v212, v214
    v_add_f32 v212, v212, v215
    v_accvgpr_read_b32 v217, a31
    v_lshlrev_b32 v213, 16, v71
    v_lshlrev_b32 v214, 16, v217
    v_mul_f32 v213, v213, v214
    v_and_b32 v215, 0xffff0000, v71
    v_and_b32 v216, 0xffff0000, v217
    v_mul_f32 v215, v215, v216
    v_cvt_pk_bf16_f32 v213, v213, v215
    v_lshlrev_b32 v214, 16, v213
    v_and_b32 v215, 0xffff0000, v213
    v_add_f32 v212, v212, v214
    v_add_f32 v212, v212, v215
    v_accvgpr_read_b32 v217, a32
    v_lshlrev_b32 v213, 16, v72
    v_lshlrev_b32 v214, 16, v217
    v_mul_f32 v213, v213, v214
    v_and_b32 v215, 0xffff0000, v72
    v_and_b32 v216, 0xffff0000, v217
    v_mul_f32 v215, v215, v216
    v_cvt_pk_bf16_f32 v213, v213, v215
    v_lshlrev_b32 v214, 16, v213
    v_and_b32 v215, 0xffff0000, v213
    v_add_f32 v212, v212, v214
    v_add_f32 v212, v212, v215
    v_accvgpr_read_b32 v217, a33
    v_lshlrev_b32 v213, 16, v73
    v_lshlrev_b32 v214, 16, v217
    v_mul_f32 v213, v213, v214
    v_and_b32 v215, 0xffff0000, v73
    v_and_b32 v216, 0xffff0000, v217
    v_mul_f32 v215, v215, v216
    v_cvt_pk_bf16_f32 v213, v213, v215
    v_lshlrev_b32 v214, 16, v213
    v_and_b32 v215, 0xffff0000, v213
    v_add_f32 v212, v212, v214
    v_add_f32 v212, v212, v215
    v_accvgpr_read_b32 v217, a34
    v_lshlrev_b32 v213, 16, v74
    v_lshlrev_b32 v214, 16, v217
    v_mul_f32 v213, v213, v214
    v_and_b32 v215, 0xffff0000, v74
    v_and_b32 v216, 0xffff0000, v217
    v_mul_f32 v215, v215, v216
    v_cvt_pk_bf16_f32 v213, v213, v215
    v_lshlrev_b32 v214, 16, v213
    v_and_b32 v215, 0xffff0000, v213
    v_add_f32 v212, v212, v214
    v_add_f32 v212, v212, v215
    v_accvgpr_read_b32 v217, a35
    v_lshlrev_b32 v213, 16, v75
    v_lshlrev_b32 v214, 16, v217
    v_mul_f32 v213, v213, v214
    v_and_b32 v215, 0xffff0000, v75
    v_and_b32 v216, 0xffff0000, v217
    v_mul_f32 v215, v215, v216
    v_cvt_pk_bf16_f32 v213, v213, v215
    v_lshlrev_b32 v214, 16, v213
    v_and_b32 v215, 0xffff0000, v213
    v_add_f32 v212, v212, v214
    v_add_f32 v212, v212, v215
    v_accvgpr_read_b32 v217, a36
    v_lshlrev_b32 v213, 16, v76
    v_lshlrev_b32 v214, 16, v217
    v_mul_f32 v213, v213, v214
    v_and_b32 v215, 0xffff0000, v76
    v_and_b32 v216, 0xffff0000, v217
    v_mul_f32 v215, v215, v216
    v_cvt_pk_bf16_f32 v213, v213, v215
    v_lshlrev_b32 v214, 16, v213
    v_and_b32 v215, 0xffff0000, v213
    v_add_f32 v212, v212, v214
    v_add_f32 v212, v212, v215
    v_accvgpr_read_b32 v217, a37
    v_lshlrev_b32 v213, 16, v77
    v_lshlrev_b32 v214, 16, v217
    v_mul_f32 v213, v213, v214
    v_and_b32 v215, 0xffff0000, v77
    v_and_b32 v216, 0xffff0000, v217
    v_mul_f32 v215, v215, v216
    v_cvt_pk_bf16_f32 v213, v213, v215
    v_lshlrev_b32 v214, 16, v213
    v_and_b32 v215, 0xffff0000, v213
    v_add_f32 v212, v212, v214
    v_add_f32 v212, v212, v215
    v_accvgpr_read_b32 v217, a38
    v_lshlrev_b32 v213, 16, v78
    v_lshlrev_b32 v214, 16, v217
    v_mul_f32 v213, v213, v214
    v_and_b32 v215, 0xffff0000, v78
    v_and_b32 v216, 0xffff0000, v217
    v_mul_f32 v215, v215, v216
    v_cvt_pk_bf16_f32 v213, v213, v215
    v_lshlrev_b32 v214, 16, v213
    v_and_b32 v215, 0xffff0000, v213
    v_add_f32 v212, v212, v214
    v_add_f32 v212, v212, v215
    v_accvgpr_read_b32 v217, a39
    v_lshlrev_b32 v213, 16, v79
    v_lshlrev_b32 v214, 16, v217
    v_mul_f32 v213, v213, v214
    v_and_b32 v215, 0xffff0000, v79
    v_and_b32 v216, 0xffff0000, v217
    v_mul_f32 v215, v215, v216
    v_cvt_pk_bf16_f32 v213, v213, v215
    v_lshlrev_b32 v214, 16, v213
    v_and_b32 v215, 0xffff0000, v213
    v_add_f32 v212, v212, v214
    v_add_f32 v212, v212, v215
    v_accvgpr_read_b32 v217, a40
    v_lshlrev_b32 v213, 16, v80
    v_lshlrev_b32 v214, 16, v217
    v_mul_f32 v213, v213, v214
    v_and_b32 v215, 0xffff0000, v80
    v_and_b32 v216, 0xffff0000, v217
    v_mul_f32 v215, v215, v216
    v_cvt_pk_bf16_f32 v213, v213, v215
    v_lshlrev_b32 v214, 16, v213
    v_and_b32 v215, 0xffff0000, v213
    v_add_f32 v212, v212, v214
    v_add_f32 v212, v212, v215
    v_accvgpr_read_b32 v217, a41
    v_lshlrev_b32 v213, 16, v81
    v_lshlrev_b32 v214, 16, v217
    v_mul_f32 v213, v213, v214
    v_and_b32 v215, 0xffff0000, v81
    v_and_b32 v216, 0xffff0000, v217
    v_mul_f32 v215, v215, v216
    v_cvt_pk_bf16_f32 v213, v213, v215
    v_lshlrev_b32 v214, 16, v213
    v_and_b32 v215, 0xffff0000, v213
    v_add_f32 v212, v212, v214
    v_add_f32 v212, v212, v215
    v_accvgpr_read_b32 v217, a42
    v_lshlrev_b32 v213, 16, v82
    v_lshlrev_b32 v214, 16, v217
    v_mul_f32 v213, v213, v214
    v_and_b32 v215, 0xffff0000, v82
    v_and_b32 v216, 0xffff0000, v217
    v_mul_f32 v215, v215, v216
    v_cvt_pk_bf16_f32 v213, v213, v215
    v_lshlrev_b32 v214, 16, v213
    v_and_b32 v215, 0xffff0000, v213
    v_add_f32 v212, v212, v214
    v_add_f32 v212, v212, v215
    v_accvgpr_read_b32 v217, a43
    v_lshlrev_b32 v213, 16, v83
    v_lshlrev_b32 v214, 16, v217
    v_mul_f32 v213, v213, v214
    v_and_b32 v215, 0xffff0000, v83
    v_and_b32 v216, 0xffff0000, v217
    v_mul_f32 v215, v215, v216
    v_cvt_pk_bf16_f32 v213, v213, v215
    v_lshlrev_b32 v214, 16, v213
    v_and_b32 v215, 0xffff0000, v213
    v_add_f32 v212, v212, v214
    v_add_f32 v212, v212, v215
    v_accvgpr_read_b32 v217, a44
    v_lshlrev_b32 v213, 16, v84
    v_lshlrev_b32 v214, 16, v217
    v_mul_f32 v213, v213, v214
    v_and_b32 v215, 0xffff0000, v84
    v_and_b32 v216, 0xffff0000, v217
    v_mul_f32 v215, v215, v216
    v_cvt_pk_bf16_f32 v213, v213, v215
    v_lshlrev_b32 v214, 16, v213
    v_and_b32 v215, 0xffff0000, v213
    v_add_f32 v212, v212, v214
    v_add_f32 v212, v212, v215
    v_accvgpr_read_b32 v217, a45
    v_lshlrev_b32 v213, 16, v85
    v_lshlrev_b32 v214, 16, v217
    v_mul_f32 v213, v213, v214
    v_and_b32 v215, 0xffff0000, v85
    v_and_b32 v216, 0xffff0000, v217
    v_mul_f32 v215, v215, v216
    v_cvt_pk_bf16_f32 v213, v213, v215
    v_lshlrev_b32 v214, 16, v213
    v_and_b32 v215, 0xffff0000, v213
    v_add_f32 v212, v212, v214
    v_add_f32 v212, v212, v215
    v_accvgpr_read_b32 v217, a46
    v_lshlrev_b32 v213, 16, v86
    v_lshlrev_b32 v214, 16, v217
    v_mul_f32 v213, v213, v214
    v_and_b32 v215, 0xffff0000, v86
    v_and_b32 v216, 0xffff0000, v217
    v_mul_f32 v215, v215, v216
    v_cvt_pk_bf16_f32 v213, v213, v215
    v_lshlrev_b32 v214, 16, v213
    v_and_b32 v215, 0xffff0000, v213
    v_add_f32 v212, v212, v214
    v_add_f32 v212, v212, v215
    v_accvgpr_read_b32 v217, a47
    v_lshlrev_b32 v213, 16, v87
    v_lshlrev_b32 v214, 16, v217
    v_mul_f32 v213, v213, v214
    v_and_b32 v215, 0xffff0000, v87
    v_and_b32 v216, 0xffff0000, v217
    v_mul_f32 v215, v215, v216
    v_cvt_pk_bf16_f32 v213, v213, v215
    v_lshlrev_b32 v214, 16, v213
    v_and_b32 v215, 0xffff0000, v213
    v_add_f32 v212, v212, v214
    v_add_f32 v212, v212, v215
    v_accvgpr_read_b32 v217, a48
    v_lshlrev_b32 v213, 16, v88
    v_lshlrev_b32 v214, 16, v217
    v_mul_f32 v213, v213, v214
    v_and_b32 v215, 0xffff0000, v88
    v_and_b32 v216, 0xffff0000, v217
    v_mul_f32 v215, v215, v216
    v_cvt_pk_bf16_f32 v213, v213, v215
    v_lshlrev_b32 v214, 16, v213
    v_and_b32 v215, 0xffff0000, v213
    v_add_f32 v212, v212, v214
    v_add_f32 v212, v212, v215
    v_accvgpr_read_b32 v217, a49
    v_lshlrev_b32 v213, 16, v89
    v_lshlrev_b32 v214, 16, v217
    v_mul_f32 v213, v213, v214
    v_and_b32 v215, 0xffff0000, v89
    v_and_b32 v216, 0xffff0000, v217
    v_mul_f32 v215, v215, v216
    v_cvt_pk_bf16_f32 v213, v213, v215
    v_lshlrev_b32 v214, 16, v213
    v_and_b32 v215, 0xffff0000, v213
    v_add_f32 v212, v212, v214
    v_add_f32 v212, v212, v215
    v_accvgpr_read_b32 v217, a50
    v_lshlrev_b32 v213, 16, v90
    v_lshlrev_b32 v214, 16, v217
    v_mul_f32 v213, v213, v214
    v_and_b32 v215, 0xffff0000, v90
    v_and_b32 v216, 0xffff0000, v217
    v_mul_f32 v215, v215, v216
    v_cvt_pk_bf16_f32 v213, v213, v215
    v_lshlrev_b32 v214, 16, v213
    v_and_b32 v215, 0xffff0000, v213
    v_add_f32 v212, v212, v214
    v_add_f32 v212, v212, v215
    v_accvgpr_read_b32 v217, a51
    v_lshlrev_b32 v213, 16, v91
    v_lshlrev_b32 v214, 16, v217
    v_mul_f32 v213, v213, v214
    v_and_b32 v215, 0xffff0000, v91
    v_and_b32 v216, 0xffff0000, v217
    v_mul_f32 v215, v215, v216
    v_cvt_pk_bf16_f32 v213, v213, v215
    v_lshlrev_b32 v214, 16, v213
    v_and_b32 v215, 0xffff0000, v213
    v_add_f32 v212, v212, v214
    v_add_f32 v212, v212, v215
    v_accvgpr_read_b32 v217, a52
    v_lshlrev_b32 v213, 16, v92
    v_lshlrev_b32 v214, 16, v217
    v_mul_f32 v213, v213, v214
    v_and_b32 v215, 0xffff0000, v92
    v_and_b32 v216, 0xffff0000, v217
    v_mul_f32 v215, v215, v216
    v_cvt_pk_bf16_f32 v213, v213, v215
    v_lshlrev_b32 v214, 16, v213
    v_and_b32 v215, 0xffff0000, v213
    v_add_f32 v212, v212, v214
    v_add_f32 v212, v212, v215
    v_accvgpr_read_b32 v217, a53
    v_lshlrev_b32 v213, 16, v93
    v_lshlrev_b32 v214, 16, v217
    v_mul_f32 v213, v213, v214
    v_and_b32 v215, 0xffff0000, v93
    v_and_b32 v216, 0xffff0000, v217
    v_mul_f32 v215, v215, v216
    v_cvt_pk_bf16_f32 v213, v213, v215
    v_lshlrev_b32 v214, 16, v213
    v_and_b32 v215, 0xffff0000, v213
    v_add_f32 v212, v212, v214
    v_add_f32 v212, v212, v215
    v_accvgpr_read_b32 v217, a54
    v_lshlrev_b32 v213, 16, v94
    v_lshlrev_b32 v214, 16, v217
    v_mul_f32 v213, v213, v214
    v_and_b32 v215, 0xffff0000, v94
    v_and_b32 v216, 0xffff0000, v217
    v_mul_f32 v215, v215, v216
    v_cvt_pk_bf16_f32 v213, v213, v215
    v_lshlrev_b32 v214, 16, v213
    v_and_b32 v215, 0xffff0000, v213
    v_add_f32 v212, v212, v214
    v_add_f32 v212, v212, v215
    v_accvgpr_read_b32 v217, a55
    v_lshlrev_b32 v213, 16, v95
    v_lshlrev_b32 v214, 16, v217
    v_mul_f32 v213, v213, v214
    v_and_b32 v215, 0xffff0000, v95
    v_and_b32 v216, 0xffff0000, v217
    v_mul_f32 v215, v215, v216
    v_cvt_pk_bf16_f32 v213, v213, v215
    v_lshlrev_b32 v214, 16, v213
    v_and_b32 v215, 0xffff0000, v213
    v_add_f32 v212, v212, v214
    v_add_f32 v212, v212, v215
    v_accvgpr_read_b32 v217, a56
    v_lshlrev_b32 v213, 16, v96
    v_lshlrev_b32 v214, 16, v217
    v_mul_f32 v213, v213, v214
    v_and_b32 v215, 0xffff0000, v96
    v_and_b32 v216, 0xffff0000, v217
    v_mul_f32 v215, v215, v216
    v_cvt_pk_bf16_f32 v213, v213, v215
    v_lshlrev_b32 v214, 16, v213
    v_and_b32 v215, 0xffff0000, v213
    v_add_f32 v212, v212, v214
    v_add_f32 v212, v212, v215
    v_accvgpr_read_b32 v217, a57
    v_lshlrev_b32 v213, 16, v97
    v_lshlrev_b32 v214, 16, v217
    v_mul_f32 v213, v213, v214
    v_and_b32 v215, 0xffff0000, v97
    v_and_b32 v216, 0xffff0000, v217
    v_mul_f32 v215, v215, v216
    v_cvt_pk_bf16_f32 v213, v213, v215
    v_lshlrev_b32 v214, 16, v213
    v_and_b32 v215, 0xffff0000, v213
    v_add_f32 v212, v212, v214
    v_add_f32 v212, v212, v215
    v_accvgpr_read_b32 v217, a58
    v_lshlrev_b32 v213, 16, v98
    v_lshlrev_b32 v214, 16, v217
    v_mul_f32 v213, v213, v214
    v_and_b32 v215, 0xffff0000, v98
    v_and_b32 v216, 0xffff0000, v217
    v_mul_f32 v215, v215, v216
    v_cvt_pk_bf16_f32 v213, v213, v215
    v_lshlrev_b32 v214, 16, v213
    v_and_b32 v215, 0xffff0000, v213
    v_add_f32 v212, v212, v214
    v_add_f32 v212, v212, v215
    v_accvgpr_read_b32 v217, a59
    v_lshlrev_b32 v213, 16, v99
    v_lshlrev_b32 v214, 16, v217
    v_mul_f32 v213, v213, v214
    v_and_b32 v215, 0xffff0000, v99
    v_and_b32 v216, 0xffff0000, v217
    v_mul_f32 v215, v215, v216
    v_cvt_pk_bf16_f32 v213, v213, v215
    v_lshlrev_b32 v214, 16, v213
    v_and_b32 v215, 0xffff0000, v213
    v_add_f32 v212, v212, v214
    v_add_f32 v212, v212, v215
    v_accvgpr_read_b32 v217, a60
    v_lshlrev_b32 v213, 16, v100
    v_lshlrev_b32 v214, 16, v217
    v_mul_f32 v213, v213, v214
    v_and_b32 v215, 0xffff0000, v100
    v_and_b32 v216, 0xffff0000, v217
    v_mul_f32 v215, v215, v216
    v_cvt_pk_bf16_f32 v213, v213, v215
    v_lshlrev_b32 v214, 16, v213
    v_and_b32 v215, 0xffff0000, v213
    v_add_f32 v212, v212, v214
    v_add_f32 v212, v212, v215
    v_accvgpr_read_b32 v217, a61
    v_lshlrev_b32 v213, 16, v101
    v_lshlrev_b32 v214, 16, v217
    v_mul_f32 v213, v213, v214
    v_and_b32 v215, 0xffff0000, v101
    v_and_b32 v216, 0xffff0000, v217
    v_mul_f32 v215, v215, v216
    v_cvt_pk_bf16_f32 v213, v213, v215
    v_lshlrev_b32 v214, 16, v213
    v_and_b32 v215, 0xffff0000, v213
    v_add_f32 v212, v212, v214
    v_add_f32 v212, v212, v215
    v_accvgpr_read_b32 v217, a62
    v_lshlrev_b32 v213, 16, v102
    v_lshlrev_b32 v214, 16, v217
    v_mul_f32 v213, v213, v214
    v_and_b32 v215, 0xffff0000, v102
    v_and_b32 v216, 0xffff0000, v217
    v_mul_f32 v215, v215, v216
    v_cvt_pk_bf16_f32 v213, v213, v215
    v_lshlrev_b32 v214, 16, v213
    v_and_b32 v215, 0xffff0000, v213
    v_add_f32 v212, v212, v214
    v_add_f32 v212, v212, v215
    v_accvgpr_read_b32 v217, a63
    v_lshlrev_b32 v213, 16, v103
    v_lshlrev_b32 v214, 16, v217
    v_mul_f32 v213, v213, v214
    v_and_b32 v215, 0xffff0000, v103
    v_and_b32 v216, 0xffff0000, v217
    v_mul_f32 v215, v215, v216
    v_cvt_pk_bf16_f32 v213, v213, v215
    v_lshlrev_b32 v214, 16, v213
    v_and_b32 v215, 0xffff0000, v213
    v_add_f32 v212, v212, v214
    v_add_f32 v212, v212, v215
    v_accvgpr_read_b32 v217, a64
    v_lshlrev_b32 v213, 16, v104
    v_lshlrev_b32 v214, 16, v217
    v_mul_f32 v213, v213, v214
    v_and_b32 v215, 0xffff0000, v104
    v_and_b32 v216, 0xffff0000, v217
    v_mul_f32 v215, v215, v216
    v_cvt_pk_bf16_f32 v213, v213, v215
    v_lshlrev_b32 v214, 16, v213
    v_and_b32 v215, 0xffff0000, v213
    v_add_f32 v212, v212, v214
    v_add_f32 v212, v212, v215
    v_accvgpr_read_b32 v217, a65
    v_lshlrev_b32 v213, 16, v105
    v_lshlrev_b32 v214, 16, v217
    v_mul_f32 v213, v213, v214
    v_and_b32 v215, 0xffff0000, v105
    v_and_b32 v216, 0xffff0000, v217
    v_mul_f32 v215, v215, v216
    v_cvt_pk_bf16_f32 v213, v213, v215
    v_lshlrev_b32 v214, 16, v213
    v_and_b32 v215, 0xffff0000, v213
    v_add_f32 v212, v212, v214
    v_add_f32 v212, v212, v215
    v_accvgpr_read_b32 v217, a66
    v_lshlrev_b32 v213, 16, v106
    v_lshlrev_b32 v214, 16, v217
    v_mul_f32 v213, v213, v214
    v_and_b32 v215, 0xffff0000, v106
    v_and_b32 v216, 0xffff0000, v217
    v_mul_f32 v215, v215, v216
    v_cvt_pk_bf16_f32 v213, v213, v215
    v_lshlrev_b32 v214, 16, v213
    v_and_b32 v215, 0xffff0000, v213
    v_add_f32 v212, v212, v214
    v_add_f32 v212, v212, v215
    v_accvgpr_read_b32 v217, a67
    v_lshlrev_b32 v213, 16, v107
    v_lshlrev_b32 v214, 16, v217
    v_mul_f32 v213, v213, v214
    v_and_b32 v215, 0xffff0000, v107
    v_and_b32 v216, 0xffff0000, v217
    v_mul_f32 v215, v215, v216
    v_cvt_pk_bf16_f32 v213, v213, v215
    v_lshlrev_b32 v214, 16, v213
    v_and_b32 v215, 0xffff0000, v213
    v_add_f32 v212, v212, v214
    v_add_f32 v212, v212, v215
    v_accvgpr_read_b32 v217, a68
    v_lshlrev_b32 v213, 16, v108
    v_lshlrev_b32 v214, 16, v217
    v_mul_f32 v213, v213, v214
    v_and_b32 v215, 0xffff0000, v108
    v_and_b32 v216, 0xffff0000, v217
    v_mul_f32 v215, v215, v216
    v_cvt_pk_bf16_f32 v213, v213, v215
    v_lshlrev_b32 v214, 16, v213
    v_and_b32 v215, 0xffff0000, v213
    v_add_f32 v212, v212, v214
    v_add_f32 v212, v212, v215
    v_accvgpr_read_b32 v217, a69
    v_lshlrev_b32 v213, 16, v109
    v_lshlrev_b32 v214, 16, v217
    v_mul_f32 v213, v213, v214
    v_and_b32 v215, 0xffff0000, v109
    v_and_b32 v216, 0xffff0000, v217
    v_mul_f32 v215, v215, v216
    v_cvt_pk_bf16_f32 v213, v213, v215
    v_lshlrev_b32 v214, 16, v213
    v_and_b32 v215, 0xffff0000, v213
    v_add_f32 v212, v212, v214
    v_add_f32 v212, v212, v215
    v_accvgpr_read_b32 v217, a70
    v_lshlrev_b32 v213, 16, v110
    v_lshlrev_b32 v214, 16, v217
    v_mul_f32 v213, v213, v214
    v_and_b32 v215, 0xffff0000, v110
    v_and_b32 v216, 0xffff0000, v217
    v_mul_f32 v215, v215, v216
    v_cvt_pk_bf16_f32 v213, v213, v215
    v_lshlrev_b32 v214, 16, v213
    v_and_b32 v215, 0xffff0000, v213
    v_add_f32 v212, v212, v214
    v_add_f32 v212, v212, v215
    v_accvgpr_read_b32 v217, a71
    v_lshlrev_b32 v213, 16, v111
    v_lshlrev_b32 v214, 16, v217
    v_mul_f32 v213, v213, v214
    v_and_b32 v215, 0xffff0000, v111
    v_and_b32 v216, 0xffff0000, v217
    v_mul_f32 v215, v215, v216
    v_cvt_pk_bf16_f32 v213, v213, v215
    v_lshlrev_b32 v214, 16, v213
    v_and_b32 v215, 0xffff0000, v213
    v_add_f32 v212, v212, v214
    v_add_f32 v212, v212, v215
    v_accvgpr_read_b32 v217, a72
    v_lshlrev_b32 v213, 16, v112
    v_lshlrev_b32 v214, 16, v217
    v_mul_f32 v213, v213, v214
    v_and_b32 v215, 0xffff0000, v112
    v_and_b32 v216, 0xffff0000, v217
    v_mul_f32 v215, v215, v216
    v_cvt_pk_bf16_f32 v213, v213, v215
    v_lshlrev_b32 v214, 16, v213
    v_and_b32 v215, 0xffff0000, v213
    v_add_f32 v212, v212, v214
    v_add_f32 v212, v212, v215
    v_accvgpr_read_b32 v217, a73
    v_lshlrev_b32 v213, 16, v113
    v_lshlrev_b32 v214, 16, v217
    v_mul_f32 v213, v213, v214
    v_and_b32 v215, 0xffff0000, v113
    v_and_b32 v216, 0xffff0000, v217
    v_mul_f32 v215, v215, v216
    v_cvt_pk_bf16_f32 v213, v213, v215
    v_lshlrev_b32 v214, 16, v213
    v_and_b32 v215, 0xffff0000, v213
    v_add_f32 v212, v212, v214
    v_add_f32 v212, v212, v215
    v_accvgpr_read_b32 v217, a74
    v_lshlrev_b32 v213, 16, v114
    v_lshlrev_b32 v214, 16, v217
    v_mul_f32 v213, v213, v214
    v_and_b32 v215, 0xffff0000, v114
    v_and_b32 v216, 0xffff0000, v217
    v_mul_f32 v215, v215, v216
    v_cvt_pk_bf16_f32 v213, v213, v215
    v_lshlrev_b32 v214, 16, v213
    v_and_b32 v215, 0xffff0000, v213
    v_add_f32 v212, v212, v214
    v_add_f32 v212, v212, v215
    v_accvgpr_read_b32 v217, a75
    v_lshlrev_b32 v213, 16, v115
    v_lshlrev_b32 v214, 16, v217
    v_mul_f32 v213, v213, v214
    v_and_b32 v215, 0xffff0000, v115
    v_and_b32 v216, 0xffff0000, v217
    v_mul_f32 v215, v215, v216
    v_cvt_pk_bf16_f32 v213, v213, v215
    v_lshlrev_b32 v214, 16, v213
    v_and_b32 v215, 0xffff0000, v213
    v_add_f32 v212, v212, v214
    v_add_f32 v212, v212, v215
    v_accvgpr_read_b32 v217, a76
    v_lshlrev_b32 v213, 16, v116
    v_lshlrev_b32 v214, 16, v217
    v_mul_f32 v213, v213, v214
    v_and_b32 v215, 0xffff0000, v116
    v_and_b32 v216, 0xffff0000, v217
    v_mul_f32 v215, v215, v216
    v_cvt_pk_bf16_f32 v213, v213, v215
    v_lshlrev_b32 v214, 16, v213
    v_and_b32 v215, 0xffff0000, v213
    v_add_f32 v212, v212, v214
    v_add_f32 v212, v212, v215
    v_accvgpr_read_b32 v217, a77
    v_lshlrev_b32 v213, 16, v117
    v_lshlrev_b32 v214, 16, v217
    v_mul_f32 v213, v213, v214
    v_and_b32 v215, 0xffff0000, v117
    v_and_b32 v216, 0xffff0000, v217
    v_mul_f32 v215, v215, v216
    v_cvt_pk_bf16_f32 v213, v213, v215
    v_lshlrev_b32 v214, 16, v213
    v_and_b32 v215, 0xffff0000, v213
    v_add_f32 v212, v212, v214
    v_add_f32 v212, v212, v215
    v_accvgpr_read_b32 v217, a78
    v_lshlrev_b32 v213, 16, v118
    v_lshlrev_b32 v214, 16, v217
    v_mul_f32 v213, v213, v214
    v_and_b32 v215, 0xffff0000, v118
    v_and_b32 v216, 0xffff0000, v217
    v_mul_f32 v215, v215, v216
    v_cvt_pk_bf16_f32 v213, v213, v215
    v_lshlrev_b32 v214, 16, v213
    v_and_b32 v215, 0xffff0000, v213
    v_add_f32 v212, v212, v214
    v_add_f32 v212, v212, v215
    v_accvgpr_read_b32 v217, a79
    v_lshlrev_b32 v213, 16, v119
    v_lshlrev_b32 v214, 16, v217
    v_mul_f32 v213, v213, v214
    v_and_b32 v215, 0xffff0000, v119
    v_and_b32 v216, 0xffff0000, v217
    v_mul_f32 v215, v215, v216
    v_cvt_pk_bf16_f32 v213, v213, v215
    v_lshlrev_b32 v214, 16, v213
    v_and_b32 v215, 0xffff0000, v213
    v_add_f32 v212, v212, v214
    v_add_f32 v212, v212, v215
    v_accvgpr_read_b32 v217, a80
    v_lshlrev_b32 v213, 16, v120
    v_lshlrev_b32 v214, 16, v217
    v_mul_f32 v213, v213, v214
    v_and_b32 v215, 0xffff0000, v120
    v_and_b32 v216, 0xffff0000, v217
    v_mul_f32 v215, v215, v216
    v_cvt_pk_bf16_f32 v213, v213, v215
    v_lshlrev_b32 v214, 16, v213
    v_and_b32 v215, 0xffff0000, v213
    v_add_f32 v212, v212, v214
    v_add_f32 v212, v212, v215
    v_accvgpr_read_b32 v217, a81
    v_lshlrev_b32 v213, 16, v121
    v_lshlrev_b32 v214, 16, v217
    v_mul_f32 v213, v213, v214
    v_and_b32 v215, 0xffff0000, v121
    v_and_b32 v216, 0xffff0000, v217
    v_mul_f32 v215, v215, v216
    v_cvt_pk_bf16_f32 v213, v213, v215
    v_lshlrev_b32 v214, 16, v213
    v_and_b32 v215, 0xffff0000, v213
    v_add_f32 v212, v212, v214
    v_add_f32 v212, v212, v215
    v_accvgpr_read_b32 v217, a82
    v_lshlrev_b32 v213, 16, v122
    v_lshlrev_b32 v214, 16, v217
    v_mul_f32 v213, v213, v214
    v_and_b32 v215, 0xffff0000, v122
    v_and_b32 v216, 0xffff0000, v217
    v_mul_f32 v215, v215, v216
    v_cvt_pk_bf16_f32 v213, v213, v215
    v_lshlrev_b32 v214, 16, v213
    v_and_b32 v215, 0xffff0000, v213
    v_add_f32 v212, v212, v214
    v_add_f32 v212, v212, v215
    v_accvgpr_read_b32 v217, a83
    v_lshlrev_b32 v213, 16, v123
    v_lshlrev_b32 v214, 16, v217
    v_mul_f32 v213, v213, v214
    v_and_b32 v215, 0xffff0000, v123
    v_and_b32 v216, 0xffff0000, v217
    v_mul_f32 v215, v215, v216
    v_cvt_pk_bf16_f32 v213, v213, v215
    v_lshlrev_b32 v214, 16, v213
    v_and_b32 v215, 0xffff0000, v213
    v_add_f32 v212, v212, v214
    v_add_f32 v212, v212, v215
    v_accvgpr_read_b32 v217, a84
    v_lshlrev_b32 v213, 16, v124
    v_lshlrev_b32 v214, 16, v217
    v_mul_f32 v213, v213, v214
    v_and_b32 v215, 0xffff0000, v124
    v_and_b32 v216, 0xffff0000, v217
    v_mul_f32 v215, v215, v216
    v_cvt_pk_bf16_f32 v213, v213, v215
    v_lshlrev_b32 v214, 16, v213
    v_and_b32 v215, 0xffff0000, v213
    v_add_f32 v212, v212, v214
    v_add_f32 v212, v212, v215
    v_accvgpr_read_b32 v217, a85
    v_lshlrev_b32 v213, 16, v125
    v_lshlrev_b32 v214, 16, v217
    v_mul_f32 v213, v213, v214
    v_and_b32 v215, 0xffff0000, v125
    v_and_b32 v216, 0xffff0000, v217
    v_mul_f32 v215, v215, v216
    v_cvt_pk_bf16_f32 v213, v213, v215
    v_lshlrev_b32 v214, 16, v213
    v_and_b32 v215, 0xffff0000, v213
    v_add_f32 v212, v212, v214
    v_add_f32 v212, v212, v215
    v_accvgpr_read_b32 v217, a86
    v_lshlrev_b32 v213, 16, v126
    v_lshlrev_b32 v214, 16, v217
    v_mul_f32 v213, v213, v214
    v_and_b32 v215, 0xffff0000, v126
    v_and_b32 v216, 0xffff0000, v217
    v_mul_f32 v215, v215, v216
    v_cvt_pk_bf16_f32 v213, v213, v215
    v_lshlrev_b32 v214, 16, v213
    v_and_b32 v215, 0xffff0000, v213
    v_add_f32 v212, v212, v214
    v_add_f32 v212, v212, v215
    v_accvgpr_read_b32 v217, a87
    v_lshlrev_b32 v213, 16, v127
    v_lshlrev_b32 v214, 16, v217
    v_mul_f32 v213, v213, v214
    v_and_b32 v215, 0xffff0000, v127
    v_and_b32 v216, 0xffff0000, v217
    v_mul_f32 v215, v215, v216
    v_cvt_pk_bf16_f32 v213, v213, v215
    v_lshlrev_b32 v214, 16, v213
    v_and_b32 v215, 0xffff0000, v213
    v_add_f32 v212, v212, v214
    v_add_f32 v212, v212, v215
    v_accvgpr_read_b32 v217, a88
    v_lshlrev_b32 v213, 16, v128
    v_lshlrev_b32 v214, 16, v217
    v_mul_f32 v213, v213, v214
    v_and_b32 v215, 0xffff0000, v128
    v_and_b32 v216, 0xffff0000, v217
    v_mul_f32 v215, v215, v216
    v_cvt_pk_bf16_f32 v213, v213, v215
    v_lshlrev_b32 v214, 16, v213
    v_and_b32 v215, 0xffff0000, v213
    v_add_f32 v212, v212, v214
    v_add_f32 v212, v212, v215
    v_accvgpr_read_b32 v217, a89
    v_lshlrev_b32 v213, 16, v129
    v_lshlrev_b32 v214, 16, v217
    v_mul_f32 v213, v213, v214
    v_and_b32 v215, 0xffff0000, v129
    v_and_b32 v216, 0xffff0000, v217
    v_mul_f32 v215, v215, v216
    v_cvt_pk_bf16_f32 v213, v213, v215
    v_lshlrev_b32 v214, 16, v213
    v_and_b32 v215, 0xffff0000, v213
    v_add_f32 v212, v212, v214
    v_add_f32 v212, v212, v215
    v_accvgpr_read_b32 v217, a90
    v_lshlrev_b32 v213, 16, v130
    v_lshlrev_b32 v214, 16, v217
    v_mul_f32 v213, v213, v214
    v_and_b32 v215, 0xffff0000, v130
    v_and_b32 v216, 0xffff0000, v217
    v_mul_f32 v215, v215, v216
    v_cvt_pk_bf16_f32 v213, v213, v215
    v_lshlrev_b32 v214, 16, v213
    v_and_b32 v215, 0xffff0000, v213
    v_add_f32 v212, v212, v214
    v_add_f32 v212, v212, v215
    v_accvgpr_read_b32 v217, a91
    v_lshlrev_b32 v213, 16, v131
    v_lshlrev_b32 v214, 16, v217
    v_mul_f32 v213, v213, v214
    v_and_b32 v215, 0xffff0000, v131
    v_and_b32 v216, 0xffff0000, v217
    v_mul_f32 v215, v215, v216
    v_cvt_pk_bf16_f32 v213, v213, v215
    v_lshlrev_b32 v214, 16, v213
    v_and_b32 v215, 0xffff0000, v213
    v_add_f32 v212, v212, v214
    v_add_f32 v212, v212, v215
    v_accvgpr_read_b32 v217, a92
    v_lshlrev_b32 v213, 16, v132
    v_lshlrev_b32 v214, 16, v217
    v_mul_f32 v213, v213, v214
    v_and_b32 v215, 0xffff0000, v132
    v_and_b32 v216, 0xffff0000, v217
    v_mul_f32 v215, v215, v216
    v_cvt_pk_bf16_f32 v213, v213, v215
    v_lshlrev_b32 v214, 16, v213
    v_and_b32 v215, 0xffff0000, v213
    v_add_f32 v212, v212, v214
    v_add_f32 v212, v212, v215
    v_accvgpr_read_b32 v217, a93
    v_lshlrev_b32 v213, 16, v133
    v_lshlrev_b32 v214, 16, v217
    v_mul_f32 v213, v213, v214
    v_and_b32 v215, 0xffff0000, v133
    v_and_b32 v216, 0xffff0000, v217
    v_mul_f32 v215, v215, v216
    v_cvt_pk_bf16_f32 v213, v213, v215
    v_lshlrev_b32 v214, 16, v213
    v_and_b32 v215, 0xffff0000, v213
    v_add_f32 v212, v212, v214
    v_add_f32 v212, v212, v215
    v_accvgpr_read_b32 v217, a94
    v_lshlrev_b32 v213, 16, v134
    v_lshlrev_b32 v214, 16, v217
    v_mul_f32 v213, v213, v214
    v_and_b32 v215, 0xffff0000, v134
    v_and_b32 v216, 0xffff0000, v217
    v_mul_f32 v215, v215, v216
    v_cvt_pk_bf16_f32 v213, v213, v215
    v_lshlrev_b32 v214, 16, v213
    v_and_b32 v215, 0xffff0000, v213
    v_add_f32 v212, v212, v214
    v_add_f32 v212, v212, v215
    v_accvgpr_read_b32 v217, a95
    v_lshlrev_b32 v213, 16, v135
    v_lshlrev_b32 v214, 16, v217
    v_mul_f32 v213, v213, v214
    v_and_b32 v215, 0xffff0000, v135
    v_and_b32 v216, 0xffff0000, v217
    v_mul_f32 v215, v215, v216
    v_cvt_pk_bf16_f32 v213, v213, v215
    v_lshlrev_b32 v214, 16, v213
    v_and_b32 v215, 0xffff0000, v213
    v_add_f32 v212, v212, v214
    v_add_f32 v212, v212, v215
    v_accvgpr_read_b32 v217, a96
    v_lshlrev_b32 v213, 16, v136
    v_lshlrev_b32 v214, 16, v217
    v_mul_f32 v213, v213, v214
    v_and_b32 v215, 0xffff0000, v136
    v_and_b32 v216, 0xffff0000, v217
    v_mul_f32 v215, v215, v216
    v_cvt_pk_bf16_f32 v213, v213, v215
    v_lshlrev_b32 v214, 16, v213
    v_and_b32 v215, 0xffff0000, v213
    v_add_f32 v212, v212, v214
    v_add_f32 v212, v212, v215
    v_accvgpr_read_b32 v217, a97
    v_lshlrev_b32 v213, 16, v137
    v_lshlrev_b32 v214, 16, v217
    v_mul_f32 v213, v213, v214
    v_and_b32 v215, 0xffff0000, v137
    v_and_b32 v216, 0xffff0000, v217
    v_mul_f32 v215, v215, v216
    v_cvt_pk_bf16_f32 v213, v213, v215
    v_lshlrev_b32 v214, 16, v213
    v_and_b32 v215, 0xffff0000, v213
    v_add_f32 v212, v212, v214
    v_add_f32 v212, v212, v215
    v_accvgpr_read_b32 v217, a98
    v_lshlrev_b32 v213, 16, v138
    v_lshlrev_b32 v214, 16, v217
    v_mul_f32 v213, v213, v214
    v_and_b32 v215, 0xffff0000, v138
    v_and_b32 v216, 0xffff0000, v217
    v_mul_f32 v215, v215, v216
    v_cvt_pk_bf16_f32 v213, v213, v215
    v_lshlrev_b32 v214, 16, v213
    v_and_b32 v215, 0xffff0000, v213
    v_add_f32 v212, v212, v214
    v_add_f32 v212, v212, v215
    v_accvgpr_read_b32 v217, a99
    v_lshlrev_b32 v213, 16, v139
    v_lshlrev_b32 v214, 16, v217
    v_mul_f32 v213, v213, v214
    v_and_b32 v215, 0xffff0000, v139
    v_and_b32 v216, 0xffff0000, v217
    v_mul_f32 v215, v215, v216
    v_cvt_pk_bf16_f32 v213, v213, v215
    v_lshlrev_b32 v214, 16, v213
    v_and_b32 v215, 0xffff0000, v213
    v_add_f32 v212, v212, v214
    v_add_f32 v212, v212, v215
    v_accvgpr_read_b32 v217, a100
    v_lshlrev_b32 v213, 16, v140
    v_lshlrev_b32 v214, 16, v217
    v_mul_f32 v213, v213, v214
    v_and_b32 v215, 0xffff0000, v140
    v_and_b32 v216, 0xffff0000, v217
    v_mul_f32 v215, v215, v216
    v_cvt_pk_bf16_f32 v213, v213, v215
    v_lshlrev_b32 v214, 16, v213
    v_and_b32 v215, 0xffff0000, v213
    v_add_f32 v212, v212, v214
    v_add_f32 v212, v212, v215
    v_accvgpr_read_b32 v217, a101
    v_lshlrev_b32 v213, 16, v141
    v_lshlrev_b32 v214, 16, v217
    v_mul_f32 v213, v213, v214
    v_and_b32 v215, 0xffff0000, v141
    v_and_b32 v216, 0xffff0000, v217
    v_mul_f32 v215, v215, v216
    v_cvt_pk_bf16_f32 v213, v213, v215
    v_lshlrev_b32 v214, 16, v213
    v_and_b32 v215, 0xffff0000, v213
    v_add_f32 v212, v212, v214
    v_add_f32 v212, v212, v215
    v_accvgpr_read_b32 v217, a102
    v_lshlrev_b32 v213, 16, v142
    v_lshlrev_b32 v214, 16, v217
    v_mul_f32 v213, v213, v214
    v_and_b32 v215, 0xffff0000, v142
    v_and_b32 v216, 0xffff0000, v217
    v_mul_f32 v215, v215, v216
    v_cvt_pk_bf16_f32 v213, v213, v215
    v_lshlrev_b32 v214, 16, v213
    v_and_b32 v215, 0xffff0000, v213
    v_add_f32 v212, v212, v214
    v_add_f32 v212, v212, v215
    v_accvgpr_read_b32 v217, a103
    v_lshlrev_b32 v213, 16, v143
    v_lshlrev_b32 v214, 16, v217
    v_mul_f32 v213, v213, v214
    v_and_b32 v215, 0xffff0000, v143
    v_and_b32 v216, 0xffff0000, v217
    v_mul_f32 v215, v215, v216
    v_cvt_pk_bf16_f32 v213, v213, v215
    v_lshlrev_b32 v214, 16, v213
    v_and_b32 v215, 0xffff0000, v213
    v_add_f32 v212, v212, v214
    v_add_f32 v212, v212, v215
    v_accvgpr_read_b32 v217, a104
    v_lshlrev_b32 v213, 16, v144
    v_lshlrev_b32 v214, 16, v217
    v_mul_f32 v213, v213, v214
    v_and_b32 v215, 0xffff0000, v144
    v_and_b32 v216, 0xffff0000, v217
    v_mul_f32 v215, v215, v216
    v_cvt_pk_bf16_f32 v213, v213, v215
    v_lshlrev_b32 v214, 16, v213
    v_and_b32 v215, 0xffff0000, v213
    v_add_f32 v212, v212, v214
    v_add_f32 v212, v212, v215
    v_accvgpr_read_b32 v217, a105
    v_lshlrev_b32 v213, 16, v145
    v_lshlrev_b32 v214, 16, v217
    v_mul_f32 v213, v213, v214
    v_and_b32 v215, 0xffff0000, v145
    v_and_b32 v216, 0xffff0000, v217
    v_mul_f32 v215, v215, v216
    v_cvt_pk_bf16_f32 v213, v213, v215
    v_lshlrev_b32 v214, 16, v213
    v_and_b32 v215, 0xffff0000, v213
    v_add_f32 v212, v212, v214
    v_add_f32 v212, v212, v215
    v_accvgpr_read_b32 v217, a106
    v_lshlrev_b32 v213, 16, v146
    v_lshlrev_b32 v214, 16, v217
    v_mul_f32 v213, v213, v214
    v_and_b32 v215, 0xffff0000, v146
    v_and_b32 v216, 0xffff0000, v217
    v_mul_f32 v215, v215, v216
    v_cvt_pk_bf16_f32 v213, v213, v215
    v_lshlrev_b32 v214, 16, v213
    v_and_b32 v215, 0xffff0000, v213
    v_add_f32 v212, v212, v214
    v_add_f32 v212, v212, v215
    v_accvgpr_read_b32 v217, a107
    v_lshlrev_b32 v213, 16, v147
    v_lshlrev_b32 v214, 16, v217
    v_mul_f32 v213, v213, v214
    v_and_b32 v215, 0xffff0000, v147
    v_and_b32 v216, 0xffff0000, v217
    v_mul_f32 v215, v215, v216
    v_cvt_pk_bf16_f32 v213, v213, v215
    v_lshlrev_b32 v214, 16, v213
    v_and_b32 v215, 0xffff0000, v213
    v_add_f32 v212, v212, v214
    v_add_f32 v212, v212, v215
    v_accvgpr_read_b32 v217, a108
    v_lshlrev_b32 v213, 16, v148
    v_lshlrev_b32 v214, 16, v217
    v_mul_f32 v213, v213, v214
    v_and_b32 v215, 0xffff0000, v148
    v_and_b32 v216, 0xffff0000, v217
    v_mul_f32 v215, v215, v216
    v_cvt_pk_bf16_f32 v213, v213, v215
    v_lshlrev_b32 v214, 16, v213
    v_and_b32 v215, 0xffff0000, v213
    v_add_f32 v212, v212, v214
    v_add_f32 v212, v212, v215
    v_accvgpr_read_b32 v217, a109
    v_lshlrev_b32 v213, 16, v149
    v_lshlrev_b32 v214, 16, v217
    v_mul_f32 v213, v213, v214
    v_and_b32 v215, 0xffff0000, v149
    v_and_b32 v216, 0xffff0000, v217
    v_mul_f32 v215, v215, v216
    v_cvt_pk_bf16_f32 v213, v213, v215
    v_lshlrev_b32 v214, 16, v213
    v_and_b32 v215, 0xffff0000, v213
    v_add_f32 v212, v212, v214
    v_add_f32 v212, v212, v215
    v_accvgpr_read_b32 v217, a110
    v_lshlrev_b32 v213, 16, v150
    v_lshlrev_b32 v214, 16, v217
    v_mul_f32 v213, v213, v214
    v_and_b32 v215, 0xffff0000, v150
    v_and_b32 v216, 0xffff0000, v217
    v_mul_f32 v215, v215, v216
    v_cvt_pk_bf16_f32 v213, v213, v215
    v_lshlrev_b32 v214, 16, v213
    v_and_b32 v215, 0xffff0000, v213
    v_add_f32 v212, v212, v214
    v_add_f32 v212, v212, v215
    v_accvgpr_read_b32 v217, a111
    v_lshlrev_b32 v213, 16, v151
    v_lshlrev_b32 v214, 16, v217
    v_mul_f32 v213, v213, v214
    v_and_b32 v215, 0xffff0000, v151
    v_and_b32 v216, 0xffff0000, v217
    v_mul_f32 v215, v215, v216
    v_cvt_pk_bf16_f32 v213, v213, v215
    v_lshlrev_b32 v214, 16, v213
    v_and_b32 v215, 0xffff0000, v213
    v_add_f32 v212, v212, v214
    v_add_f32 v212, v212, v215
    v_accvgpr_read_b32 v217, a112
    v_lshlrev_b32 v213, 16, v152
    v_lshlrev_b32 v214, 16, v217
    v_mul_f32 v213, v213, v214
    v_and_b32 v215, 0xffff0000, v152
    v_and_b32 v216, 0xffff0000, v217
    v_mul_f32 v215, v215, v216
    v_cvt_pk_bf16_f32 v213, v213, v215
    v_lshlrev_b32 v214, 16, v213
    v_and_b32 v215, 0xffff0000, v213
    v_add_f32 v212, v212, v214
    v_add_f32 v212, v212, v215
    v_accvgpr_read_b32 v217, a113
    v_lshlrev_b32 v213, 16, v153
    v_lshlrev_b32 v214, 16, v217
    v_mul_f32 v213, v213, v214
    v_and_b32 v215, 0xffff0000, v153
    v_and_b32 v216, 0xffff0000, v217
    v_mul_f32 v215, v215, v216
    v_cvt_pk_bf16_f32 v213, v213, v215
    v_lshlrev_b32 v214, 16, v213
    v_and_b32 v215, 0xffff0000, v213
    v_add_f32 v212, v212, v214
    v_add_f32 v212, v212, v215
    v_accvgpr_read_b32 v217, a114
    v_lshlrev_b32 v213, 16, v154
    v_lshlrev_b32 v214, 16, v217
    v_mul_f32 v213, v213, v214
    v_and_b32 v215, 0xffff0000, v154
    v_and_b32 v216, 0xffff0000, v217
    v_mul_f32 v215, v215, v216
    v_cvt_pk_bf16_f32 v213, v213, v215
    v_lshlrev_b32 v214, 16, v213
    v_and_b32 v215, 0xffff0000, v213
    v_add_f32 v212, v212, v214
    v_add_f32 v212, v212, v215
    v_accvgpr_read_b32 v217, a115
    v_lshlrev_b32 v213, 16, v155
    v_lshlrev_b32 v214, 16, v217
    v_mul_f32 v213, v213, v214
    v_and_b32 v215, 0xffff0000, v155
    v_and_b32 v216, 0xffff0000, v217
    v_mul_f32 v215, v215, v216
    v_cvt_pk_bf16_f32 v213, v213, v215
    v_lshlrev_b32 v214, 16, v213
    v_and_b32 v215, 0xffff0000, v213
    v_add_f32 v212, v212, v214
    v_add_f32 v212, v212, v215
    v_accvgpr_read_b32 v217, a116
    v_lshlrev_b32 v213, 16, v156
    v_lshlrev_b32 v214, 16, v217
    v_mul_f32 v213, v213, v214
    v_and_b32 v215, 0xffff0000, v156
    v_and_b32 v216, 0xffff0000, v217
    v_mul_f32 v215, v215, v216
    v_cvt_pk_bf16_f32 v213, v213, v215
    v_lshlrev_b32 v214, 16, v213
    v_and_b32 v215, 0xffff0000, v213
    v_add_f32 v212, v212, v214
    v_add_f32 v212, v212, v215
    v_accvgpr_read_b32 v217, a117
    v_lshlrev_b32 v213, 16, v157
    v_lshlrev_b32 v214, 16, v217
    v_mul_f32 v213, v213, v214
    v_and_b32 v215, 0xffff0000, v157
    v_and_b32 v216, 0xffff0000, v217
    v_mul_f32 v215, v215, v216
    v_cvt_pk_bf16_f32 v213, v213, v215
    v_lshlrev_b32 v214, 16, v213
    v_and_b32 v215, 0xffff0000, v213
    v_add_f32 v212, v212, v214
    v_add_f32 v212, v212, v215
    v_accvgpr_read_b32 v217, a118
    v_lshlrev_b32 v213, 16, v158
    v_lshlrev_b32 v214, 16, v217
    v_mul_f32 v213, v213, v214
    v_and_b32 v215, 0xffff0000, v158
    v_and_b32 v216, 0xffff0000, v217
    v_mul_f32 v215, v215, v216
    v_cvt_pk_bf16_f32 v213, v213, v215
    v_lshlrev_b32 v214, 16, v213
    v_and_b32 v215, 0xffff0000, v213
    v_add_f32 v212, v212, v214
    v_add_f32 v212, v212, v215
    v_accvgpr_read_b32 v217, a119
    v_lshlrev_b32 v213, 16, v159
    v_lshlrev_b32 v214, 16, v217
    v_mul_f32 v213, v213, v214
    v_and_b32 v215, 0xffff0000, v159
    v_and_b32 v216, 0xffff0000, v217
    v_mul_f32 v215, v215, v216
    v_cvt_pk_bf16_f32 v213, v213, v215
    v_lshlrev_b32 v214, 16, v213
    v_and_b32 v215, 0xffff0000, v213
    v_add_f32 v212, v212, v214
    v_add_f32 v212, v212, v215
    v_accvgpr_read_b32 v217, a120
    v_lshlrev_b32 v213, 16, v160
    v_lshlrev_b32 v214, 16, v217
    v_mul_f32 v213, v213, v214
    v_and_b32 v215, 0xffff0000, v160
    v_and_b32 v216, 0xffff0000, v217
    v_mul_f32 v215, v215, v216
    v_cvt_pk_bf16_f32 v213, v213, v215
    v_lshlrev_b32 v214, 16, v213
    v_and_b32 v215, 0xffff0000, v213
    v_add_f32 v212, v212, v214
    v_add_f32 v212, v212, v215
    v_accvgpr_read_b32 v217, a121
    v_lshlrev_b32 v213, 16, v161
    v_lshlrev_b32 v214, 16, v217
    v_mul_f32 v213, v213, v214
    v_and_b32 v215, 0xffff0000, v161
    v_and_b32 v216, 0xffff0000, v217
    v_mul_f32 v215, v215, v216
    v_cvt_pk_bf16_f32 v213, v213, v215
    v_lshlrev_b32 v214, 16, v213
    v_and_b32 v215, 0xffff0000, v213
    v_add_f32 v212, v212, v214
    v_add_f32 v212, v212, v215
    v_accvgpr_read_b32 v217, a122
    v_lshlrev_b32 v213, 16, v162
    v_lshlrev_b32 v214, 16, v217
    v_mul_f32 v213, v213, v214
    v_and_b32 v215, 0xffff0000, v162
    v_and_b32 v216, 0xffff0000, v217
    v_mul_f32 v215, v215, v216
    v_cvt_pk_bf16_f32 v213, v213, v215
    v_lshlrev_b32 v214, 16, v213
    v_and_b32 v215, 0xffff0000, v213
    v_add_f32 v212, v212, v214
    v_add_f32 v212, v212, v215
    v_accvgpr_read_b32 v217, a123
    v_lshlrev_b32 v213, 16, v163
    v_lshlrev_b32 v214, 16, v217
    v_mul_f32 v213, v213, v214
    v_and_b32 v215, 0xffff0000, v163
    v_and_b32 v216, 0xffff0000, v217
    v_mul_f32 v215, v215, v216
    v_cvt_pk_bf16_f32 v213, v213, v215
    v_lshlrev_b32 v214, 16, v213
    v_and_b32 v215, 0xffff0000, v213
    v_add_f32 v212, v212, v214
    v_add_f32 v212, v212, v215
    v_accvgpr_read_b32 v217, a124
    v_lshlrev_b32 v213, 16, v164
    v_lshlrev_b32 v214, 16, v217
    v_mul_f32 v213, v213, v214
    v_and_b32 v215, 0xffff0000, v164
    v_and_b32 v216, 0xffff0000, v217
    v_mul_f32 v215, v215, v216
    v_cvt_pk_bf16_f32 v213, v213, v215
    v_lshlrev_b32 v214, 16, v213
    v_and_b32 v215, 0xffff0000, v213
    v_add_f32 v212, v212, v214
    v_add_f32 v212, v212, v215
    v_accvgpr_read_b32 v217, a125
    v_lshlrev_b32 v213, 16, v165
    v_lshlrev_b32 v214, 16, v217
    v_mul_f32 v213, v213, v214
    v_and_b32 v215, 0xffff0000, v165
    v_and_b32 v216, 0xffff0000, v217
    v_mul_f32 v215, v215, v216
    v_cvt_pk_bf16_f32 v213, v213, v215
    v_lshlrev_b32 v214, 16, v213
    v_and_b32 v215, 0xffff0000, v213
    v_add_f32 v212, v212, v214
    v_add_f32 v212, v212, v215
    v_accvgpr_read_b32 v217, a126
    v_lshlrev_b32 v213, 16, v166
    v_lshlrev_b32 v214, 16, v217
    v_mul_f32 v213, v213, v214
    v_and_b32 v215, 0xffff0000, v166
    v_and_b32 v216, 0xffff0000, v217
    v_mul_f32 v215, v215, v216
    v_cvt_pk_bf16_f32 v213, v213, v215
    v_lshlrev_b32 v214, 16, v213
    v_and_b32 v215, 0xffff0000, v213
    v_add_f32 v212, v212, v214
    v_add_f32 v212, v212, v215
    v_accvgpr_read_b32 v217, a127
    v_lshlrev_b32 v213, 16, v167
    v_lshlrev_b32 v214, 16, v217
    v_mul_f32 v213, v213, v214
    v_and_b32 v215, 0xffff0000, v167
    v_and_b32 v216, 0xffff0000, v217
    v_mul_f32 v215, v215, v216
    v_cvt_pk_bf16_f32 v213, v213, v215
    v_lshlrev_b32 v214, 16, v213
    v_and_b32 v215, 0xffff0000, v213
    v_add_f32 v212, v212, v214
    v_add_f32 v212, v212, v215
    v_mov_b32 v213, v212
    s_nop 1
    v_permlane32_swap_b32 v212, v213
    v_add_f32 v212, v212, v213
    v_cvt_pk_bf16_f32 v212, v212, v212
    v_lshlrev_b32 v212, 16, v212
    v_mul_f32 v213, 0xbfb8aa3b, v212
    v_exp_f32 v213, v213
    s_nop 0
    v_add_f32 v213, 1.0, v213
    v_rcp_f32 v213, v213
    s_nop 0
    v_cvt_pk_bf16_f32 v213, v213, v213
    v_lshlrev_b32 v213, 16, v213
    v_sub_f32 v214, 1.0, v213
    v_cvt_pk_bf16_f32 v214, v214, v214
    v_lshlrev_b32 v214, 16, v214
    s_lshl_b32 s3, s15, 7
    v_lshlrev_b32 v215, 2, v2
    v_add_u32 v215, s3, v215
    buffer_store_dword v213, v215, s[40:43], 0 offen
    v_add_u32 v216, 8192, v215
    buffer_store_dword v214, v216, s[40:43], 0 offen
    s_nop 7
    v_cvt_pk_bf16_f32 v220, v172, v173
    v_cvt_pk_bf16_f32 v221, v174, v175
    v_cvt_pk_bf16_f32 v222, v176, v177
    v_cvt_pk_bf16_f32 v223, v178, v179
    s_nop 1
    v_permlane32_swap_b32 v220, v222
    v_permlane32_swap_b32 v221, v223
    v_and_b32 v213, 4, v2
    v_lshlrev_b32 v213, 1, v213
    v_and_b32 v214, 8, v2
    v_lshrrev_b32 v214, 1, v214
    v_and_b32 v215, 19, v2
    v_or_b32 v213, v213, v214
    v_or_b32 v213, v213, v215
    v_lshlrev_b32 v214, 5, v3
    v_add_u32 v213, v213, v214
    v_lshlrev_b32 v213, 4, v213
    s_lshl_b32 s3, s15, 10
    v_add_u32 v213, s3, v213
    buffer_store_dwordx4 v[220:223], v213, s[32:35], 0 offen
    v_cvt_pk_bf16_f32 v224, v188, v189
    v_cvt_pk_bf16_f32 v225, v190, v191
    v_cvt_pk_bf16_f32 v226, v192, v193
    v_cvt_pk_bf16_f32 v227, v194, v195
    s_nop 1
    v_permlane32_swap_b32 v224, v226
    v_permlane32_swap_b32 v225, v227
    v_cvt_pk_bf16_f32 v228, v196, v197
    v_cvt_pk_bf16_f32 v229, v198, v199
    v_cvt_pk_bf16_f32 v230, v200, v201
    v_cvt_pk_bf16_f32 v231, v202, v203
    s_nop 1
    v_permlane32_swap_b32 v228, v230
    v_permlane32_swap_b32 v229, v231
    v_subrev_u32 v213, 16, v2
    v_lshlrev_b32 v213, 4, v213
    v_lshlrev_b32 v214, 8, v3
    v_add_u32 v213, v213, v214
    v_add_u32 v213, s3, v213
    v_cmp_le_u32 vcc, 16, v2
    s_and_saveexec_b64 s[44:45], vcc
    buffer_store_dwordx4 v[224:227], v213, s[36:39], 0 offen
    buffer_store_dwordx4 v[228:231], v213, s[36:39], 0 offen offset:512
    s_mov_b64 exec, s[44:45]
pre0_end:
    s_endpgm

.globl attna_kernel
.p2align 8
.type attna_kernel,@function
attna_kernel:
    s_cmp_ge_u32 s2, 256
    s_cbranch_scc1 attna_kernel_end
    s_load_dwordx2 s[4:5], s[0:1], 112
    s_and_b32 s6, s2, 31
    s_lshr_b32 s7, s2, 5
    v_lshrrev_b32 v4, 6, v0
    v_and_b32 v1, 63, v0
    v_and_b32 v2, 31, v0
    v_lshrrev_b32 v3, 5, v1
    s_nop 1
    v_readfirstlane_b32 s8, v4
    s_waitcnt lgkmcnt(0)
    s_mov_b32 s12, s4
    s_mov_b32 s13, s5
    s_mov_b32 s14, 0x1000000
    s_mov_b32 s15, 0x00020000
    s_add_u32 s16, s4, 0x1000000
    s_addc_u32 s17, s5, 0x0
    s_mov_b32 s18, 0x1000000
    s_mov_b32 s19, 0x00020000
    s_add_u32 s20, s4, 0x2000000
    s_addc_u32 s21, s5, 0x0
    s_mov_b32 s22, 0x1000000
    s_mov_b32 s23, 0x00020000
    s_add_u32 s24, s4, 0x3000000
    s_addc_u32 s25, s5, 0x0
    s_mov_b32 s26, 0x1000000
    s_mov_b32 s27, 0x00020000
    s_mov_b32 s28, 0x3e0293ee
    s_mov_b32 s29, 0xbe0293ee
    s_lshl_b32 s30, s7, 2
    s_add_u32 s30, s30, s8
    s_sub_u32 s31, 15, s7
    s_lshl_b32 s31, s31, 2
    s_add_u32 s31, s31, s8
    s_lshl_b32 s32, s7, 1
    s_add_u32 s32, s32, 2
    s_sub_u32 s33, 16, s7
    s_lshl_b32 s33, s33, 1
    v_lshlrev_b32 v6, 4, v1
    s_lshl_b32 s35, s6, 6
    s_add_u32 s35, s35, s30
    s_lshl_b32 s35, s35, 13
    buffer_load_dwordx4 a[0:3], v6, s[12:15], s35 offen offset:0
    buffer_load_dwordx4 a[4:7], v6, s[12:15], s35 offen offset:1024
    buffer_load_dwordx4 a[8:11], v6, s[12:15], s35 offen offset:2048
    buffer_load_dwordx4 a[12:15], v6, s[12:15], s35 offen offset:3072
    s_add_u32 s35, s35, 4096
    buffer_load_dwordx4 a[16:19], v6, s[12:15], s35 offen offset:0
    buffer_load_dwordx4 a[20:23], v6, s[12:15], s35 offen offset:1024
    buffer_load_dwordx4 a[24:27], v6, s[12:15], s35 offen offset:2048
    buffer_load_dwordx4 a[28:31], v6, s[12:15], s35 offen offset:3072
    s_lshl_b32 s35, s6, 6
    s_add_u32 s35, s35, s31
    s_lshl_b32 s35, s35, 13
    buffer_load_dwordx4 a[32:35], v6, s[12:15], s35 offen offset:0
    buffer_load_dwordx4 a[36:39], v6, s[12:15], s35 offen offset:1024
    buffer_load_dwordx4 a[40:43], v6, s[12:15], s35 offen offset:2048
    buffer_load_dwordx4 a[44:47], v6, s[12:15], s35 offen offset:3072
    s_add_u32 s35, s35, 4096
    buffer_load_dwordx4 a[48:51], v6, s[12:15], s35 offen offset:0
    buffer_load_dwordx4 a[52:55], v6, s[12:15], s35 offen offset:1024
    buffer_load_dwordx4 a[56:59], v6, s[12:15], s35 offen offset:2048
    buffer_load_dwordx4 a[60:63], v6, s[12:15], s35 offen offset:3072
    s_lshl_b32 s37, s6, 19
    s_lshl_b32 s35, s8, 12
    s_add_u32 s37, s37, s35
    s_lshl_b32 s38, s6, 2
    s_add_u32 s38, s38, s8
    s_lshl_b32 s38, s38, 17
    s_lshl_b32 s40, s8, 12
    s_lshl_b32 s41, s8, 12
    s_add_u32 s41, s41, 16384
    v_and_b32 v4, 4, v2
    v_lshlrev_b32 v4, 1, v4
    v_and_b32 v5, 8, v2
    v_lshrrev_b32 v5, 1, v5
    v_or_b32 v4, v4, v5
    v_and_b32 v5, 19, v2
    v_or_b32 v4, v4, v5
    v_lshlrev_b32 v5, 5, v3
    v_add_u32 v4, v4, v5
    v_lshlrev_b32 v7, 4, v4
    v_add_u32 v8, 16384, v6
    v_lshlrev_b32 v4, 3, v3
    v_sub_u32 v9, v2, v4
    s_mov_b32 s42, 0x427af233
    v_mov_b32 v245, 0xff800000
    v_mov_b32 v236, 0xff800000
    v_mov_b32 v238, 0
    v_mov_b32 v12, 0
    v_mov_b32 v13, 0
    v_mov_b32 v14, 0
    v_mov_b32 v15, 0
    v_mov_b32 v16, 0
    v_mov_b32 v17, 0
    v_mov_b32 v18, 0
    v_mov_b32 v19, 0
    v_mov_b32 v20, 0
    v_mov_b32 v21, 0
    v_mov_b32 v22, 0
    v_mov_b32 v23, 0
    v_mov_b32 v24, 0
    v_mov_b32 v25, 0
    v_mov_b32 v26, 0
    v_mov_b32 v27, 0
    v_mov_b32 v28, 0
    v_mov_b32 v29, 0
    v_mov_b32 v30, 0
    v_mov_b32 v31, 0
    v_mov_b32 v32, 0
    v_mov_b32 v33, 0
    v_mov_b32 v34, 0
    v_mov_b32 v35, 0
    v_mov_b32 v36, 0
    v_mov_b32 v37, 0
    v_mov_b32 v38, 0
    v_mov_b32 v39, 0
    v_mov_b32 v40, 0
    v_mov_b32 v41, 0
    v_mov_b32 v42, 0
    v_mov_b32 v43, 0
    v_mov_b32 v44, 0
    v_mov_b32 v45, 0
    v_mov_b32 v46, 0
    v_mov_b32 v47, 0
    v_mov_b32 v48, 0
    v_mov_b32 v49, 0
    v_mov_b32 v50, 0
    v_mov_b32 v51, 0
    v_mov_b32 v52, 0
    v_mov_b32 v53, 0
    v_mov_b32 v54, 0
    v_mov_b32 v55, 0
    v_mov_b32 v56, 0
    v_mov_b32 v57, 0
    v_mov_b32 v58, 0
    v_mov_b32 v59, 0
    v_mov_b32 v60, 0
    v_mov_b32 v61, 0
    v_mov_b32 v62, 0
    v_mov_b32 v63, 0
    v_mov_b32 v64, 0
    v_mov_b32 v65, 0
    v_mov_b32 v66, 0
    v_mov_b32 v67, 0
    v_mov_b32 v68, 0
    v_mov_b32 v69, 0
    v_mov_b32 v70, 0
    v_mov_b32 v71, 0
    v_mov_b32 v72, 0
    v_mov_b32 v73, 0
    v_mov_b32 v74, 0
    v_mov_b32 v75, 0
    v_mov_b32 v237, 0xff800000
    v_mov_b32 v239, 0
    v_mov_b32 v76, 0
    v_mov_b32 v77, 0
    v_mov_b32 v78, 0
    v_mov_b32 v79, 0
    v_mov_b32 v80, 0
    v_mov_b32 v81, 0
    v_mov_b32 v82, 0
    v_mov_b32 v83, 0
    v_mov_b32 v84, 0
    v_mov_b32 v85, 0
    v_mov_b32 v86, 0
    v_mov_b32 v87, 0
    v_mov_b32 v88, 0
    v_mov_b32 v89, 0
    v_mov_b32 v90, 0
    v_mov_b32 v91, 0
    v_mov_b32 v92, 0
    v_mov_b32 v93, 0
    v_mov_b32 v94, 0
    v_mov_b32 v95, 0
    v_mov_b32 v96, 0
    v_mov_b32 v97, 0
    v_mov_b32 v98, 0
    v_mov_b32 v99, 0
    v_mov_b32 v100, 0
    v_mov_b32 v101, 0
    v_mov_b32 v102, 0
    v_mov_b32 v103, 0
    v_mov_b32 v104, 0
    v_mov_b32 v105, 0
    v_mov_b32 v106, 0
    v_mov_b32 v107, 0
    v_mov_b32 v108, 0
    v_mov_b32 v109, 0
    v_mov_b32 v110, 0
    v_mov_b32 v111, 0
    v_mov_b32 v112, 0
    v_mov_b32 v113, 0
    v_mov_b32 v114, 0
    v_mov_b32 v115, 0
    v_mov_b32 v116, 0
    v_mov_b32 v117, 0
    v_mov_b32 v118, 0
    v_mov_b32 v119, 0
    v_mov_b32 v120, 0
    v_mov_b32 v121, 0
    v_mov_b32 v122, 0
    v_mov_b32 v123, 0
    v_mov_b32 v124, 0
    v_mov_b32 v125, 0
    v_mov_b32 v126, 0
    v_mov_b32 v127, 0
    v_mov_b32 v128, 0
    v_mov_b32 v129, 0
    v_mov_b32 v130, 0
    v_mov_b32 v131, 0
    v_mov_b32 v132, 0
    v_mov_b32 v133, 0
    v_mov_b32 v134, 0
    v_mov_b32 v135, 0
    v_mov_b32 v136, 0
    v_mov_b32 v137, 0
    v_mov_b32 v138, 0
    v_mov_b32 v139, 0
    s_mov_b32 s39, 0
    s_add_u32 s35, s37, 0x0
    s_add_u32 s36, s40, s39
    s_add_u32 m0, s36, 0x0
    buffer_load_dwordx4 v6, s[16:19], s35 offen lds
    s_add_u32 s35, s37, 0x400
    s_add_u32 s36, s40, s39
    s_add_u32 m0, s36, 0x400
    buffer_load_dwordx4 v6, s[16:19], s35 offen lds
    s_add_u32 s35, s37, 0x800
    s_add_u32 s36, s40, s39
    s_add_u32 m0, s36, 0x800
    buffer_load_dwordx4 v6, s[16:19], s35 offen lds
    s_add_u32 s35, s37, 0xc00
    s_add_u32 s36, s40, s39
    s_add_u32 m0, s36, 0xc00
    buffer_load_dwordx4 v6, s[16:19], s35 offen lds
    s_add_u32 s35, s38, 0x0
    s_add_u32 s36, s41, s39
    s_add_u32 m0, s36, 0x0
    buffer_load_dwordx4 v6, s[20:23], s35 offen lds
    s_add_u32 s35, s38, 0x400
    s_add_u32 s36, s41, s39
    s_add_u32 m0, s36, 0x400
    buffer_load_dwordx4 v6, s[20:23], s35 offen lds
    s_add_u32 s35, s38, 0x800
    s_add_u32 s36, s41, s39
    s_add_u32 m0, s36, 0x800
    buffer_load_dwordx4 v6, s[20:23], s35 offen lds
    s_add_u32 s35, s38, 0xc00
    s_add_u32 s36, s41, s39
    s_add_u32 m0, s36, 0xc00
    buffer_load_dwordx4 v6, s[20:23], s35 offen lds
    s_add_u32 s37, s37, 16384
    s_add_u32 s38, s38, 4096
    s_mov_b32 s34, 0
attna_kernel_loop:
    s_waitcnt vmcnt(0)
    s_barrier
    ds_read_b128 a[64:67], v7 offset:0
    ds_read_b128 a[68:71], v7 offset:1024
    ds_read_b128 a[72:75], v7 offset:2048
    ds_read_b128 a[76:79], v7 offset:3072
    s_xor_b32 s39, s39, 32768
    s_add_u32 s35, s34, 1
    s_cmp_lt_u32 s35, s33
    s_cselect_b32 s43, 1, 0
    s_cmp_ge_u32 s34, s32
    s_cbranch_scc1 attna_kernel_skipL
    s_waitcnt lgkmcnt(3)
    v_mfma_f32_32x32x16_bf16 v[140:155], a[64:67], a[0:3], 0
    ds_read_b128 a[80:83], v7 offset:4096
    ds_read_b128 a[84:87], v7 offset:5120
    ds_read_b128 a[88:91], v7 offset:6144
    s_waitcnt lgkmcnt(5)
    v_mfma_f32_32x32x16_bf16 v[140:155], a[68:71], a[4:7], v[140:155]
    ds_read_b128 a[92:95], v7 offset:7168
    ds_read_b128 a[96:99], v7 offset:8192
    ds_read_b128 a[100:103], v7 offset:9216
    s_waitcnt lgkmcnt(7)
    v_mfma_f32_32x32x16_bf16 v[140:155], a[72:75], a[8:11], v[140:155]
    ds_read_b128 a[104:107], v7 offset:10240
    ds_read_b128 a[108:111], v7 offset:11264
    ds_read_b128 a[112:115], v7 offset:12288
    s_waitcnt lgkmcnt(9)
    v_mfma_f32_32x32x16_bf16 v[140:155], a[76:79], a[12:15], v[140:155]
    ds_read_b128 a[116:119], v7 offset:13312
    ds_read_b128 a[120:123], v7 offset:14336
    ds_read_b128 a[124:127], v7 offset:15360
    s_waitcnt lgkmcnt(11)
    v_mfma_f32_32x32x16_bf16 v[140:155], a[80:83], a[16:19], v[140:155]
    ds_read_b128 a[128:131], v8 offset:0
    ds_read_b128 a[132:135], v8 offset:1024
    ds_read_b128 a[136:139], v8 offset:2048
    s_waitcnt lgkmcnt(13)
    v_mfma_f32_32x32x16_bf16 v[140:155], a[84:87], a[20:23], v[140:155]
    ds_read_b128 a[140:143], v8 offset:3072
    ds_read_b128 a[144:147], v8 offset:4096
    ds_read_b128 a[148:151], v8 offset:5120
    s_waitcnt lgkmcnt(11)
    v_mfma_f32_32x32x16_bf16 v[140:155], a[88:91], a[24:27], v[140:155]
    ds_read_b128 a[152:155], v8 offset:6144
    ds_read_b128 a[156:159], v8 offset:7168
    ds_read_b128 a[160:163], v8 offset:8192
    v_mfma_f32_32x32x16_bf16 v[140:155], a[92:95], a[28:31], v[140:155]
    ds_read_b128 a[164:167], v8 offset:9216
    s_waitcnt lgkmcnt(11)
    ds_read_b128 a[168:171], v8 offset:10240
    v_mfma_f32_32x32x16_bf16 v[156:171], a[96:99], a[0:3], 0
    ds_read_b128 a[172:175], v8 offset:11264
    ds_read_b128 a[176:179], v8 offset:12288
    v_mfma_f32_32x32x16_bf16 v[156:171], a[100:103], a[4:7], v[156:171]
    ds_read_b128 a[180:183], v8 offset:13312
    s_waitcnt lgkmcnt(11)
    ds_read_b128 a[184:187], v8 offset:14336
    v_mfma_f32_32x32x16_bf16 v[156:171], a[104:107], a[8:11], v[156:171]
    ds_read_b128 a[188:191], v8 offset:15360
    s_cmp_eq_u32 s43, 0
    s_cbranch_scc1 attna_kernel_nd1
    s_add_u32 s35, s37, 0x0
    s_add_u32 s36, s40, s39
    s_add_u32 m0, s36, 0x0
    buffer_load_dwordx4 v6, s[16:19], s35 offen lds
attna_kernel_nd1:
    v_mfma_f32_32x32x16_bf16 v[156:171], a[108:111], a[12:15], v[156:171]
    s_cmp_eq_u32 s43, 0
    s_cbranch_scc1 attna_kernel_nd2
    s_add_u32 s35, s37, 0x400
    s_add_u32 s36, s40, s39
    s_add_u32 m0, s36, 0x400
    buffer_load_dwordx4 v6, s[16:19], s35 offen lds
attna_kernel_nd2:
    s_cmp_eq_u32 s43, 0
    s_cbranch_scc1 attna_kernel_nd3
    s_add_u32 s35, s37, 0x800
    s_add_u32 s36, s40, s39
    s_add_u32 m0, s36, 0x800
    buffer_load_dwordx4 v6, s[16:19], s35 offen lds
attna_kernel_nd3:
    v_mfma_f32_32x32x16_bf16 v[156:171], a[112:115], a[16:19], v[156:171]
    s_cmp_eq_u32 s43, 0
    s_cbranch_scc1 attna_kernel_nd4
    s_add_u32 s35, s37, 0xc00
    s_add_u32 s36, s40, s39
    s_add_u32 m0, s36, 0xc00
    buffer_load_dwordx4 v6, s[16:19], s35 offen lds
attna_kernel_nd4:
    s_cmp_eq_u32 s43, 0
    s_cbranch_scc1 attna_kernel_nd5
    s_add_u32 s35, s38, 0x0
    s_add_u32 s36, s41, s39
    s_add_u32 m0, s36, 0x0
    buffer_load_dwordx4 v6, s[20:23], s35 offen lds
attna_kernel_nd5:
    v_mfma_f32_32x32x16_bf16 v[156:171], a[116:119], a[20:23], v[156:171]
    s_cmp_eq_u32 s43, 0
    s_cbranch_scc1 attna_kernel_nd6
    s_add_u32 s35, s38, 0x400
    s_add_u32 s36, s41, s39
    s_add_u32 m0, s36, 0x400
    buffer_load_dwordx4 v6, s[20:23], s35 offen lds
attna_kernel_nd6:
    s_cmp_eq_u32 s43, 0
    s_cbranch_scc1 attna_kernel_nd7
    s_add_u32 s35, s38, 0x800
    s_add_u32 s36, s41, s39
    s_add_u32 m0, s36, 0x800
    buffer_load_dwordx4 v6, s[20:23], s35 offen lds
attna_kernel_nd7:
    v_mfma_f32_32x32x16_bf16 v[156:171], a[120:123], a[24:27], v[156:171]
    s_cmp_eq_u32 s43, 0
    s_cbranch_scc1 attna_kernel_nd8
    s_add_u32 s35, s38, 0xc00
    s_add_u32 s36, s41, s39
    s_add_u32 m0, s36, 0xc00
    buffer_load_dwordx4 v6, s[20:23], s35 offen lds
attna_kernel_nd8:
    s_add_u32 s37, s37, 16384
    s_add_u32 s38, s38, 4096
    v_xor_b32 v7, 32768, v7
    v_xor_b32 v8, 32768, v8
    v_mfma_f32_32x32x16_bf16 v[156:171], a[124:127], a[28:31], v[156:171]
    v_mfma_f32_32x32x16_bf16 v[172:187], a[64:67], a[32:35], 0
    v_mfma_f32_32x32x16_bf16 v[172:187], a[68:71], a[36:39], v[172:187]
    v_mfma_f32_32x32x16_bf16 v[172:187], a[72:75], a[40:43], v[172:187]
    v_mfma_f32_32x32x16_bf16 v[172:187], a[76:79], a[44:47], v[172:187]
    s_lshl_b32 s35, s34, 1
    s_add_u32 s35, s35, 1
    s_cmp_lt_u32 s35, s30
    s_cbranch_scc1 attna_kernel_nm9
    s_lshl_b32 s35, s30, 5
    s_lshl_b32 s36, s34, 6
    s_sub_u32 s35, s35, s36
    v_add_u32 v244, s35, v9
    v_cmp_gt_i32 vcc, 0, v244
    s_nop 1
    v_cndmask_b32 v140, v140, v245, vcc
    v_cmp_gt_i32 vcc, 1, v244
    s_nop 1
    v_cndmask_b32 v141, v141, v245, vcc
    v_cmp_gt_i32 vcc, 2, v244
    s_nop 1
    v_cndmask_b32 v142, v142, v245, vcc
    v_cmp_gt_i32 vcc, 3, v244
    s_nop 1
    v_cndmask_b32 v143, v143, v245, vcc
    v_cmp_gt_i32 vcc, 4, v244
    s_nop 1
    v_cndmask_b32 v144, v144, v245, vcc
    v_cmp_gt_i32 vcc, 5, v244
    s_nop 1
    v_cndmask_b32 v145, v145, v245, vcc
    v_cmp_gt_i32 vcc, 6, v244
    s_nop 1
    v_cndmask_b32 v146, v146, v245, vcc
    v_cmp_gt_i32 vcc, 7, v244
    s_nop 1
    v_cndmask_b32 v147, v147, v245, vcc
    v_cmp_gt_i32 vcc, 16, v244
    s_nop 1
    v_cndmask_b32 v148, v148, v245, vcc
    v_cmp_gt_i32 vcc, 17, v244
    s_nop 1
    v_cndmask_b32 v149, v149, v245, vcc
    v_cmp_gt_i32 vcc, 18, v244
    s_nop 1
    v_cndmask_b32 v150, v150, v245, vcc
    v_cmp_gt_i32 vcc, 19, v244
    s_nop 1
    v_cndmask_b32 v151, v151, v245, vcc
    v_cmp_gt_i32 vcc, 20, v244
    s_nop 1
    v_cndmask_b32 v152, v152, v245, vcc
    v_cmp_gt_i32 vcc, 21, v244
    s_nop 1
    v_cndmask_b32 v153, v153, v245, vcc
    v_cmp_gt_i32 vcc, 22, v244
    s_nop 1
    v_cndmask_b32 v154, v154, v245, vcc
    v_cmp_gt_i32 vcc, 23, v244
    s_nop 1
    v_cndmask_b32 v155, v155, v245, vcc
    v_cmp_gt_i32 vcc, 32, v244
    s_nop 1
    v_cndmask_b32 v156, v156, v245, vcc
    v_cmp_gt_i32 vcc, 33, v244
    s_nop 1
    v_cndmask_b32 v157, v157, v245, vcc
    v_cmp_gt_i32 vcc, 34, v244
    s_nop 1
    v_cndmask_b32 v158, v158, v245, vcc
    v_cmp_gt_i32 vcc, 35, v244
    s_nop 1
    v_cndmask_b32 v159, v159, v245, vcc
    v_cmp_gt_i32 vcc, 36, v244
    s_nop 1
    v_cndmask_b32 v160, v160, v245, vcc
    v_cmp_gt_i32 vcc, 37, v244
    s_nop 1
    v_cndmask_b32 v161, v161, v245, vcc
    v_cmp_gt_i32 vcc, 38, v244
    s_nop 1
    v_cndmask_b32 v162, v162, v245, vcc
    v_cmp_gt_i32 vcc, 39, v244
    s_nop 1
    v_cndmask_b32 v163, v163, v245, vcc
    v_cmp_gt_i32 vcc, 48, v244
    s_nop 1
    v_cndmask_b32 v164, v164, v245, vcc
    v_cmp_gt_i32 vcc, 49, v244
    s_nop 1
    v_cndmask_b32 v165, v165, v245, vcc
    v_cmp_gt_i32 vcc, 50, v244
    s_nop 1
    v_cndmask_b32 v166, v166, v245, vcc
    v_cmp_gt_i32 vcc, 51, v244
    s_nop 1
    v_cndmask_b32 v167, v167, v245, vcc
    v_cmp_gt_i32 vcc, 52, v244
    s_nop 1
    v_cndmask_b32 v168, v168, v245, vcc
    v_cmp_gt_i32 vcc, 53, v244
    s_nop 1
    v_cndmask_b32 v169, v169, v245, vcc
    v_cmp_gt_i32 vcc, 54, v244
    s_nop 1
    v_cndmask_b32 v170, v170, v245, vcc
    v_cmp_gt_i32 vcc, 55, v244
    s_nop 1
    v_cndmask_b32 v171, v171, v245, vcc
attna_kernel_nm9:
    v_max3_f32 v240, v140, v141, v142
    v_max3_f32 v241, v148, v149, v150
    v_max3_f32 v242, v156, v157, v158
    v_max3_f32 v244, v164, v165, v166
    v_max3_f32 v240, v240, v143, v144
    v_max3_f32 v241, v241, v151, v152
    v_max3_f32 v242, v242, v159, v160
    v_max3_f32 v244, v244, v167, v168
    v_max3_f32 v240, v240, v145, v146
    v_max3_f32 v241, v241, v153, v154
    v_max3_f32 v242, v242, v161, v162
    v_max3_f32 v244, v244, v169, v170
    v_max_f32 v240, v240, v147
    v_max_f32 v241, v241, v155
    v_max_f32 v242, v242, v163
    v_max_f32 v244, v244, v171
    v_max3_f32 v240, v240, v241, v242
    v_max_f32 v240, v240, v244
    v_mov_b32 v241, v240
    s_nop 1
    v_permlane32_swap_b32 v240, v241
    v_max_f32 v240, v240, v241
    v_sub_f32 v241, v240, v236
    v_cmp_lt_f32 vcc, s42, v241
    s_nop 1
    s_cbranch_vccz attna_kernel_nr10
    v_max_f32 v240, v240, v236
    v_sub_f32 v242, v236, v240
    v_mul_f32 v242, s28, v242
    v_exp_f32 v242, v242
    v_mov_b32 v236, v240
    v_mul_f32 v238, v238, v242
    v_mul_f32 v12, v12, v242
    v_mul_f32 v13, v13, v242
    v_mul_f32 v14, v14, v242
    v_mul_f32 v15, v15, v242
    v_mul_f32 v16, v16, v242
    v_mul_f32 v17, v17, v242
    v_mul_f32 v18, v18, v242
    v_mul_f32 v19, v19, v242
    v_mul_f32 v20, v20, v242
    v_mul_f32 v21, v21, v242
    v_mul_f32 v22, v22, v242
    v_mul_f32 v23, v23, v242
    v_mul_f32 v24, v24, v242
    v_mul_f32 v25, v25, v242
    v_mul_f32 v26, v26, v242
    v_mul_f32 v27, v27, v242
    v_mul_f32 v28, v28, v242
    v_mul_f32 v29, v29, v242
    v_mul_f32 v30, v30, v242
    v_mul_f32 v31, v31, v242
    v_mul_f32 v32, v32, v242
    v_mul_f32 v33, v33, v242
    v_mul_f32 v34, v34, v242
    v_mul_f32 v35, v35, v242
    v_mul_f32 v36, v36, v242
    v_mul_f32 v37, v37, v242
    v_mul_f32 v38, v38, v242
    v_mul_f32 v39, v39, v242
    v_mul_f32 v40, v40, v242
    v_mul_f32 v41, v41, v242
    v_mul_f32 v42, v42, v242
    v_mul_f32 v43, v43, v242
    v_mul_f32 v44, v44, v242
    v_mul_f32 v45, v45, v242
    v_mul_f32 v46, v46, v242
    v_mul_f32 v47, v47, v242
    v_mul_f32 v48, v48, v242
    v_mul_f32 v49, v49, v242
    v_mul_f32 v50, v50, v242
    v_mul_f32 v51, v51, v242
    v_mul_f32 v52, v52, v242
    v_mul_f32 v53, v53, v242
    v_mul_f32 v54, v54, v242
    v_mul_f32 v55, v55, v242
    v_mul_f32 v56, v56, v242
    v_mul_f32 v57, v57, v242
    v_mul_f32 v58, v58, v242
    v_mul_f32 v59, v59, v242
    v_mul_f32 v60, v60, v242
    v_mul_f32 v61, v61, v242
    v_mul_f32 v62, v62, v242
    v_mul_f32 v63, v63, v242
    v_mul_f32 v64, v64, v242
    v_mul_f32 v65, v65, v242
    v_mul_f32 v66, v66, v242
    v_mul_f32 v67, v67, v242
    v_mul_f32 v68, v68, v242
    v_mul_f32 v69, v69, v242
    v_mul_f32 v70, v70, v242
    v_mul_f32 v71, v71, v242
    v_mul_f32 v72, v72, v242
    v_mul_f32 v73, v73, v242
    v_mul_f32 v74, v74, v242
    v_mul_f32 v75, v75, v242
attna_kernel_nr10:
    v_mul_f32 v243, s29, v236
    v_mfma_f32_32x32x16_bf16 v[172:187], a[80:83], a[48:51], v[172:187]
    v_fma_f32 v140, v140, s28, v243
    v_fma_f32 v141, v141, s28, v243
    v_fma_f32 v142, v142, s28, v243
    v_fma_f32 v143, v143, s28, v243
    v_fma_f32 v144, v144, s28, v243
    v_fma_f32 v145, v145, s28, v243
    v_fma_f32 v146, v146, s28, v243
    v_fma_f32 v147, v147, s28, v243
    v_exp_f32 v140, v140
    v_exp_f32 v141, v141
    v_exp_f32 v142, v142
    v_mfma_f32_32x32x16_bf16 v[172:187], a[84:87], a[52:55], v[172:187]
    v_exp_f32 v143, v143
    v_exp_f32 v144, v144
    v_exp_f32 v145, v145
    v_exp_f32 v146, v146
    v_exp_f32 v147, v147
    v_fma_f32 v148, v148, s28, v243
    v_fma_f32 v149, v149, s28, v243
    v_fma_f32 v150, v150, s28, v243
    v_fma_f32 v151, v151, s28, v243
    v_fma_f32 v152, v152, s28, v243
    v_fma_f32 v153, v153, s28, v243
    v_mfma_f32_32x32x16_bf16 v[172:187], a[88:91], a[56:59], v[172:187]
    v_fma_f32 v154, v154, s28, v243
    v_fma_f32 v155, v155, s28, v243
    v_exp_f32 v148, v148
    v_exp_f32 v149, v149
    v_exp_f32 v150, v150
    v_exp_f32 v151, v151
    v_exp_f32 v152, v152
    v_exp_f32 v153, v153
    v_exp_f32 v154, v154
    v_exp_f32 v155, v155
    v_mfma_f32_32x32x16_bf16 v[172:187], a[92:95], a[60:63], v[172:187]
    v_fma_f32 v156, v156, s28, v243
    v_fma_f32 v157, v157, s28, v243
    v_fma_f32 v158, v158, s28, v243
    v_fma_f32 v159, v159, s28, v243
    v_fma_f32 v160, v160, s28, v243
    v_fma_f32 v161, v161, s28, v243
    v_fma_f32 v162, v162, s28, v243
    v_fma_f32 v163, v163, s28, v243
    v_exp_f32 v156, v156
    v_exp_f32 v157, v157
    v_mfma_f32_32x32x16_bf16 v[188:203], a[96:99], a[32:35], 0
    v_exp_f32 v158, v158
    v_exp_f32 v159, v159
    v_exp_f32 v160, v160
    v_exp_f32 v161, v161
    v_exp_f32 v162, v162
    v_exp_f32 v163, v163
    v_fma_f32 v164, v164, s28, v243
    v_fma_f32 v165, v165, s28, v243
    v_fma_f32 v166, v166, s28, v243
    v_fma_f32 v167, v167, s28, v243
    v_mfma_f32_32x32x16_bf16 v[188:203], a[100:103], a[36:39], v[188:203]
    v_fma_f32 v168, v168, s28, v243
    v_fma_f32 v169, v169, s28, v243
    v_fma_f32 v170, v170, s28, v243
    v_fma_f32 v171, v171, s28, v243
    v_exp_f32 v164, v164
    v_exp_f32 v165, v165
    v_exp_f32 v166, v166
    v_exp_f32 v167, v167
    v_exp_f32 v168, v168
    v_exp_f32 v169, v169
    v_mfma_f32_32x32x16_bf16 v[188:203], a[104:107], a[40:43], v[188:203]
    v_exp_f32 v170, v170
    v_exp_f32 v171, v171
    v_add_f32 v240, v140, v144
    v_add_f32 v241, v141, v145
    v_add_f32 v242, v142, v146
    v_add_f32 v244, v143, v147
    v_add_f32 v240, v240, v148
    v_add_f32 v241, v241, v149
    v_add_f32 v242, v242, v150
    v_add_f32 v244, v244, v151
    v_mfma_f32_32x32x16_bf16 v[188:203], a[108:111], a[44:47], v[188:203]
    v_add_f32 v240, v240, v152
    v_add_f32 v241, v241, v153
    v_add_f32 v242, v242, v154
    v_add_f32 v244, v244, v155
    v_add_f32 v240, v240, v156
    v_add_f32 v241, v241, v157
    v_add_f32 v242, v242, v158
    v_add_f32 v244, v244, v159
    v_add_f32 v240, v240, v160
    v_add_f32 v241, v241, v161
    v_mfma_f32_32x32x16_bf16 v[188:203], a[112:115], a[48:51], v[188:203]
    v_add_f32 v242, v242, v162
    v_add_f32 v244, v244, v163
    v_add_f32 v240, v240, v164
    v_add_f32 v241, v241, v165
    v_add_f32 v242, v242, v166
    v_add_f32 v244, v244, v167
    v_add_f32 v240, v240, v168
    v_add_f32 v241, v241, v169
    v_add_f32 v242, v242, v170
    v_add_f32 v244, v244, v171
    v_mfma_f32_32x32x16_bf16 v[188:203], a[116:119], a[52:55], v[188:203]
    v_add_f32 v240, v240, v241
    v_add_f32 v242, v242, v244
    v_add_f32 v238, v238, v240
    v_add_f32 v238, v238, v242
    v_cvt_pk_bf16_f32 v204, v140, v141
    v_cvt_pk_bf16_f32 v205, v142, v143
    v_cvt_pk_bf16_f32 v206, v144, v145
    v_cvt_pk_bf16_f32 v207, v146, v147
    v_cvt_pk_bf16_f32 v208, v148, v149
    v_cvt_pk_bf16_f32 v209, v150, v151
    v_mfma_f32_32x32x16_bf16 v[188:203], a[120:123], a[56:59], v[188:203]
    v_cvt_pk_bf16_f32 v210, v152, v153
    v_cvt_pk_bf16_f32 v211, v154, v155
    v_cvt_pk_bf16_f32 v212, v156, v157
    v_cvt_pk_bf16_f32 v213, v158, v159
    v_cvt_pk_bf16_f32 v214, v160, v161
    v_cvt_pk_bf16_f32 v215, v162, v163
    v_cvt_pk_bf16_f32 v216, v164, v165
    v_cvt_pk_bf16_f32 v217, v166, v167
    v_cvt_pk_bf16_f32 v218, v168, v169
    v_cvt_pk_bf16_f32 v219, v170, v171
    v_mfma_f32_32x32x16_bf16 v[188:203], a[124:127], a[60:63], v[188:203]
    s_nop 1
    v_mfma_f32_32x32x16_bf16 v[12:27], a[128:131], v[204:207], v[12:27]
    s_waitcnt lgkmcnt(11)
    v_mfma_f32_32x32x16_bf16 v[28:43], a[144:147], v[204:207], v[28:43]
    s_lshl_b32 s35, s34, 1
    s_add_u32 s35, s35, 1
    s_cmp_lt_u32 s35, s31
    s_cbranch_scc1 attna_kernel_nm11
    s_lshl_b32 s35, s31, 5
    s_lshl_b32 s36, s34, 6
    s_sub_u32 s35, s35, s36
    v_add_u32 v244, s35, v9
    v_cmp_gt_i32 vcc, 0, v244
    s_nop 1
    v_cndmask_b32 v172, v172, v245, vcc
    v_cmp_gt_i32 vcc, 1, v244
    s_nop 1
    v_cndmask_b32 v173, v173, v245, vcc
    v_cmp_gt_i32 vcc, 2, v244
    s_nop 1
    v_cndmask_b32 v174, v174, v245, vcc
    v_cmp_gt_i32 vcc, 3, v244
    s_nop 1
    v_cndmask_b32 v175, v175, v245, vcc
    v_cmp_gt_i32 vcc, 4, v244
    s_nop 1
    v_cndmask_b32 v176, v176, v245, vcc
    v_cmp_gt_i32 vcc, 5, v244
    s_nop 1
    v_cndmask_b32 v177, v177, v245, vcc
    v_cmp_gt_i32 vcc, 6, v244
    s_nop 1
    v_cndmask_b32 v178, v178, v245, vcc
    v_cmp_gt_i32 vcc, 7, v244
    s_nop 1
    v_cndmask_b32 v179, v179, v245, vcc
    v_cmp_gt_i32 vcc, 16, v244
    s_nop 1
    v_cndmask_b32 v180, v180, v245, vcc
    v_cmp_gt_i32 vcc, 17, v244
    s_nop 1
    v_cndmask_b32 v181, v181, v245, vcc
    v_cmp_gt_i32 vcc, 18, v244
    s_nop 1
    v_cndmask_b32 v182, v182, v245, vcc
    v_cmp_gt_i32 vcc, 19, v244
    s_nop 1
    v_cndmask_b32 v183, v183, v245, vcc
    v_cmp_gt_i32 vcc, 20, v244
    s_nop 1
    v_cndmask_b32 v184, v184, v245, vcc
    v_cmp_gt_i32 vcc, 21, v244
    s_nop 1
    v_cndmask_b32 v185, v185, v245, vcc
    v_cmp_gt_i32 vcc, 22, v244
    s_nop 1
    v_cndmask_b32 v186, v186, v245, vcc
    v_cmp_gt_i32 vcc, 23, v244
    s_nop 1
    v_cndmask_b32 v187, v187, v245, vcc
    v_cmp_gt_i32 vcc, 32, v244
    s_nop 1
    v_cndmask_b32 v188, v188, v245, vcc
    v_cmp_gt_i32 vcc, 33, v244
    s_nop 1
    v_cndmask_b32 v189, v189, v245, vcc
    v_cmp_gt_i32 vcc, 34, v244
    s_nop 1
    v_cndmask_b32 v190, v190, v245, vcc
    v_cmp_gt_i32 vcc, 35, v244
    s_nop 1
    v_cndmask_b32 v191, v191, v245, vcc
    v_cmp_gt_i32 vcc, 36, v244
    s_nop 1
    v_cndmask_b32 v192, v192, v245, vcc
    v_cmp_gt_i32 vcc, 37, v244
    s_nop 1
    v_cndmask_b32 v193, v193, v245, vcc
    v_cmp_gt_i32 vcc, 38, v244
    s_nop 1
    v_cndmask_b32 v194, v194, v245, vcc
    v_cmp_gt_i32 vcc, 39, v244
    s_nop 1
    v_cndmask_b32 v195, v195, v245, vcc
    v_cmp_gt_i32 vcc, 48, v244
    s_nop 1
    v_cndmask_b32 v196, v196, v245, vcc
    v_cmp_gt_i32 vcc, 49, v244
    s_nop 1
    v_cndmask_b32 v197, v197, v245, vcc
    v_cmp_gt_i32 vcc, 50, v244
    s_nop 1
    v_cndmask_b32 v198, v198, v245, vcc
    v_cmp_gt_i32 vcc, 51, v244
    s_nop 1
    v_cndmask_b32 v199, v199, v245, vcc
    v_cmp_gt_i32 vcc, 52, v244
    s_nop 1
    v_cndmask_b32 v200, v200, v245, vcc
    v_cmp_gt_i32 vcc, 53, v244
    s_nop 1
    v_cndmask_b32 v201, v201, v245, vcc
    v_cmp_gt_i32 vcc, 54, v244
    s_nop 1
    v_cndmask_b32 v202, v202, v245, vcc
    v_cmp_gt_i32 vcc, 55, v244
    s_nop 1
    v_cndmask_b32 v203, v203, v245, vcc
attna_kernel_nm11:
    v_max3_f32 v240, v172, v173, v174
    v_max3_f32 v241, v180, v181, v182
    v_max3_f32 v242, v188, v189, v190
    v_max3_f32 v244, v196, v197, v198
    v_max3_f32 v240, v240, v175, v176
    v_max3_f32 v241, v241, v183, v184
    v_max3_f32 v242, v242, v191, v192
    v_max3_f32 v244, v244, v199, v200
    v_max3_f32 v240, v240, v177, v178
    v_max3_f32 v241, v241, v185, v186
    v_max3_f32 v242, v242, v193, v194
    v_max3_f32 v244, v244, v201, v202
    v_max_f32 v240, v240, v179
    v_max_f32 v241, v241, v187
    v_max_f32 v242, v242, v195
    v_max_f32 v244, v244, v203
    v_max3_f32 v240, v240, v241, v242
    v_max_f32 v240, v240, v244
    v_mov_b32 v241, v240
    s_nop 1
    v_permlane32_swap_b32 v240, v241
    v_max_f32 v240, v240, v241
    v_sub_f32 v241, v240, v237
    v_cmp_lt_f32 vcc, s42, v241
    s_nop 1
    s_cbranch_vccz attna_kernel_nr12
    v_max_f32 v240, v240, v237
    v_sub_f32 v242, v237, v240
    v_mul_f32 v242, s28, v242
    v_exp_f32 v242, v242
    v_mov_b32 v237, v240
    v_mul_f32 v239, v239, v242
    v_mul_f32 v76, v76, v242
    v_mul_f32 v77, v77, v242
    v_mul_f32 v78, v78, v242
    v_mul_f32 v79, v79, v242
    v_mul_f32 v80, v80, v242
    v_mul_f32 v81, v81, v242
    v_mul_f32 v82, v82, v242
    v_mul_f32 v83, v83, v242
    v_mul_f32 v84, v84, v242
    v_mul_f32 v85, v85, v242
    v_mul_f32 v86, v86, v242
    v_mul_f32 v87, v87, v242
    v_mul_f32 v88, v88, v242
    v_mul_f32 v89, v89, v242
    v_mul_f32 v90, v90, v242
    v_mul_f32 v91, v91, v242
    v_mul_f32 v92, v92, v242
    v_mul_f32 v93, v93, v242
    v_mul_f32 v94, v94, v242
    v_mul_f32 v95, v95, v242
    v_mul_f32 v96, v96, v242
    v_mul_f32 v97, v97, v242
    v_mul_f32 v98, v98, v242
    v_mul_f32 v99, v99, v242
    v_mul_f32 v100, v100, v242
    v_mul_f32 v101, v101, v242
    v_mul_f32 v102, v102, v242
    v_mul_f32 v103, v103, v242
    v_mul_f32 v104, v104, v242
    v_mul_f32 v105, v105, v242
    v_mul_f32 v106, v106, v242
    v_mul_f32 v107, v107, v242
    v_mul_f32 v108, v108, v242
    v_mul_f32 v109, v109, v242
    v_mul_f32 v110, v110, v242
    v_mul_f32 v111, v111, v242
    v_mul_f32 v112, v112, v242
    v_mul_f32 v113, v113, v242
    v_mul_f32 v114, v114, v242
    v_mul_f32 v115, v115, v242
    v_mul_f32 v116, v116, v242
    v_mul_f32 v117, v117, v242
    v_mul_f32 v118, v118, v242
    v_mul_f32 v119, v119, v242
    v_mul_f32 v120, v120, v242
    v_mul_f32 v121, v121, v242
    v_mul_f32 v122, v122, v242
    v_mul_f32 v123, v123, v242
    v_mul_f32 v124, v124, v242
    v_mul_f32 v125, v125, v242
    v_mul_f32 v126, v126, v242
    v_mul_f32 v127, v127, v242
    v_mul_f32 v128, v128, v242
    v_mul_f32 v129, v129, v242
    v_mul_f32 v130, v130, v242
    v_mul_f32 v131, v131, v242
    v_mul_f32 v132, v132, v242
    v_mul_f32 v133, v133, v242
    v_mul_f32 v134, v134, v242
    v_mul_f32 v135, v135, v242
    v_mul_f32 v136, v136, v242
    v_mul_f32 v137, v137, v242
    v_mul_f32 v138, v138, v242
    v_mul_f32 v139, v139, v242
attna_kernel_nr12:
    v_mul_f32 v243, s29, v237
    s_waitcnt lgkmcnt(7)
    v_mfma_f32_32x32x16_bf16 v[44:59], a[160:163], v[204:207], v[44:59]
    v_fma_f32 v172, v172, s28, v243
    v_fma_f32 v173, v173, s28, v243
    v_fma_f32 v174, v174, s28, v243
    v_fma_f32 v175, v175, s28, v243
    v_fma_f32 v176, v176, s28, v243
    v_fma_f32 v177, v177, s28, v243
    v_fma_f32 v178, v178, s28, v243
    v_fma_f32 v179, v179, s28, v243
    v_exp_f32 v172, v172
    s_waitcnt lgkmcnt(3)
    v_mfma_f32_32x32x16_bf16 v[60:75], a[176:179], v[204:207], v[60:75]
    v_exp_f32 v173, v173
    v_exp_f32 v174, v174
    v_exp_f32 v175, v175
    v_exp_f32 v176, v176
    v_exp_f32 v177, v177
    v_exp_f32 v178, v178
    v_exp_f32 v179, v179
    v_fma_f32 v180, v180, s28, v243
    v_fma_f32 v181, v181, s28, v243
    v_mfma_f32_32x32x16_bf16 v[12:27], a[132:135], v[208:211], v[12:27]
    v_fma_f32 v182, v182, s28, v243
    v_fma_f32 v183, v183, s28, v243
    v_fma_f32 v184, v184, s28, v243
    v_fma_f32 v185, v185, s28, v243
    v_fma_f32 v186, v186, s28, v243
    v_fma_f32 v187, v187, s28, v243
    v_exp_f32 v180, v180
    v_exp_f32 v181, v181
    v_exp_f32 v182, v182
    v_mfma_f32_32x32x16_bf16 v[28:43], a[148:151], v[208:211], v[28:43]
    v_exp_f32 v183, v183
    v_exp_f32 v184, v184
    v_exp_f32 v185, v185
    v_exp_f32 v186, v186
    v_exp_f32 v187, v187
    v_fma_f32 v188, v188, s28, v243
    v_fma_f32 v189, v189, s28, v243
    v_fma_f32 v190, v190, s28, v243
    v_fma_f32 v191, v191, s28, v243
    v_mfma_f32_32x32x16_bf16 v[44:59], a[164:167], v[208:211], v[44:59]
    v_fma_f32 v192, v192, s28, v243
    v_fma_f32 v193, v193, s28, v243
    v_fma_f32 v194, v194, s28, v243
    v_fma_f32 v195, v195, s28, v243
    v_exp_f32 v188, v188
    v_exp_f32 v189, v189
    v_exp_f32 v190, v190
    v_exp_f32 v191, v191
    v_exp_f32 v192, v192
    s_waitcnt lgkmcnt(2)
    v_mfma_f32_32x32x16_bf16 v[60:75], a[180:183], v[208:211], v[60:75]
    v_exp_f32 v193, v193
    v_exp_f32 v194, v194
    v_exp_f32 v195, v195
    v_fma_f32 v196, v196, s28, v243
    v_fma_f32 v197, v197, s28, v243
    v_fma_f32 v198, v198, s28, v243
    v_fma_f32 v199, v199, s28, v243
    v_fma_f32 v200, v200, s28, v243
    v_fma_f32 v201, v201, s28, v243
    v_mfma_f32_32x32x16_bf16 v[12:27], a[136:139], v[212:215], v[12:27]
    v_fma_f32 v202, v202, s28, v243
    v_fma_f32 v203, v203, s28, v243
    v_exp_f32 v196, v196
    v_exp_f32 v197, v197
    v_exp_f32 v198, v198
    v_exp_f32 v199, v199
    v_exp_f32 v200, v200
    v_exp_f32 v201, v201
    v_exp_f32 v202, v202
    v_mfma_f32_32x32x16_bf16 v[28:43], a[152:155], v[212:215], v[28:43]
    v_exp_f32 v203, v203
    v_add_f32 v240, v172, v176
    v_add_f32 v241, v173, v177
    v_add_f32 v242, v174, v178
    v_add_f32 v244, v175, v179
    v_add_f32 v240, v240, v180
    v_add_f32 v241, v241, v181
    v_add_f32 v242, v242, v182
    v_add_f32 v244, v244, v183
    v_mfma_f32_32x32x16_bf16 v[44:59], a[168:171], v[212:215], v[44:59]
    v_add_f32 v240, v240, v184
    v_add_f32 v241, v241, v185
    v_add_f32 v242, v242, v186
    v_add_f32 v244, v244, v187
    v_add_f32 v240, v240, v188
    v_add_f32 v241, v241, v189
    v_add_f32 v242, v242, v190
    v_add_f32 v244, v244, v191
    s_waitcnt lgkmcnt(1)
    v_mfma_f32_32x32x16_bf16 v[60:75], a[184:187], v[212:215], v[60:75]
    v_add_f32 v240, v240, v192
    v_add_f32 v241, v241, v193
    v_add_f32 v242, v242, v194
    v_add_f32 v244, v244, v195
    v_add_f32 v240, v240, v196
    v_add_f32 v241, v241, v197
    v_add_f32 v242, v242, v198
    v_add_f32 v244, v244, v199
    v_mfma_f32_32x32x16_bf16 v[12:27], a[140:143], v[216:219], v[12:27]
    v_add_f32 v240, v240, v200
    v_add_f32 v241, v241, v201
    v_add_f32 v242, v242, v202
    v_add_f32 v244, v244, v203
    v_add_f32 v240, v240, v241
    v_add_f32 v242, v242, v244
    v_add_f32 v239, v239, v240
    v_add_f32 v239, v239, v242
    v_mfma_f32_32x32x16_bf16 v[28:43], a[156:159], v[216:219], v[28:43]
    v_cvt_pk_bf16_f32 v220, v172, v173
    v_cvt_pk_bf16_f32 v221, v174, v175
    v_cvt_pk_bf16_f32 v222, v176, v177
    v_cvt_pk_bf16_f32 v223, v178, v179
    v_cvt_pk_bf16_f32 v224, v180, v181
    v_cvt_pk_bf16_f32 v225, v182, v183
    v_cvt_pk_bf16_f32 v226, v184, v185
    v_cvt_pk_bf16_f32 v227, v186, v187
    v_mfma_f32_32x32x16_bf16 v[44:59], a[172:175], v[216:219], v[44:59]
    v_cvt_pk_bf16_f32 v228, v188, v189
    v_cvt_pk_bf16_f32 v229, v190, v191
    v_cvt_pk_bf16_f32 v230, v192, v193
    v_cvt_pk_bf16_f32 v231, v194, v195
    v_cvt_pk_bf16_f32 v232, v196, v197
    v_cvt_pk_bf16_f32 v233, v198, v199
    v_cvt_pk_bf16_f32 v234, v200, v201
    v_cvt_pk_bf16_f32 v235, v202, v203
    s_waitcnt lgkmcnt(0)
    v_mfma_f32_32x32x16_bf16 v[60:75], a[188:191], v[216:219], v[60:75]
    s_nop 1
    v_mfma_f32_32x32x16_bf16 v[76:91], a[128:131], v[220:223], v[76:91]
    v_mfma_f32_32x32x16_bf16 v[92:107], a[144:147], v[220:223], v[92:107]
    v_mfma_f32_32x32x16_bf16 v[108:123], a[160:163], v[220:223], v[108:123]
    v_mfma_f32_32x32x16_bf16 v[124:139], a[176:179], v[220:223], v[124:139]
    v_mfma_f32_32x32x16_bf16 v[76:91], a[132:135], v[224:227], v[76:91]
    v_mfma_f32_32x32x16_bf16 v[92:107], a[148:151], v[224:227], v[92:107]
    v_mfma_f32_32x32x16_bf16 v[108:123], a[164:167], v[224:227], v[108:123]
    v_mfma_f32_32x32x16_bf16 v[124:139], a[180:183], v[224:227], v[124:139]
    v_mfma_f32_32x32x16_bf16 v[76:91], a[136:139], v[228:231], v[76:91]
    v_mfma_f32_32x32x16_bf16 v[92:107], a[152:155], v[228:231], v[92:107]
    v_mfma_f32_32x32x16_bf16 v[108:123], a[168:171], v[228:231], v[108:123]
    v_mfma_f32_32x32x16_bf16 v[124:139], a[184:187], v[228:231], v[124:139]
    v_mfma_f32_32x32x16_bf16 v[76:91], a[140:143], v[232:235], v[76:91]
    v_mfma_f32_32x32x16_bf16 v[92:107], a[156:159], v[232:235], v[92:107]
    v_mfma_f32_32x32x16_bf16 v[108:123], a[172:175], v[232:235], v[108:123]
    v_mfma_f32_32x32x16_bf16 v[124:139], a[188:191], v[232:235], v[124:139]
    s_branch attna_kernel_next
attna_kernel_skipL:
    s_waitcnt lgkmcnt(3)
    v_mfma_f32_32x32x16_bf16 v[172:187], a[64:67], a[32:35], 0
    ds_read_b128 a[80:83], v7 offset:4096
    ds_read_b128 a[84:87], v7 offset:5120
    ds_read_b128 a[88:91], v7 offset:6144
    s_waitcnt lgkmcnt(5)
    v_mfma_f32_32x32x16_bf16 v[172:187], a[68:71], a[36:39], v[172:187]
    ds_read_b128 a[92:95], v7 offset:7168
    ds_read_b128 a[96:99], v7 offset:8192
    ds_read_b128 a[100:103], v7 offset:9216
    s_waitcnt lgkmcnt(7)
    v_mfma_f32_32x32x16_bf16 v[172:187], a[72:75], a[40:43], v[172:187]
    ds_read_b128 a[104:107], v7 offset:10240
    ds_read_b128 a[108:111], v7 offset:11264
    ds_read_b128 a[112:115], v7 offset:12288
    s_waitcnt lgkmcnt(9)
    v_mfma_f32_32x32x16_bf16 v[172:187], a[76:79], a[44:47], v[172:187]
    ds_read_b128 a[116:119], v7 offset:13312
    ds_read_b128 a[120:123], v7 offset:14336
    ds_read_b128 a[124:127], v7 offset:15360
    s_waitcnt lgkmcnt(11)
    v_mfma_f32_32x32x16_bf16 v[172:187], a[80:83], a[48:51], v[172:187]
    ds_read_b128 a[128:131], v8 offset:0
    ds_read_b128 a[132:135], v8 offset:1024
    ds_read_b128 a[136:139], v8 offset:2048
    s_waitcnt lgkmcnt(13)
    v_mfma_f32_32x32x16_bf16 v[172:187], a[84:87], a[52:55], v[172:187]
    ds_read_b128 a[140:143], v8 offset:3072
    ds_read_b128 a[144:147], v8 offset:4096
    ds_read_b128 a[148:151], v8 offset:5120
    s_waitcnt lgkmcnt(11)
    v_mfma_f32_32x32x16_bf16 v[172:187], a[88:91], a[56:59], v[172:187]
    ds_read_b128 a[152:155], v8 offset:6144
    ds_read_b128 a[156:159], v8 offset:7168
    ds_read_b128 a[160:163], v8 offset:8192
    v_mfma_f32_32x32x16_bf16 v[172:187], a[92:95], a[60:63], v[172:187]
    ds_read_b128 a[164:167], v8 offset:9216
    s_waitcnt lgkmcnt(11)
    ds_read_b128 a[168:171], v8 offset:10240
    v_mfma_f32_32x32x16_bf16 v[188:203], a[96:99], a[32:35], 0
    ds_read_b128 a[172:175], v8 offset:11264
    ds_read_b128 a[176:179], v8 offset:12288
    v_mfma_f32_32x32x16_bf16 v[188:203], a[100:103], a[36:39], v[188:203]
    ds_read_b128 a[180:183], v8 offset:13312
    s_waitcnt lgkmcnt(11)
    ds_read_b128 a[184:187], v8 offset:14336
    v_mfma_f32_32x32x16_bf16 v[188:203], a[104:107], a[40:43], v[188:203]
    ds_read_b128 a[188:191], v8 offset:15360
    s_cmp_eq_u32 s43, 0
    s_cbranch_scc1 attna_kernel_nd13
    s_add_u32 s35, s37, 0x0
    s_add_u32 s36, s40, s39
    s_add_u32 m0, s36, 0x0
    buffer_load_dwordx4 v6, s[16:19], s35 offen lds
attna_kernel_nd13:
    v_mfma_f32_32x32x16_bf16 v[188:203], a[108:111], a[44:47], v[188:203]
    s_cmp_eq_u32 s43, 0
    s_cbranch_scc1 attna_kernel_nd14
    s_add_u32 s35, s37, 0x400
    s_add_u32 s36, s40, s39
    s_add_u32 m0, s36, 0x400
    buffer_load_dwordx4 v6, s[16:19], s35 offen lds
attna_kernel_nd14:
    s_cmp_eq_u32 s43, 0
    s_cbranch_scc1 attna_kernel_nd15
    s_add_u32 s35, s37, 0x800
    s_add_u32 s36, s40, s39
    s_add_u32 m0, s36, 0x800
    buffer_load_dwordx4 v6, s[16:19], s35 offen lds
attna_kernel_nd15:
    v_mfma_f32_32x32x16_bf16 v[188:203], a[112:115], a[48:51], v[188:203]
    s_cmp_eq_u32 s43, 0
    s_cbranch_scc1 attna_kernel_nd16
    s_add_u32 s35, s37, 0xc00
    s_add_u32 s36, s40, s39
    s_add_u32 m0, s36, 0xc00
    buffer_load_dwordx4 v6, s[16:19], s35 offen lds
attna_kernel_nd16:
    s_cmp_eq_u32 s43, 0
    s_cbranch_scc1 attna_kernel_nd17
    s_add_u32 s35, s38, 0x0
    s_add_u32 s36, s41, s39
    s_add_u32 m0, s36, 0x0
    buffer_load_dwordx4 v6, s[20:23], s35 offen lds
attna_kernel_nd17:
    v_mfma_f32_32x32x16_bf16 v[188:203], a[116:119], a[52:55], v[188:203]
    s_cmp_eq_u32 s43, 0
    s_cbranch_scc1 attna_kernel_nd18
    s_add_u32 s35, s38, 0x400
    s_add_u32 s36, s41, s39
    s_add_u32 m0, s36, 0x400
    buffer_load_dwordx4 v6, s[20:23], s35 offen lds
attna_kernel_nd18:
    s_cmp_eq_u32 s43, 0
    s_cbranch_scc1 attna_kernel_nd19
    s_add_u32 s35, s38, 0x800
    s_add_u32 s36, s41, s39
    s_add_u32 m0, s36, 0x800
    buffer_load_dwordx4 v6, s[20:23], s35 offen lds
attna_kernel_nd19:
    v_mfma_f32_32x32x16_bf16 v[188:203], a[120:123], a[56:59], v[188:203]
    s_cmp_eq_u32 s43, 0
    s_cbranch_scc1 attna_kernel_nd20
    s_add_u32 s35, s38, 0xc00
    s_add_u32 s36, s41, s39
    s_add_u32 m0, s36, 0xc00
    buffer_load_dwordx4 v6, s[20:23], s35 offen lds
attna_kernel_nd20:
    s_add_u32 s37, s37, 16384
    s_add_u32 s38, s38, 4096
    v_xor_b32 v7, 32768, v7
    v_xor_b32 v8, 32768, v8
    v_mfma_f32_32x32x16_bf16 v[188:203], a[124:127], a[60:63], v[188:203]
    s_nop 7
    s_nop 3
    s_lshl_b32 s35, s34, 1
    s_add_u32 s35, s35, 1
    s_cmp_lt_u32 s35, s31
    s_cbranch_scc1 attna_kernel_nm21
    s_lshl_b32 s35, s31, 5
    s_lshl_b32 s36, s34, 6
    s_sub_u32 s35, s35, s36
    v_add_u32 v244, s35, v9
    v_cmp_gt_i32 vcc, 0, v244
    s_nop 1
    v_cndmask_b32 v172, v172, v245, vcc
    v_cmp_gt_i32 vcc, 1, v244
    s_nop 1
    v_cndmask_b32 v173, v173, v245, vcc
    v_cmp_gt_i32 vcc, 2, v244
    s_nop 1
    v_cndmask_b32 v174, v174, v245, vcc
    v_cmp_gt_i32 vcc, 3, v244
    s_nop 1
    v_cndmask_b32 v175, v175, v245, vcc
    v_cmp_gt_i32 vcc, 4, v244
    s_nop 1
    v_cndmask_b32 v176, v176, v245, vcc
    v_cmp_gt_i32 vcc, 5, v244
    s_nop 1
    v_cndmask_b32 v177, v177, v245, vcc
    v_cmp_gt_i32 vcc, 6, v244
    s_nop 1
    v_cndmask_b32 v178, v178, v245, vcc
    v_cmp_gt_i32 vcc, 7, v244
    s_nop 1
    v_cndmask_b32 v179, v179, v245, vcc
    v_cmp_gt_i32 vcc, 16, v244
    s_nop 1
    v_cndmask_b32 v180, v180, v245, vcc
    v_cmp_gt_i32 vcc, 17, v244
    s_nop 1
    v_cndmask_b32 v181, v181, v245, vcc
    v_cmp_gt_i32 vcc, 18, v244
    s_nop 1
    v_cndmask_b32 v182, v182, v245, vcc
    v_cmp_gt_i32 vcc, 19, v244
    s_nop 1
    v_cndmask_b32 v183, v183, v245, vcc
    v_cmp_gt_i32 vcc, 20, v244
    s_nop 1
    v_cndmask_b32 v184, v184, v245, vcc
    v_cmp_gt_i32 vcc, 21, v244
    s_nop 1
    v_cndmask_b32 v185, v185, v245, vcc
    v_cmp_gt_i32 vcc, 22, v244
    s_nop 1
    v_cndmask_b32 v186, v186, v245, vcc
    v_cmp_gt_i32 vcc, 23, v244
    s_nop 1
    v_cndmask_b32 v187, v187, v245, vcc
    v_cmp_gt_i32 vcc, 32, v244
    s_nop 1
    v_cndmask_b32 v188, v188, v245, vcc
    v_cmp_gt_i32 vcc, 33, v244
    s_nop 1
    v_cndmask_b32 v189, v189, v245, vcc
    v_cmp_gt_i32 vcc, 34, v244
    s_nop 1
    v_cndmask_b32 v190, v190, v245, vcc
    v_cmp_gt_i32 vcc, 35, v244
    s_nop 1
    v_cndmask_b32 v191, v191, v245, vcc
    v_cmp_gt_i32 vcc, 36, v244
    s_nop 1
    v_cndmask_b32 v192, v192, v245, vcc
    v_cmp_gt_i32 vcc, 37, v244
    s_nop 1
    v_cndmask_b32 v193, v193, v245, vcc
    v_cmp_gt_i32 vcc, 38, v244
    s_nop 1
    v_cndmask_b32 v194, v194, v245, vcc
    v_cmp_gt_i32 vcc, 39, v244
    s_nop 1
    v_cndmask_b32 v195, v195, v245, vcc
    v_cmp_gt_i32 vcc, 48, v244
    s_nop 1
    v_cndmask_b32 v196, v196, v245, vcc
    v_cmp_gt_i32 vcc, 49, v244
    s_nop 1
    v_cndmask_b32 v197, v197, v245, vcc
    v_cmp_gt_i32 vcc, 50, v244
    s_nop 1
    v_cndmask_b32 v198, v198, v245, vcc
    v_cmp_gt_i32 vcc, 51, v244
    s_nop 1
    v_cndmask_b32 v199, v199, v245, vcc
    v_cmp_gt_i32 vcc, 52, v244
    s_nop 1
    v_cndmask_b32 v200, v200, v245, vcc
    v_cmp_gt_i32 vcc, 53, v244
    s_nop 1
    v_cndmask_b32 v201, v201, v245, vcc
    v_cmp_gt_i32 vcc, 54, v244
    s_nop 1
    v_cndmask_b32 v202, v202, v245, vcc
    v_cmp_gt_i32 vcc, 55, v244
    s_nop 1
    v_cndmask_b32 v203, v203, v245, vcc
attna_kernel_nm21:
    v_max3_f32 v240, v172, v173, v174
    v_max3_f32 v241, v180, v181, v182
    v_max3_f32 v242, v188, v189, v190
    v_max3_f32 v244, v196, v197, v198
    v_max3_f32 v240, v240, v175, v176
    v_max3_f32 v241, v241, v183, v184
    v_max3_f32 v242, v242, v191, v192
    v_max3_f32 v244, v244, v199, v200
    v_max3_f32 v240, v240, v177, v178
    v_max3_f32 v241, v241, v185, v186
    v_max3_f32 v242, v242, v193, v194
    v_max3_f32 v244, v244, v201, v202
    v_max_f32 v240, v240, v179
    v_max_f32 v241, v241, v187
    v_max_f32 v242, v242, v195
    v_max_f32 v244, v244, v203
    v_max3_f32 v240, v240, v241, v242
    v_max_f32 v240, v240, v244
    v_mov_b32 v241, v240
    s_nop 1
    v_permlane32_swap_b32 v240, v241
    v_max_f32 v240, v240, v241
    v_sub_f32 v241, v240, v237
    v_cmp_lt_f32 vcc, s42, v241
    s_nop 1
    s_cbranch_vccz attna_kernel_nr22
    v_max_f32 v240, v240, v237
    v_sub_f32 v242, v237, v240
    v_mul_f32 v242, s28, v242
    v_exp_f32 v242, v242
    v_mov_b32 v237, v240
    v_mul_f32 v239, v239, v242
    v_mul_f32 v76, v76, v242
    v_mul_f32 v77, v77, v242
    v_mul_f32 v78, v78, v242
    v_mul_f32 v79, v79, v242
    v_mul_f32 v80, v80, v242
    v_mul_f32 v81, v81, v242
    v_mul_f32 v82, v82, v242
    v_mul_f32 v83, v83, v242
    v_mul_f32 v84, v84, v242
    v_mul_f32 v85, v85, v242
    v_mul_f32 v86, v86, v242
    v_mul_f32 v87, v87, v242
    v_mul_f32 v88, v88, v242
    v_mul_f32 v89, v89, v242
    v_mul_f32 v90, v90, v242
    v_mul_f32 v91, v91, v242
    v_mul_f32 v92, v92, v242
    v_mul_f32 v93, v93, v242
    v_mul_f32 v94, v94, v242
    v_mul_f32 v95, v95, v242
    v_mul_f32 v96, v96, v242
    v_mul_f32 v97, v97, v242
    v_mul_f32 v98, v98, v242
    v_mul_f32 v99, v99, v242
    v_mul_f32 v100, v100, v242
    v_mul_f32 v101, v101, v242
    v_mul_f32 v102, v102, v242
    v_mul_f32 v103, v103, v242
    v_mul_f32 v104, v104, v242
    v_mul_f32 v105, v105, v242
    v_mul_f32 v106, v106, v242
    v_mul_f32 v107, v107, v242
    v_mul_f32 v108, v108, v242
    v_mul_f32 v109, v109, v242
    v_mul_f32 v110, v110, v242
    v_mul_f32 v111, v111, v242
    v_mul_f32 v112, v112, v242
    v_mul_f32 v113, v113, v242
    v_mul_f32 v114, v114, v242
    v_mul_f32 v115, v115, v242
    v_mul_f32 v116, v116, v242
    v_mul_f32 v117, v117, v242
    v_mul_f32 v118, v118, v242
    v_mul_f32 v119, v119, v242
    v_mul_f32 v120, v120, v242
    v_mul_f32 v121, v121, v242
    v_mul_f32 v122, v122, v242
    v_mul_f32 v123, v123, v242
    v_mul_f32 v124, v124, v242
    v_mul_f32 v125, v125, v242
    v_mul_f32 v126, v126, v242
    v_mul_f32 v127, v127, v242
    v_mul_f32 v128, v128, v242
    v_mul_f32 v129, v129, v242
    v_mul_f32 v130, v130, v242
    v_mul_f32 v131, v131, v242
    v_mul_f32 v132, v132, v242
    v_mul_f32 v133, v133, v242
    v_mul_f32 v134, v134, v242
    v_mul_f32 v135, v135, v242
    v_mul_f32 v136, v136, v242
    v_mul_f32 v137, v137, v242
    v_mul_f32 v138, v138, v242
    v_mul_f32 v139, v139, v242
attna_kernel_nr22:
    v_mul_f32 v243, s29, v237
    v_fma_f32 v172, v172, s28, v243
    v_fma_f32 v173, v173, s28, v243
    v_fma_f32 v174, v174, s28, v243
    v_fma_f32 v175, v175, s28, v243
    v_fma_f32 v176, v176, s28, v243
    v_fma_f32 v177, v177, s28, v243
    v_fma_f32 v178, v178, s28, v243
    v_fma_f32 v179, v179, s28, v243
    v_exp_f32 v172, v172
    v_exp_f32 v173, v173
    v_exp_f32 v174, v174
    v_exp_f32 v175, v175
    v_exp_f32 v176, v176
    v_exp_f32 v177, v177
    v_exp_f32 v178, v178
    v_exp_f32 v179, v179
    v_fma_f32 v180, v180, s28, v243
    v_fma_f32 v181, v181, s28, v243
    v_fma_f32 v182, v182, s28, v243
    v_fma_f32 v183, v183, s28, v243
    v_fma_f32 v184, v184, s28, v243
    v_fma_f32 v185, v185, s28, v243
    v_fma_f32 v186, v186, s28, v243
    v_fma_f32 v187, v187, s28, v243
    v_exp_f32 v180, v180
    v_exp_f32 v181, v181
    v_exp_f32 v182, v182
    v_exp_f32 v183, v183
    v_exp_f32 v184, v184
    v_exp_f32 v185, v185
    v_exp_f32 v186, v186
    v_exp_f32 v187, v187
    v_fma_f32 v188, v188, s28, v243
    v_fma_f32 v189, v189, s28, v243
    v_fma_f32 v190, v190, s28, v243
    v_fma_f32 v191, v191, s28, v243
    v_fma_f32 v192, v192, s28, v243
    v_fma_f32 v193, v193, s28, v243
    v_fma_f32 v194, v194, s28, v243
    v_fma_f32 v195, v195, s28, v243
    v_exp_f32 v188, v188
    v_exp_f32 v189, v189
    v_exp_f32 v190, v190
    v_exp_f32 v191, v191
    v_exp_f32 v192, v192
    v_exp_f32 v193, v193
    v_exp_f32 v194, v194
    v_exp_f32 v195, v195
    v_fma_f32 v196, v196, s28, v243
    v_fma_f32 v197, v197, s28, v243
    v_fma_f32 v198, v198, s28, v243
    v_fma_f32 v199, v199, s28, v243
    v_fma_f32 v200, v200, s28, v243
    v_fma_f32 v201, v201, s28, v243
    v_fma_f32 v202, v202, s28, v243
    v_fma_f32 v203, v203, s28, v243
    v_exp_f32 v196, v196
    v_exp_f32 v197, v197
    v_exp_f32 v198, v198
    v_exp_f32 v199, v199
    v_exp_f32 v200, v200
    v_exp_f32 v201, v201
    v_exp_f32 v202, v202
    v_exp_f32 v203, v203
    v_add_f32 v240, v172, v176
    v_add_f32 v241, v173, v177
    v_add_f32 v242, v174, v178
    v_add_f32 v244, v175, v179
    v_add_f32 v240, v240, v180
    v_add_f32 v241, v241, v181
    v_add_f32 v242, v242, v182
    v_add_f32 v244, v244, v183
    v_add_f32 v240, v240, v184
    v_add_f32 v241, v241, v185
    v_add_f32 v242, v242, v186
    v_add_f32 v244, v244, v187
    v_add_f32 v240, v240, v188
    v_add_f32 v241, v241, v189
    v_add_f32 v242, v242, v190
    v_add_f32 v244, v244, v191
    v_add_f32 v240, v240, v192
    v_add_f32 v241, v241, v193
    v_add_f32 v242, v242, v194
    v_add_f32 v244, v244, v195
    v_add_f32 v240, v240, v196
    v_add_f32 v241, v241, v197
    v_add_f32 v242, v242, v198
    v_add_f32 v244, v244, v199
    v_add_f32 v240, v240, v200
    v_add_f32 v241, v241, v201
    v_add_f32 v242, v242, v202
    v_add_f32 v244, v244, v203
    v_add_f32 v240, v240, v241
    v_add_f32 v242, v242, v244
    v_add_f32 v239, v239, v240
    v_add_f32 v239, v239, v242
    v_cvt_pk_bf16_f32 v220, v172, v173
    v_cvt_pk_bf16_f32 v221, v174, v175
    v_cvt_pk_bf16_f32 v222, v176, v177
    v_cvt_pk_bf16_f32 v223, v178, v179
    v_cvt_pk_bf16_f32 v224, v180, v181
    v_cvt_pk_bf16_f32 v225, v182, v183
    v_cvt_pk_bf16_f32 v226, v184, v185
    v_cvt_pk_bf16_f32 v227, v186, v187
    v_cvt_pk_bf16_f32 v228, v188, v189
    v_cvt_pk_bf16_f32 v229, v190, v191
    v_cvt_pk_bf16_f32 v230, v192, v193
    v_cvt_pk_bf16_f32 v231, v194, v195
    v_cvt_pk_bf16_f32 v232, v196, v197
    v_cvt_pk_bf16_f32 v233, v198, v199
    v_cvt_pk_bf16_f32 v234, v200, v201
    v_cvt_pk_bf16_f32 v235, v202, v203
    s_nop 1
    v_mfma_f32_32x32x16_bf16 v[76:91], a[128:131], v[220:223], v[76:91]
    s_waitcnt lgkmcnt(11)
    v_mfma_f32_32x32x16_bf16 v[92:107], a[144:147], v[220:223], v[92:107]
    s_waitcnt lgkmcnt(7)
    v_mfma_f32_32x32x16_bf16 v[108:123], a[160:163], v[220:223], v[108:123]
    s_waitcnt lgkmcnt(3)
    v_mfma_f32_32x32x16_bf16 v[124:139], a[176:179], v[220:223], v[124:139]
    v_mfma_f32_32x32x16_bf16 v[76:91], a[132:135], v[224:227], v[76:91]
    v_mfma_f32_32x32x16_bf16 v[92:107], a[148:151], v[224:227], v[92:107]
    v_mfma_f32_32x32x16_bf16 v[108:123], a[164:167], v[224:227], v[108:123]
    s_waitcnt lgkmcnt(2)
    v_mfma_f32_32x32x16_bf16 v[124:139], a[180:183], v[224:227], v[124:139]
    v_mfma_f32_32x32x16_bf16 v[76:91], a[136:139], v[228:231], v[76:91]
    v_mfma_f32_32x32x16_bf16 v[92:107], a[152:155], v[228:231], v[92:107]
    v_mfma_f32_32x32x16_bf16 v[108:123], a[168:171], v[228:231], v[108:123]
    s_waitcnt lgkmcnt(1)
    v_mfma_f32_32x32x16_bf16 v[124:139], a[184:187], v[228:231], v[124:139]
    v_mfma_f32_32x32x16_bf16 v[76:91], a[140:143], v[232:235], v[76:91]
    v_mfma_f32_32x32x16_bf16 v[92:107], a[156:159], v[232:235], v[92:107]
    v_mfma_f32_32x32x16_bf16 v[108:123], a[172:175], v[232:235], v[108:123]
    s_waitcnt lgkmcnt(0)
    v_mfma_f32_32x32x16_bf16 v[124:139], a[188:191], v[232:235], v[124:139]
attna_kernel_next:
    s_add_u32 s34, s34, 1
    s_cmp_lt_u32 s34, s33
    s_cbranch_scc1 attna_kernel_loop
    s_nop 7
    s_nop 7
    v_mov_b32 v240, v238
    s_nop 1
    v_permlane32_swap_b32 v238, v240
    v_add_f32 v240, v240, v238
    v_rcp_f32 v240, v240
    s_nop 0
    v_mul_f32 v12, v12, v240
    v_mul_f32 v13, v13, v240
    v_mul_f32 v14, v14, v240
    v_mul_f32 v15, v15, v240
    v_mul_f32 v16, v16, v240
    v_mul_f32 v17, v17, v240
    v_mul_f32 v18, v18, v240
    v_mul_f32 v19, v19, v240
    v_mul_f32 v20, v20, v240
    v_mul_f32 v21, v21, v240
    v_mul_f32 v22, v22, v240
    v_mul_f32 v23, v23, v240
    v_mul_f32 v24, v24, v240
    v_mul_f32 v25, v25, v240
    v_mul_f32 v26, v26, v240
    v_mul_f32 v27, v27, v240
    v_mul_f32 v28, v28, v240
    v_mul_f32 v29, v29, v240
    v_mul_f32 v30, v30, v240
    v_mul_f32 v31, v31, v240
    v_mul_f32 v32, v32, v240
    v_mul_f32 v33, v33, v240
    v_mul_f32 v34, v34, v240
    v_mul_f32 v35, v35, v240
    v_mul_f32 v36, v36, v240
    v_mul_f32 v37, v37, v240
    v_mul_f32 v38, v38, v240
    v_mul_f32 v39, v39, v240
    v_mul_f32 v40, v40, v240
    v_mul_f32 v41, v41, v240
    v_mul_f32 v42, v42, v240
    v_mul_f32 v43, v43, v240
    v_mul_f32 v44, v44, v240
    v_mul_f32 v45, v45, v240
    v_mul_f32 v46, v46, v240
    v_mul_f32 v47, v47, v240
    v_mul_f32 v48, v48, v240
    v_mul_f32 v49, v49, v240
    v_mul_f32 v50, v50, v240
    v_mul_f32 v51, v51, v240
    v_mul_f32 v52, v52, v240
    v_mul_f32 v53, v53, v240
    v_mul_f32 v54, v54, v240
    v_mul_f32 v55, v55, v240
    v_mul_f32 v56, v56, v240
    v_mul_f32 v57, v57, v240
    v_mul_f32 v58, v58, v240
    v_mul_f32 v59, v59, v240
    v_mul_f32 v60, v60, v240
    v_mul_f32 v61, v61, v240
    v_mul_f32 v62, v62, v240
    v_mul_f32 v63, v63, v240
    v_mul_f32 v64, v64, v240
    v_mul_f32 v65, v65, v240
    v_mul_f32 v66, v66, v240
    v_mul_f32 v67, v67, v240
    v_mul_f32 v68, v68, v240
    v_mul_f32 v69, v69, v240
    v_mul_f32 v70, v70, v240
    v_mul_f32 v71, v71, v240
    v_mul_f32 v72, v72, v240
    v_mul_f32 v73, v73, v240
    v_mul_f32 v74, v74, v240
    v_mul_f32 v75, v75, v240
    s_lshl_b32 s35, s30, 8
    s_lshl_b32 s36, s6, 3
    s_add_u32 s35, s35, s36
    s_lshl_b32 s35, s35, 10
    v_cvt_pk_bf16_f32 v248, v12, v13
    v_cvt_pk_bf16_f32 v249, v14, v15
    v_cvt_pk_bf16_f32 v250, v16, v17
    v_cvt_pk_bf16_f32 v251, v18, v19
    s_nop 1
    v_permlane32_swap_b32 v248, v250
    v_permlane32_swap_b32 v249, v251
    buffer_store_dwordx4 v[248:251], v6, s[24:27], s35 offen offset:0
    s_nop 1
    v_cvt_pk_bf16_f32 v248, v20, v21
    v_cvt_pk_bf16_f32 v249, v22, v23
    v_cvt_pk_bf16_f32 v250, v24, v25
    v_cvt_pk_bf16_f32 v251, v26, v27
    s_nop 1
    v_permlane32_swap_b32 v248, v250
    v_permlane32_swap_b32 v249, v251
    buffer_store_dwordx4 v[248:251], v6, s[24:27], s35 offen offset:1024
    s_nop 1
    v_cvt_pk_bf16_f32 v248, v28, v29
    v_cvt_pk_bf16_f32 v249, v30, v31
    v_cvt_pk_bf16_f32 v250, v32, v33
    v_cvt_pk_bf16_f32 v251, v34, v35
    s_nop 1
    v_permlane32_swap_b32 v248, v250
    v_permlane32_swap_b32 v249, v251
    buffer_store_dwordx4 v[248:251], v6, s[24:27], s35 offen offset:2048
    s_nop 1
    v_cvt_pk_bf16_f32 v248, v36, v37
    v_cvt_pk_bf16_f32 v249, v38, v39
    v_cvt_pk_bf16_f32 v250, v40, v41
    v_cvt_pk_bf16_f32 v251, v42, v43
    s_nop 1
    v_permlane32_swap_b32 v248, v250
    v_permlane32_swap_b32 v249, v251
    buffer_store_dwordx4 v[248:251], v6, s[24:27], s35 offen offset:3072
    s_nop 1
    v_cvt_pk_bf16_f32 v248, v44, v45
    v_cvt_pk_bf16_f32 v249, v46, v47
    v_cvt_pk_bf16_f32 v250, v48, v49
    v_cvt_pk_bf16_f32 v251, v50, v51
    s_nop 1
    v_permlane32_swap_b32 v248, v250
    v_permlane32_swap_b32 v249, v251
    s_add_u32 s35, s35, 4096
    buffer_store_dwordx4 v[248:251], v6, s[24:27], s35 offen offset:0
    s_nop 1
    v_cvt_pk_bf16_f32 v248, v52, v53
    v_cvt_pk_bf16_f32 v249, v54, v55
    v_cvt_pk_bf16_f32 v250, v56, v57
    v_cvt_pk_bf16_f32 v251, v58, v59
    s_nop 1
    v_permlane32_swap_b32 v248, v250
    v_permlane32_swap_b32 v249, v251
    buffer_store_dwordx4 v[248:251], v6, s[24:27], s35 offen offset:1024
    s_nop 1
    v_cvt_pk_bf16_f32 v248, v60, v61
    v_cvt_pk_bf16_f32 v249, v62, v63
    v_cvt_pk_bf16_f32 v250, v64, v65
    v_cvt_pk_bf16_f32 v251, v66, v67
    s_nop 1
    v_permlane32_swap_b32 v248, v250
    v_permlane32_swap_b32 v249, v251
    buffer_store_dwordx4 v[248:251], v6, s[24:27], s35 offen offset:2048
    s_nop 1
    v_cvt_pk_bf16_f32 v248, v68, v69
    v_cvt_pk_bf16_f32 v249, v70, v71
    v_cvt_pk_bf16_f32 v250, v72, v73
    v_cvt_pk_bf16_f32 v251, v74, v75
    s_nop 1
    v_permlane32_swap_b32 v248, v250
    v_permlane32_swap_b32 v249, v251
    buffer_store_dwordx4 v[248:251], v6, s[24:27], s35 offen offset:3072
    s_nop 1
    v_mov_b32 v240, v239
    s_nop 1
    v_permlane32_swap_b32 v239, v240
    v_add_f32 v240, v240, v239
    v_rcp_f32 v240, v240
    s_nop 0
    v_mul_f32 v76, v76, v240
    v_mul_f32 v77, v77, v240
    v_mul_f32 v78, v78, v240
    v_mul_f32 v79, v79, v240
    v_mul_f32 v80, v80, v240
    v_mul_f32 v81, v81, v240
    v_mul_f32 v82, v82, v240
    v_mul_f32 v83, v83, v240
    v_mul_f32 v84, v84, v240
    v_mul_f32 v85, v85, v240
    v_mul_f32 v86, v86, v240
    v_mul_f32 v87, v87, v240
    v_mul_f32 v88, v88, v240
    v_mul_f32 v89, v89, v240
    v_mul_f32 v90, v90, v240
    v_mul_f32 v91, v91, v240
    v_mul_f32 v92, v92, v240
    v_mul_f32 v93, v93, v240
    v_mul_f32 v94, v94, v240
    v_mul_f32 v95, v95, v240
    v_mul_f32 v96, v96, v240
    v_mul_f32 v97, v97, v240
    v_mul_f32 v98, v98, v240
    v_mul_f32 v99, v99, v240
    v_mul_f32 v100, v100, v240
    v_mul_f32 v101, v101, v240
    v_mul_f32 v102, v102, v240
    v_mul_f32 v103, v103, v240
    v_mul_f32 v104, v104, v240
    v_mul_f32 v105, v105, v240
    v_mul_f32 v106, v106, v240
    v_mul_f32 v107, v107, v240
    v_mul_f32 v108, v108, v240
    v_mul_f32 v109, v109, v240
    v_mul_f32 v110, v110, v240
    v_mul_f32 v111, v111, v240
    v_mul_f32 v112, v112, v240
    v_mul_f32 v113, v113, v240
    v_mul_f32 v114, v114, v240
    v_mul_f32 v115, v115, v240
    v_mul_f32 v116, v116, v240
    v_mul_f32 v117, v117, v240
    v_mul_f32 v118, v118, v240
    v_mul_f32 v119, v119, v240
    v_mul_f32 v120, v120, v240
    v_mul_f32 v121, v121, v240
    v_mul_f32 v122, v122, v240
    v_mul_f32 v123, v123, v240
    v_mul_f32 v124, v124, v240
    v_mul_f32 v125, v125, v240
    v_mul_f32 v126, v126, v240
    v_mul_f32 v127, v127, v240
    v_mul_f32 v128, v128, v240
    v_mul_f32 v129, v129, v240
    v_mul_f32 v130, v130, v240
    v_mul_f32 v131, v131, v240
    v_mul_f32 v132, v132, v240
    v_mul_f32 v133, v133, v240
    v_mul_f32 v134, v134, v240
    v_mul_f32 v135, v135, v240
    v_mul_f32 v136, v136, v240
    v_mul_f32 v137, v137, v240
    v_mul_f32 v138, v138, v240
    v_mul_f32 v139, v139, v240
    s_lshl_b32 s35, s31, 8
    s_lshl_b32 s36, s6, 3
    s_add_u32 s35, s35, s36
    s_lshl_b32 s35, s35, 10
    v_cvt_pk_bf16_f32 v248, v76, v77
    v_cvt_pk_bf16_f32 v249, v78, v79
    v_cvt_pk_bf16_f32 v250, v80, v81
    v_cvt_pk_bf16_f32 v251, v82, v83
    s_nop 1
    v_permlane32_swap_b32 v248, v250
    v_permlane32_swap_b32 v249, v251
    buffer_store_dwordx4 v[248:251], v6, s[24:27], s35 offen offset:0
    s_nop 1
    v_cvt_pk_bf16_f32 v248, v84, v85
    v_cvt_pk_bf16_f32 v249, v86, v87
    v_cvt_pk_bf16_f32 v250, v88, v89
    v_cvt_pk_bf16_f32 v251, v90, v91
    s_nop 1
    v_permlane32_swap_b32 v248, v250
    v_permlane32_swap_b32 v249, v251
    buffer_store_dwordx4 v[248:251], v6, s[24:27], s35 offen offset:1024
    s_nop 1
    v_cvt_pk_bf16_f32 v248, v92, v93
    v_cvt_pk_bf16_f32 v249, v94, v95
    v_cvt_pk_bf16_f32 v250, v96, v97
    v_cvt_pk_bf16_f32 v251, v98, v99
    s_nop 1
    v_permlane32_swap_b32 v248, v250
    v_permlane32_swap_b32 v249, v251
    buffer_store_dwordx4 v[248:251], v6, s[24:27], s35 offen offset:2048
    s_nop 1
    v_cvt_pk_bf16_f32 v248, v100, v101
    v_cvt_pk_bf16_f32 v249, v102, v103
    v_cvt_pk_bf16_f32 v250, v104, v105
    v_cvt_pk_bf16_f32 v251, v106, v107
    s_nop 1
    v_permlane32_swap_b32 v248, v250
    v_permlane32_swap_b32 v249, v251
    buffer_store_dwordx4 v[248:251], v6, s[24:27], s35 offen offset:3072
    s_nop 1
    v_cvt_pk_bf16_f32 v248, v108, v109
    v_cvt_pk_bf16_f32 v249, v110, v111
    v_cvt_pk_bf16_f32 v250, v112, v113
    v_cvt_pk_bf16_f32 v251, v114, v115
    s_nop 1
    v_permlane32_swap_b32 v248, v250
    v_permlane32_swap_b32 v249, v251
    s_add_u32 s35, s35, 4096
    buffer_store_dwordx4 v[248:251], v6, s[24:27], s35 offen offset:0
    s_nop 1
    v_cvt_pk_bf16_f32 v248, v116, v117
    v_cvt_pk_bf16_f32 v249, v118, v119
    v_cvt_pk_bf16_f32 v250, v120, v121
    v_cvt_pk_bf16_f32 v251, v122, v123
    s_nop 1
    v_permlane32_swap_b32 v248, v250
    v_permlane32_swap_b32 v249, v251
    buffer_store_dwordx4 v[248:251], v6, s[24:27], s35 offen offset:1024
    s_nop 1
    v_cvt_pk_bf16_f32 v248, v124, v125
    v_cvt_pk_bf16_f32 v249, v126, v127
    v_cvt_pk_bf16_f32 v250, v128, v129
    v_cvt_pk_bf16_f32 v251, v130, v131
    s_nop 1
    v_permlane32_swap_b32 v248, v250
    v_permlane32_swap_b32 v249, v251
    buffer_store_dwordx4 v[248:251], v6, s[24:27], s35 offen offset:2048
    s_nop 1
    v_cvt_pk_bf16_f32 v248, v132, v133
    v_cvt_pk_bf16_f32 v249, v134, v135
    v_cvt_pk_bf16_f32 v250, v136, v137
    v_cvt_pk_bf16_f32 v251, v138, v139
    s_nop 1
    v_permlane32_swap_b32 v248, v250
    v_permlane32_swap_b32 v249, v251
    buffer_store_dwordx4 v[248:251], v6, s[24:27], s35 offen offset:3072
    s_nop 1
attna_kernel_end:
    s_endpgm

.globl attnb_kernel
.p2align 8
.type attnb_kernel,@function
attnb_kernel:
    s_cmp_ge_u32 s2, 256
    s_cbranch_scc1 attnb_kernel_end
    s_load_dwordx2 s[4:5], s[0:1], 112
    v_lshrrev_b32 v4, 6, v0
    v_and_b32 v1, 63, v0
    v_and_b32 v2, 31, v0
    v_lshrrev_b32 v3, 5, v1
    v_lshlrev_b32 v5, 4, v1
    s_nop 0
    v_readfirstlane_b32 s6, v4
    s_waitcnt lgkmcnt(0)
    s_add_u32 s12, s4, 0x4200000
    s_addc_u32 s13, s5, 0x0
    s_mov_b32 s14, 0x20000
    s_mov_b32 s15, 0x00020000
    s_add_u32 s16, s4, 0x4000000
    s_addc_u32 s17, s5, 0x0
    s_mov_b32 s18, 0x200000
    s_mov_b32 s19, 0x00020000
    s_add_u32 s20, s4, 0x4400000
    s_addc_u32 s21, s5, 0x0
    s_mov_b32 s22, 0x200000
    s_mov_b32 s23, 0x00020000
    s_lshl_b32 s9, s2, 3
    s_add_u32 s9, s9, s6
    s_and_b32 s7, s9, 31
    s_lshr_b32 s8, s9, 5
    s_lshl_b32 s10, s6, 14
    s_add_u32 s9, s10, 0x0
    s_mov_b32 m0, s9
    buffer_load_dwordx4 v5, s[12:15], s9 offen lds
    s_add_u32 s9, s10, 0x400
    s_mov_b32 m0, s9
    buffer_load_dwordx4 v5, s[12:15], s9 offen lds
    s_add_u32 s9, s10, 0x800
    s_mov_b32 m0, s9
    buffer_load_dwordx4 v5, s[12:15], s9 offen lds
    s_add_u32 s9, s10, 0xc00
    s_mov_b32 m0, s9
    buffer_load_dwordx4 v5, s[12:15], s9 offen lds
    s_add_u32 s9, s10, 0x1000
    s_mov_b32 m0, s9
    buffer_load_dwordx4 v5, s[12:15], s9 offen lds
    s_add_u32 s9, s10, 0x1400
    s_mov_b32 m0, s9
    buffer_load_dwordx4 v5, s[12:15], s9 offen lds
    s_add_u32 s9, s10, 0x1800
    s_mov_b32 m0, s9
    buffer_load_dwordx4 v5, s[12:15], s9 offen lds
    s_add_u32 s9, s10, 0x1c00
    s_mov_b32 m0, s9
    buffer_load_dwordx4 v5, s[12:15], s9 offen lds
    s_add_u32 s9, s10, 0x2000
    s_mov_b32 m0, s9
    buffer_load_dwordx4 v5, s[12:15], s9 offen lds
    s_add_u32 s9, s10, 0x2400
    s_mov_b32 m0, s9
    buffer_load_dwordx4 v5, s[12:15], s9 offen lds
    s_add_u32 s9, s10, 0x2800
    s_mov_b32 m0, s9
    buffer_load_dwordx4 v5, s[12:15], s9 offen lds
    s_add_u32 s9, s10, 0x2c00
    s_mov_b32 m0, s9
    buffer_load_dwordx4 v5, s[12:15], s9 offen lds
    s_add_u32 s9, s10, 0x3000
    s_mov_b32 m0, s9
    buffer_load_dwordx4 v5, s[12:15], s9 offen lds
    s_add_u32 s9, s10, 0x3400
    s_mov_b32 m0, s9
    buffer_load_dwordx4 v5, s[12:15], s9 offen lds
    s_add_u32 s9, s10, 0x3800
    s_mov_b32 m0, s9
    buffer_load_dwordx4 v5, s[12:15], s9 offen lds
    s_add_u32 s9, s10, 0x3c00
    s_mov_b32 m0, s9
    buffer_load_dwordx4 v5, s[12:15], s9 offen lds
    s_lshl_b32 s9, s7, 6
    s_add_u32 s9, s9, s8
    s_lshl_b32 s9, s9, 10
    buffer_load_dwordx4 v[8:11], v5, s[16:19], s9 offen
    s_mov_b32 s24, 0x3eb8aa3b
    s_mov_b32 s25, 0xbeb8aa3b
    v_lshlrev_b32 v12, 8, v3
    v_lshlrev_b32 v4, 4, v2
    v_add_u32 v12, v12, v4
    v_add_u32 v12, 65536, v12
    v_mov_b32 v13, v5
    v_cmp_eq_u32 vcc, 16, v2
    s_nop 1
    v_mov_b32 v64, 0x3f803f80
    v_cndmask_b32 v4, 0, v64, vcc
    v_mov_b32 v32, v4
    v_mov_b32 v33, v4
    v_mov_b32 v34, v4
    v_mov_b32 v35, v4
    v_mov_b32 v36, v4
    v_mov_b32 v37, v4
    v_mov_b32 v38, v4
    v_mov_b32 v39, v4
    v_mov_b32 v40, v4
    v_mov_b32 v41, v4
    v_mov_b32 v42, v4
    v_mov_b32 v43, v4
    v_mov_b32 v44, v4
    v_mov_b32 v45, v4
    v_mov_b32 v46, v4
    v_mov_b32 v47, v4
    v_mov_b32 v48, v4
    v_mov_b32 v49, v4
    v_mov_b32 v50, v4
    v_mov_b32 v51, v4
    v_mov_b32 v52, v4
    v_mov_b32 v53, v4
    v_mov_b32 v54, v4
    v_mov_b32 v55, v4
    v_mov_b32 v56, v4
    v_mov_b32 v57, v4
    v_mov_b32 v58, v4
    v_mov_b32 v59, v4
    v_mov_b32 v60, v4
    v_mov_b32 v61, v4
    v_mov_b32 v62, v4
    v_mov_b32 v63, v4
    s_mov_b32 s26, 0x0000ffff
    s_mov_b32 s27, 0x0000ffff
    v_mov_b32 v180, 0xff800000
    v_mov_b32 v164, 0
    v_mov_b32 v165, 0
    v_mov_b32 v166, 0
    v_mov_b32 v167, 0
    v_mov_b32 v168, 0
    v_mov_b32 v169, 0
    v_mov_b32 v170, 0
    v_mov_b32 v171, 0
    v_mov_b32 v172, 0
    v_mov_b32 v173, 0
    v_mov_b32 v174, 0
    v_mov_b32 v175, 0
    v_mov_b32 v176, 0
    v_mov_b32 v177, 0
    v_mov_b32 v178, 0
    v_mov_b32 v179, 0
    s_mov_b32 s28, 0
    s_waitcnt vmcnt(0)
    s_barrier
attnb_kernel_loop:
    ds_read_b128 v[16:19], v13 offset:0
    ds_read_b128 v[20:23], v13 offset:1024
    ds_read_b128 v[24:27], v13 offset:2048
    ds_read_b128 v[28:31], v13 offset:3072
    s_mov_b64 exec, s[26:27]
    ds_read_b128 v[32:35], v12 offset:0
    ds_read_b128 v[36:39], v12 offset:512
    ds_read_b128 v[40:43], v12 offset:1024
    ds_read_b128 v[44:47], v12 offset:1536
    ds_read_b128 v[48:51], v12 offset:2048
    ds_read_b128 v[52:55], v12 offset:2560
    ds_read_b128 v[56:59], v12 offset:3072
    ds_read_b128 v[60:63], v12 offset:3584
    s_mov_b64 exec, -1
    v_add_u32 v13, 4096, v13
    v_add_u32 v12, 4096, v12
    s_waitcnt lgkmcnt(8)
    v_mfma_f32_32x32x16_bf16 v[68:83], v[16:19], v[8:11], 0
    v_mfma_f32_32x32x16_bf16 v[84:99], v[20:23], v[8:11], 0
    v_mfma_f32_32x32x16_bf16 v[100:115], v[24:27], v[8:11], 0
    v_mfma_f32_32x32x16_bf16 v[116:131], v[28:31], v[8:11], 0
    s_nop 7
    s_nop 7
    v_max3_f32 v181, v68, v69, v70
    v_max3_f32 v181, v181, v71, v72
    v_max3_f32 v181, v181, v73, v74
    v_max3_f32 v181, v181, v75, v76
    v_max3_f32 v181, v181, v77, v78
    v_max3_f32 v181, v181, v79, v80
    v_max3_f32 v181, v181, v81, v82
    v_max3_f32 v181, v181, v83, v84
    v_max3_f32 v181, v181, v85, v86
    v_max3_f32 v181, v181, v87, v88
    v_max3_f32 v181, v181, v89, v90
    v_max3_f32 v181, v181, v91, v92
    v_max3_f32 v181, v181, v93, v94
    v_max3_f32 v181, v181, v95, v96
    v_max3_f32 v181, v181, v97, v98
    v_max3_f32 v181, v181, v99, v100
    v_max3_f32 v181, v181, v101, v102
    v_max3_f32 v181, v181, v103, v104
    v_max3_f32 v181, v181, v105, v106
    v_max3_f32 v181, v181, v107, v108
    v_max3_f32 v181, v181, v109, v110
    v_max3_f32 v181, v181, v111, v112
    v_max3_f32 v181, v181, v113, v114
    v_max3_f32 v181, v181, v115, v116
    v_max3_f32 v181, v181, v117, v118
    v_max3_f32 v181, v181, v119, v120
    v_max3_f32 v181, v181, v121, v122
    v_max3_f32 v181, v181, v123, v124
    v_max3_f32 v181, v181, v125, v126
    v_max3_f32 v181, v181, v127, v128
    v_max3_f32 v181, v181, v129, v130
    v_max_f32 v181, v181, v131
    v_mov_b32 v182, v181
    s_nop 1
    v_permlane32_swap_b32 v181, v182
    v_max_f32 v181, v181, v182
    v_max_f32 v181, v181, v180
    v_sub_f32 v183, v180, v181
    v_mul_f32 v183, s24, v183
    v_exp_f32 v183, v183
    v_mov_b32 v180, v181
    v_mul_f32 v184, s25, v181
    v_fma_f32 v68, v68, s24, v184
    v_fma_f32 v69, v69, s24, v184
    v_fma_f32 v70, v70, s24, v184
    v_fma_f32 v71, v71, s24, v184
    v_fma_f32 v72, v72, s24, v184
    v_fma_f32 v73, v73, s24, v184
    v_fma_f32 v74, v74, s24, v184
    v_fma_f32 v75, v75, s24, v184
    v_fma_f32 v76, v76, s24, v184
    v_fma_f32 v77, v77, s24, v184
    v_fma_f32 v78, v78, s24, v184
    v_fma_f32 v79, v79, s24, v184
    v_fma_f32 v80, v80, s24, v184
    v_fma_f32 v81, v81, s24, v184
    v_fma_f32 v82, v82, s24, v184
    v_fma_f32 v83, v83, s24, v184
    v_fma_f32 v84, v84, s24, v184
    v_fma_f32 v85, v85, s24, v184
    v_fma_f32 v86, v86, s24, v184
    v_fma_f32 v87, v87, s24, v184
    v_fma_f32 v88, v88, s24, v184
    v_fma_f32 v89, v89, s24, v184
    v_fma_f32 v90, v90, s24, v184
    v_fma_f32 v91, v91, s24, v184
    v_fma_f32 v92, v92, s24, v184
    v_fma_f32 v93, v93, s24, v184
    v_fma_f32 v94, v94, s24, v184
    v_fma_f32 v95, v95, s24, v184
    v_fma_f32 v96, v96, s24, v184
    v_fma_f32 v97, v97, s24, v184
    v_fma_f32 v98, v98, s24, v184
    v_fma_f32 v99, v99, s24, v184
    v_fma_f32 v100, v100, s24, v184
    v_fma_f32 v101, v101, s24, v184
    v_fma_f32 v102, v102, s24, v184
    v_fma_f32 v103, v103, s24, v184
    v_fma_f32 v104, v104, s24, v184
    v_fma_f32 v105, v105, s24, v184
    v_fma_f32 v106, v106, s24, v184
    v_fma_f32 v107, v107, s24, v184
    v_fma_f32 v108, v108, s24, v184
    v_fma_f32 v109, v109, s24, v184
    v_fma_f32 v110, v110, s24, v184
    v_fma_f32 v111, v111, s24, v184
    v_fma_f32 v112, v112, s24, v184
    v_fma_f32 v113, v113, s24, v184
    v_fma_f32 v114, v114, s24, v184
    v_fma_f32 v115, v115, s24, v184
    v_fma_f32 v116, v116, s24, v184
    v_fma_f32 v117, v117, s24, v184
    v_fma_f32 v118, v118, s24, v184
    v_fma_f32 v119, v119, s24, v184
    v_fma_f32 v120, v120, s24, v184
    v_fma_f32 v121, v121, s24, v184
    v_fma_f32 v122, v122, s24, v184
    v_fma_f32 v123, v123, s24, v184
    v_fma_f32 v124, v124, s24, v184
    v_fma_f32 v125, v125, s24, v184
    v_fma_f32 v126, v126, s24, v184
    v_fma_f32 v127, v127, s24, v184
    v_fma_f32 v128, v128, s24, v184
    v_fma_f32 v129, v129, s24, v184
    v_fma_f32 v130, v130, s24, v184
    v_fma_f32 v131, v131, s24, v184
    v_exp_f32 v68, v68
    v_exp_f32 v69, v69
    v_exp_f32 v70, v70
    v_exp_f32 v71, v71
    v_exp_f32 v72, v72
    v_exp_f32 v73, v73
    v_exp_f32 v74, v74
    v_exp_f32 v75, v75
    v_exp_f32 v76, v76
    v_exp_f32 v77, v77
    v_exp_f32 v78, v78
    v_exp_f32 v79, v79
    v_exp_f32 v80, v80
    v_exp_f32 v81, v81
    v_exp_f32 v82, v82
    v_exp_f32 v83, v83
    v_exp_f32 v84, v84
    v_exp_f32 v85, v85
    v_exp_f32 v86, v86
    v_exp_f32 v87, v87
    v_exp_f32 v88, v88
    v_exp_f32 v89, v89
    v_exp_f32 v90, v90
    v_exp_f32 v91, v91
    v_exp_f32 v92, v92
    v_exp_f32 v93, v93
    v_exp_f32 v94, v94
    v_exp_f32 v95, v95
    v_exp_f32 v96, v96
    v_exp_f32 v97, v97
    v_exp_f32 v98, v98
    v_exp_f32 v99, v99
    v_exp_f32 v100, v100
    v_exp_f32 v101, v101
    v_exp_f32 v102, v102
    v_exp_f32 v103, v103
    v_exp_f32 v104, v104
    v_exp_f32 v105, v105
    v_exp_f32 v106, v106
    v_exp_f32 v107, v107
    v_exp_f32 v108, v108
    v_exp_f32 v109, v109
    v_exp_f32 v110, v110
    v_exp_f32 v111, v111
    v_exp_f32 v112, v112
    v_exp_f32 v113, v113
    v_exp_f32 v114, v114
    v_exp_f32 v115, v115
    v_exp_f32 v116, v116
    v_exp_f32 v117, v117
    v_exp_f32 v118, v118
    v_exp_f32 v119, v119
    v_exp_f32 v120, v120
    v_exp_f32 v121, v121
    v_exp_f32 v122, v122
    v_exp_f32 v123, v123
    v_exp_f32 v124, v124
    v_exp_f32 v125, v125
    v_exp_f32 v126, v126
    v_exp_f32 v127, v127
    v_exp_f32 v128, v128
    v_exp_f32 v129, v129
    v_exp_f32 v130, v130
    v_exp_f32 v131, v131
    v_mul_f32 v164, v164, v183
    v_mul_f32 v165, v165, v183
    v_mul_f32 v166, v166, v183
    v_mul_f32 v167, v167, v183
    v_mul_f32 v168, v168, v183
    v_mul_f32 v169, v169, v183
    v_mul_f32 v170, v170, v183
    v_mul_f32 v171, v171, v183
    v_mul_f32 v172, v172, v183
    v_mul_f32 v173, v173, v183
    v_mul_f32 v174, v174, v183
    v_mul_f32 v175, v175, v183
    v_mul_f32 v176, v176, v183
    v_mul_f32 v177, v177, v183
    v_mul_f32 v178, v178, v183
    v_mul_f32 v179, v179, v183
    v_cvt_pk_bf16_f32 v132, v68, v69
    v_cvt_pk_bf16_f32 v133, v70, v71
    v_cvt_pk_bf16_f32 v134, v72, v73
    v_cvt_pk_bf16_f32 v135, v74, v75
    v_cvt_pk_bf16_f32 v136, v76, v77
    v_cvt_pk_bf16_f32 v137, v78, v79
    v_cvt_pk_bf16_f32 v138, v80, v81
    v_cvt_pk_bf16_f32 v139, v82, v83
    v_cvt_pk_bf16_f32 v140, v84, v85
    v_cvt_pk_bf16_f32 v141, v86, v87
    v_cvt_pk_bf16_f32 v142, v88, v89
    v_cvt_pk_bf16_f32 v143, v90, v91
    v_cvt_pk_bf16_f32 v144, v92, v93
    v_cvt_pk_bf16_f32 v145, v94, v95
    v_cvt_pk_bf16_f32 v146, v96, v97
    v_cvt_pk_bf16_f32 v147, v98, v99
    v_cvt_pk_bf16_f32 v148, v100, v101
    v_cvt_pk_bf16_f32 v149, v102, v103
    v_cvt_pk_bf16_f32 v150, v104, v105
    v_cvt_pk_bf16_f32 v151, v106, v107
    v_cvt_pk_bf16_f32 v152, v108, v109
    v_cvt_pk_bf16_f32 v153, v110, v111
    v_cvt_pk_bf16_f32 v154, v112, v113
    v_cvt_pk_bf16_f32 v155, v114, v115
    v_cvt_pk_bf16_f32 v156, v116, v117
    v_cvt_pk_bf16_f32 v157, v118, v119
    v_cvt_pk_bf16_f32 v158, v120, v121
    v_cvt_pk_bf16_f32 v159, v122, v123
    v_cvt_pk_bf16_f32 v160, v124, v125
    v_cvt_pk_bf16_f32 v161, v126, v127
    v_cvt_pk_bf16_f32 v162, v128, v129
    v_cvt_pk_bf16_f32 v163, v130, v131
    s_waitcnt lgkmcnt(0)
    s_nop 0
    v_mfma_f32_32x32x16_bf16 v[164:179], v[32:35], v[132:135], v[164:179]
    v_mfma_f32_32x32x16_bf16 v[164:179], v[36:39], v[136:139], v[164:179]
    v_mfma_f32_32x32x16_bf16 v[164:179], v[40:43], v[140:143], v[164:179]
    v_mfma_f32_32x32x16_bf16 v[164:179], v[44:47], v[144:147], v[164:179]
    v_mfma_f32_32x32x16_bf16 v[164:179], v[48:51], v[148:151], v[164:179]
    v_mfma_f32_32x32x16_bf16 v[164:179], v[52:55], v[152:155], v[164:179]
    v_mfma_f32_32x32x16_bf16 v[164:179], v[56:59], v[156:159], v[164:179]
    v_mfma_f32_32x32x16_bf16 v[164:179], v[60:63], v[160:163], v[164:179]
    s_add_u32 s28, s28, 1
    s_cmp_lt_u32 s28, 16
    s_cbranch_scc1 attnb_kernel_loop
    s_nop 7
    s_nop 7
    v_mov_b32 v181, v172
    v_mov_b32 v182, v172
    s_nop 1
    v_permlane32_swap_b32 v181, v182
    v_rcp_f32 v181, v181
    s_nop 0
    v_mul_f32 v164, v164, v181
    v_mul_f32 v165, v165, v181
    v_mul_f32 v166, v166, v181
    v_mul_f32 v167, v167, v181
    v_mul_f32 v168, v168, v181
    v_mul_f32 v169, v169, v181
    v_mul_f32 v170, v170, v181
    v_mul_f32 v171, v171, v181
    v_cvt_pk_bf16_f32 v188, v164, v165
    v_cvt_pk_bf16_f32 v189, v166, v167
    v_cvt_pk_bf16_f32 v190, v168, v169
    v_cvt_pk_bf16_f32 v191, v170, v171
    s_nop 1
    v_permlane32_swap_b32 v188, v190
    v_permlane32_swap_b32 v189, v191
    s_lshl_b32 s9, s8, 5
    s_add_u32 s9, s9, s7
    s_lshl_b32 s9, s9, 10
    buffer_store_dwordx4 v[188:191], v5, s[20:23], s9 offen
attnb_kernel_end:
    s_endpgm

.globl outp_kernel
.p2align 8
.type outp_kernel,@function
outp_kernel:
    s_cmp_ge_u32 s2, 256
    s_cbranch_scc1 outp_kernel_end
    s_load_dwordx2 s[4:5], s[0:1], 112
    s_load_dwordx2 s[6:7], s[0:1], 40
    s_load_dwordx2 s[8:9], s[0:1], 80
    s_load_dwordx2 s[10:11], s[0:1], 96
    v_lshrrev_b32 v4, 6, v0
    v_and_b32 v1, 63, v0
    v_and_b32 v2, 31, v0
    v_lshrrev_b32 v3, 5, v1
    v_lshlrev_b32 v6, 4, v1
    s_nop 0
    v_readfirstlane_b32 s12, v4
    s_waitcnt lgkmcnt(0)
    s_add_u32 s20, s4, 0x3000000
    s_addc_u32 s21, s5, 0x0
    s_mov_b32 s22, 0x1000000
    s_mov_b32 s23, 0x00020000
    s_add_u32 s24, s4, 0x4400000
    s_addc_u32 s25, s5, 0x0
    s_mov_b32 s26, 0x200000
    s_mov_b32 s27, 0x00020000
    s_mov_b32 s28, s6
    s_mov_b32 s29, s7
    s_mov_b32 s30, 0x400000
    s_mov_b32 s31, 0x00020000
    s_mov_b32 s32, s8
    s_mov_b32 s33, s9
    s_mov_b32 s34, 0x80000
    s_mov_b32 s35, 0x00020000
    s_add_u32 s36, s4, 0x4220000
    s_addc_u32 s37, s5, 0x0
    s_mov_b32 s38, 0x4000
    s_mov_b32 s39, 0x00020000
    s_mov_b32 s40, s10
    s_mov_b32 s41, s11
    s_mov_b32 s42, 0x200000
    s_mov_b32 s43, 0x00020000
    s_and_b32 s14, s2, 7
    s_lshr_b32 s13, s2, 3
    s_lshr_b32 s15, s12, 1
    s_lshl_b32 s44, s13, 1
    s_add_u32 s44, s44, s15
    s_and_b32 s45, s12, 1
    v_lshrrev_b32 v4, 3, v1
    v_lshrrev_b32 v5, 1, v4
    v_and_b32 v5, 1, v5
    v_lshlrev_b32 v5, 2, v5
    v_and_b32 v7, 7, v1
    v_xor_b32 v7, v7, v5
    v_lshlrev_b32 v7, 4, v7
    v_lshlrev_b32 v4, 10, v4
    v_add_u32 v7, v7, v4
    s_lshl_b32 s46, s12, 14
    s_lshl_b32 s15, s14, 7
    s_add_u32 s46, s46, s15
    s_lshl_b32 s47, s12, 11
    v_lshrrev_b32 v8, 4, v1
    v_and_b32 v9, 15, v1
    v_lshrrev_b32 v9, 2, v9
    v_lshrrev_b32 v4, 1, v8
    v_lshlrev_b32 v4, 3, v4
    v_add_u32 v4, v4, v9
    v_lshlrev_b32 v4, 7, v4
    v_lshrrev_b32 v5, 1, v9
    v_xor_b32 v5, s45, v5
    v_lshlrev_b32 v5, 6, v5
    v_add_u32 v4, v4, v5
    v_and_b32 v5, 1, v8
    v_lshlrev_b32 v5, 5, v5
    v_add_u32 v4, v4, v5
    v_and_b32 v5, 3, v1
    v_lshlrev_b32 v5, 3, v5
    v_add_u32 v10, v4, v5
    v_mov_b32 v12, 0
    v_mov_b32 v13, 0
    v_mov_b32 v14, 0
    v_mov_b32 v15, 0
    v_mov_b32 v16, 0
    v_mov_b32 v17, 0
    v_mov_b32 v18, 0
    v_mov_b32 v19, 0
    v_mov_b32 v20, 0
    v_mov_b32 v21, 0
    v_mov_b32 v22, 0
    v_mov_b32 v23, 0
    v_mov_b32 v24, 0
    v_mov_b32 v25, 0
    v_mov_b32 v26, 0
    v_mov_b32 v27, 0
    s_lshl_b32 s49, s44, 18
    s_mov_b32 s50, s46
    s_waitcnt vmcnt(0)
    s_barrier
    s_add_u32 s15, s50, 0x0
    s_add_u32 m0, s47, 0x0
    buffer_load_dwordx4 v7, s[28:31], s15 offen lds
    s_add_u32 s15, s50, 0x2000
    s_add_u32 m0, s47, 0x400
    buffer_load_dwordx4 v7, s[28:31], s15 offen lds
    s_add_u32 s50, s50, 65536
    buffer_load_dwordx4 v[44:47], v6, s[20:23], s49 offen offset:0
    buffer_load_dwordx4 v[48:51], v6, s[20:23], s49 offen offset:1024
    buffer_load_dwordx4 v[52:55], v6, s[20:23], s49 offen offset:2048
    buffer_load_dwordx4 v[56:59], v6, s[20:23], s49 offen offset:3072
    s_add_u32 s49, s49, 4096
    s_add_u32 s15, s50, 0x0
    s_add_u32 m0, s47, 0x2000
    buffer_load_dwordx4 v7, s[28:31], s15 offen lds
    s_add_u32 s15, s50, 0x2000
    s_add_u32 m0, s47, 0x2400
    buffer_load_dwordx4 v7, s[28:31], s15 offen lds
    s_add_u32 s50, s50, 65536
    buffer_load_dwordx4 v[60:63], v6, s[20:23], s49 offen offset:0
    buffer_load_dwordx4 v[64:67], v6, s[20:23], s49 offen offset:1024
    buffer_load_dwordx4 v[68:71], v6, s[20:23], s49 offen offset:2048
    buffer_load_dwordx4 v[72:75], v6, s[20:23], s49 offen offset:3072
    s_add_u32 s49, s49, 4096
    s_add_u32 s15, s50, 0x0
    s_add_u32 m0, s47, 0x4000
    buffer_load_dwordx4 v7, s[28:31], s15 offen lds
    s_add_u32 s15, s50, 0x2000
    s_add_u32 m0, s47, 0x4400
    buffer_load_dwordx4 v7, s[28:31], s15 offen lds
    s_add_u32 s50, s50, 65536
    buffer_load_dwordx4 v[76:79], v6, s[20:23], s49 offen offset:0
    buffer_load_dwordx4 v[80:83], v6, s[20:23], s49 offen offset:1024
    buffer_load_dwordx4 v[84:87], v6, s[20:23], s49 offen offset:2048
    buffer_load_dwordx4 v[88:91], v6, s[20:23], s49 offen offset:3072
    s_add_u32 s49, s49, 4096
    s_mov_b32 s48, 0
outp_kernel_seg0:
    s_waitcnt vmcnt(12)
    s_barrier
    s_add_u32 s15, s50, 0x0
    s_add_u32 m0, s47, 0x6000
    buffer_load_dwordx4 v7, s[28:31], s15 offen lds
    s_add_u32 s15, s50, 0x2000
    s_add_u32 m0, s47, 0x6400
    buffer_load_dwordx4 v7, s[28:31], s15 offen lds
    s_add_u32 s50, s50, 65536
    buffer_load_dwordx4 v[92:95], v6, s[20:23], s49 offen offset:0
    buffer_load_dwordx4 v[96:99], v6, s[20:23], s49 offen offset:1024
    buffer_load_dwordx4 v[100:103], v6, s[20:23], s49 offen offset:2048
    buffer_load_dwordx4 v[104:107], v6, s[20:23], s49 offen offset:3072
    s_add_u32 s49, s49, 4096
    ds_read_b64_tr_b16 v[108:109], v10 offset:0
    ds_read_b64_tr_b16 v[110:111], v10 offset:512
    ds_read_b64_tr_b16 v[112:113], v10 offset:2048
    ds_read_b64_tr_b16 v[114:115], v10 offset:2560
    ds_read_b64_tr_b16 v[116:117], v10 offset:4096
    ds_read_b64_tr_b16 v[118:119], v10 offset:4608
    ds_read_b64_tr_b16 v[120:121], v10 offset:6144
    ds_read_b64_tr_b16 v[122:123], v10 offset:6656
    s_waitcnt lgkmcnt(6)
    v_mfma_f32_32x32x16_bf16 v[12:27], v[108:111], v[44:47], v[12:27]
    s_waitcnt lgkmcnt(4)
    v_mfma_f32_32x32x16_bf16 v[12:27], v[112:115], v[48:51], v[12:27]
    s_waitcnt lgkmcnt(2)
    v_mfma_f32_32x32x16_bf16 v[12:27], v[116:119], v[52:55], v[12:27]
    s_waitcnt lgkmcnt(0)
    v_mfma_f32_32x32x16_bf16 v[12:27], v[120:123], v[56:59], v[12:27]
    s_waitcnt vmcnt(12)
    s_barrier
    s_add_u32 s15, s50, 0x0
    s_add_u32 m0, s47, 0x0
    buffer_load_dwordx4 v7, s[28:31], s15 offen lds
    s_add_u32 s15, s50, 0x2000
    s_add_u32 m0, s47, 0x400
    buffer_load_dwordx4 v7, s[28:31], s15 offen lds
    s_add_u32 s50, s50, 65536
    buffer_load_dwordx4 v[44:47], v6, s[20:23], s49 offen offset:0
    buffer_load_dwordx4 v[48:51], v6, s[20:23], s49 offen offset:1024
    buffer_load_dwordx4 v[52:55], v6, s[20:23], s49 offen offset:2048
    buffer_load_dwordx4 v[56:59], v6, s[20:23], s49 offen offset:3072
    s_add_u32 s49, s49, 4096
    ds_read_b64_tr_b16 v[124:125], v10 offset:8192
    ds_read_b64_tr_b16 v[126:127], v10 offset:8704
    ds_read_b64_tr_b16 v[128:129], v10 offset:10240
    ds_read_b64_tr_b16 v[130:131], v10 offset:10752
    ds_read_b64_tr_b16 v[132:133], v10 offset:12288
    ds_read_b64_tr_b16 v[134:135], v10 offset:12800
    ds_read_b64_tr_b16 v[136:137], v10 offset:14336
    ds_read_b64_tr_b16 v[138:139], v10 offset:14848
    s_waitcnt lgkmcnt(6)
    v_mfma_f32_32x32x16_bf16 v[12:27], v[124:127], v[60:63], v[12:27]
    s_waitcnt lgkmcnt(4)
    v_mfma_f32_32x32x16_bf16 v[12:27], v[128:131], v[64:67], v[12:27]
    s_waitcnt lgkmcnt(2)
    v_mfma_f32_32x32x16_bf16 v[12:27], v[132:135], v[68:71], v[12:27]
    s_waitcnt lgkmcnt(0)
    v_mfma_f32_32x32x16_bf16 v[12:27], v[136:139], v[72:75], v[12:27]
    s_waitcnt vmcnt(12)
    s_barrier
    s_add_u32 s15, s50, 0x0
    s_add_u32 m0, s47, 0x2000
    buffer_load_dwordx4 v7, s[28:31], s15 offen lds
    s_add_u32 s15, s50, 0x2000
    s_add_u32 m0, s47, 0x2400
    buffer_load_dwordx4 v7, s[28:31], s15 offen lds
    s_add_u32 s50, s50, 65536
    buffer_load_dwordx4 v[60:63], v6, s[20:23], s49 offen offset:0
    buffer_load_dwordx4 v[64:67], v6, s[20:23], s49 offen offset:1024
    buffer_load_dwordx4 v[68:71], v6, s[20:23], s49 offen offset:2048
    buffer_load_dwordx4 v[72:75], v6, s[20:23], s49 offen offset:3072
    s_add_u32 s49, s49, 4096
    ds_read_b64_tr_b16 v[108:109], v10 offset:16384
    ds_read_b64_tr_b16 v[110:111], v10 offset:16896
    ds_read_b64_tr_b16 v[112:113], v10 offset:18432
    ds_read_b64_tr_b16 v[114:115], v10 offset:18944
    ds_read_b64_tr_b16 v[116:117], v10 offset:20480
    ds_read_b64_tr_b16 v[118:119], v10 offset:20992
    ds_read_b64_tr_b16 v[120:121], v10 offset:22528
    ds_read_b64_tr_b16 v[122:123], v10 offset:23040
    s_waitcnt lgkmcnt(6)
    v_mfma_f32_32x32x16_bf16 v[12:27], v[108:111], v[76:79], v[12:27]
    s_waitcnt lgkmcnt(4)
    v_mfma_f32_32x32x16_bf16 v[12:27], v[112:115], v[80:83], v[12:27]
    s_waitcnt lgkmcnt(2)
    v_mfma_f32_32x32x16_bf16 v[12:27], v[116:119], v[84:87], v[12:27]
    s_waitcnt lgkmcnt(0)
    v_mfma_f32_32x32x16_bf16 v[12:27], v[120:123], v[88:91], v[12:27]
    s_waitcnt vmcnt(12)
    s_barrier
    s_add_u32 s15, s50, 0x0
    s_add_u32 m0, s47, 0x4000
    buffer_load_dwordx4 v7, s[28:31], s15 offen lds
    s_add_u32 s15, s50, 0x2000
    s_add_u32 m0, s47, 0x4400
    buffer_load_dwordx4 v7, s[28:31], s15 offen lds
    s_add_u32 s50, s50, 65536
    buffer_load_dwordx4 v[76:79], v6, s[20:23], s49 offen offset:0
    buffer_load_dwordx4 v[80:83], v6, s[20:23], s49 offen offset:1024
    buffer_load_dwordx4 v[84:87], v6, s[20:23], s49 offen offset:2048
    buffer_load_dwordx4 v[88:91], v6, s[20:23], s49 offen offset:3072
    s_add_u32 s49, s49, 4096
    ds_read_b64_tr_b16 v[124:125], v10 offset:24576
    ds_read_b64_tr_b16 v[126:127], v10 offset:25088
    ds_read_b64_tr_b16 v[128:129], v10 offset:26624
    ds_read_b64_tr_b16 v[130:131], v10 offset:27136
    ds_read_b64_tr_b16 v[132:133], v10 offset:28672
    ds_read_b64_tr_b16 v[134:135], v10 offset:29184
    ds_read_b64_tr_b16 v[136:137], v10 offset:30720
    ds_read_b64_tr_b16 v[138:139], v10 offset:31232
    s_waitcnt lgkmcnt(6)
    v_mfma_f32_32x32x16_bf16 v[12:27], v[124:127], v[92:95], v[12:27]
    s_waitcnt lgkmcnt(4)
    v_mfma_f32_32x32x16_bf16 v[12:27], v[128:131], v[96:99], v[12:27]
    s_waitcnt lgkmcnt(2)
    v_mfma_f32_32x32x16_bf16 v[12:27], v[132:135], v[100:103], v[12:27]
    s_waitcnt lgkmcnt(0)
    v_mfma_f32_32x32x16_bf16 v[12:27], v[136:139], v[104:107], v[12:27]
    s_add_u32 s48, s48, 4
    s_cmp_lt_u32 s48, 64
    s_cbranch_scc1 outp_kernel_seg0
    v_mov_b32 v28, 0
    v_mov_b32 v29, 0
    v_mov_b32 v30, 0
    v_mov_b32 v31, 0
    v_mov_b32 v32, 0
    v_mov_b32 v33, 0
    v_mov_b32 v34, 0
    v_mov_b32 v35, 0
    v_mov_b32 v36, 0
    v_mov_b32 v37, 0
    v_mov_b32 v38, 0
    v_mov_b32 v39, 0
    v_mov_b32 v40, 0
    v_mov_b32 v41, 0
    v_mov_b32 v42, 0
    v_mov_b32 v43, 0
    s_lshl_b32 s49, s44, 15
    s_mov_b32 s50, s46
    s_waitcnt vmcnt(0)
    s_barrier
    s_add_u32 s15, s50, 0x0
    s_add_u32 m0, s47, 0x0
    buffer_load_dwordx4 v7, s[32:35], s15 offen lds
    s_add_u32 s15, s50, 0x2000
    s_add_u32 m0, s47, 0x400
    buffer_load_dwordx4 v7, s[32:35], s15 offen lds
    s_add_u32 s50, s50, 65536
    buffer_load_dwordx4 v[44:47], v6, s[24:27], s49 offen offset:0
    buffer_load_dwordx4 v[48:51], v6, s[24:27], s49 offen offset:1024
    buffer_load_dwordx4 v[52:55], v6, s[24:27], s49 offen offset:2048
    buffer_load_dwordx4 v[56:59], v6, s[24:27], s49 offen offset:3072
    s_add_u32 s49, s49, 4096
    s_add_u32 s15, s50, 0x0
    s_add_u32 m0, s47, 0x2000
    buffer_load_dwordx4 v7, s[32:35], s15 offen lds
    s_add_u32 s15, s50, 0x2000
    s_add_u32 m0, s47, 0x2400
    buffer_load_dwordx4 v7, s[32:35], s15 offen lds
    s_add_u32 s50, s50, 65536
    buffer_load_dwordx4 v[60:63], v6, s[24:27], s49 offen offset:0
    buffer_load_dwordx4 v[64:67], v6, s[24:27], s49 offen offset:1024
    buffer_load_dwordx4 v[68:71], v6, s[24:27], s49 offen offset:2048
    buffer_load_dwordx4 v[72:75], v6, s[24:27], s49 offen offset:3072
    s_add_u32 s49, s49, 4096
    s_add_u32 s15, s50, 0x0
    s_add_u32 m0, s47, 0x4000
    buffer_load_dwordx4 v7, s[32:35], s15 offen lds
    s_add_u32 s15, s50, 0x2000
    s_add_u32 m0, s47, 0x4400
    buffer_load_dwordx4 v7, s[32:35], s15 offen lds
    s_add_u32 s50, s50, 65536
    buffer_load_dwordx4 v[76:79], v6, s[24:27], s49 offen offset:0
    buffer_load_dwordx4 v[80:83], v6, s[24:27], s49 offen offset:1024
    buffer_load_dwordx4 v[84:87], v6, s[24:27], s49 offen offset:2048
    buffer_load_dwordx4 v[88:91], v6, s[24:27], s49 offen offset:3072
    s_add_u32 s49, s49, 4096
    s_mov_b32 s48, 0
outp_kernel_seg1:
    s_waitcnt vmcnt(12)
    s_barrier
    s_add_u32 s15, s50, 0x0
    s_add_u32 m0, s47, 0x6000
    buffer_load_dwordx4 v7, s[32:35], s15 offen lds
    s_add_u32 s15, s50, 0x2000
    s_add_u32 m0, s47, 0x6400
    buffer_load_dwordx4 v7, s[32:35], s15 offen lds
    s_add_u32 s50, s50, 65536
    buffer_load_dwordx4 v[92:95], v6, s[24:27], s49 offen offset:0
    buffer_load_dwordx4 v[96:99], v6, s[24:27], s49 offen offset:1024
    buffer_load_dwordx4 v[100:103], v6, s[24:27], s49 offen offset:2048
    buffer_load_dwordx4 v[104:107], v6, s[24:27], s49 offen offset:3072
    s_add_u32 s49, s49, 4096
    ds_read_b64_tr_b16 v[108:109], v10 offset:0
    ds_read_b64_tr_b16 v[110:111], v10 offset:512
    ds_read_b64_tr_b16 v[112:113], v10 offset:2048
    ds_read_b64_tr_b16 v[114:115], v10 offset:2560
    ds_read_b64_tr_b16 v[116:117], v10 offset:4096
    ds_read_b64_tr_b16 v[118:119], v10 offset:4608
    ds_read_b64_tr_b16 v[120:121], v10 offset:6144
    ds_read_b64_tr_b16 v[122:123], v10 offset:6656
    s_waitcnt lgkmcnt(6)
    v_mfma_f32_32x32x16_bf16 v[28:43], v[108:111], v[44:47], v[28:43]
    s_waitcnt lgkmcnt(4)
    v_mfma_f32_32x32x16_bf16 v[28:43], v[112:115], v[48:51], v[28:43]
    s_waitcnt lgkmcnt(2)
    v_mfma_f32_32x32x16_bf16 v[28:43], v[116:119], v[52:55], v[28:43]
    s_waitcnt lgkmcnt(0)
    v_mfma_f32_32x32x16_bf16 v[28:43], v[120:123], v[56:59], v[28:43]
    s_waitcnt vmcnt(12)
    s_barrier
    s_add_u32 s15, s50, 0x0
    s_add_u32 m0, s47, 0x0
    buffer_load_dwordx4 v7, s[32:35], s15 offen lds
    s_add_u32 s15, s50, 0x2000
    s_add_u32 m0, s47, 0x400
    buffer_load_dwordx4 v7, s[32:35], s15 offen lds
    s_add_u32 s50, s50, 65536
    buffer_load_dwordx4 v[44:47], v6, s[24:27], s49 offen offset:0
    buffer_load_dwordx4 v[48:51], v6, s[24:27], s49 offen offset:1024
    buffer_load_dwordx4 v[52:55], v6, s[24:27], s49 offen offset:2048
    buffer_load_dwordx4 v[56:59], v6, s[24:27], s49 offen offset:3072
    s_add_u32 s49, s49, 4096
    ds_read_b64_tr_b16 v[124:125], v10 offset:8192
    ds_read_b64_tr_b16 v[126:127], v10 offset:8704
    ds_read_b64_tr_b16 v[128:129], v10 offset:10240
    ds_read_b64_tr_b16 v[130:131], v10 offset:10752
    ds_read_b64_tr_b16 v[132:133], v10 offset:12288
    ds_read_b64_tr_b16 v[134:135], v10 offset:12800
    ds_read_b64_tr_b16 v[136:137], v10 offset:14336
    ds_read_b64_tr_b16 v[138:139], v10 offset:14848
    s_waitcnt lgkmcnt(6)
    v_mfma_f32_32x32x16_bf16 v[28:43], v[124:127], v[60:63], v[28:43]
    s_waitcnt lgkmcnt(4)
    v_mfma_f32_32x32x16_bf16 v[28:43], v[128:131], v[64:67], v[28:43]
    s_waitcnt lgkmcnt(2)
    v_mfma_f32_32x32x16_bf16 v[28:43], v[132:135], v[68:71], v[28:43]
    s_waitcnt lgkmcnt(0)
    v_mfma_f32_32x32x16_bf16 v[28:43], v[136:139], v[72:75], v[28:43]
    s_waitcnt vmcnt(12)
    s_barrier
    s_add_u32 s15, s50, 0x0
    s_add_u32 m0, s47, 0x2000
    buffer_load_dwordx4 v7, s[32:35], s15 offen lds
    s_add_u32 s15, s50, 0x2000
    s_add_u32 m0, s47, 0x2400
    buffer_load_dwordx4 v7, s[32:35], s15 offen lds
    s_add_u32 s50, s50, 65536
    buffer_load_dwordx4 v[60:63], v6, s[24:27], s49 offen offset:0
    buffer_load_dwordx4 v[64:67], v6, s[24:27], s49 offen offset:1024
    buffer_load_dwordx4 v[68:71], v6, s[24:27], s49 offen offset:2048
    buffer_load_dwordx4 v[72:75], v6, s[24:27], s49 offen offset:3072
    s_add_u32 s49, s49, 4096
    ds_read_b64_tr_b16 v[108:109], v10 offset:16384
    ds_read_b64_tr_b16 v[110:111], v10 offset:16896
    ds_read_b64_tr_b16 v[112:113], v10 offset:18432
    ds_read_b64_tr_b16 v[114:115], v10 offset:18944
    ds_read_b64_tr_b16 v[116:117], v10 offset:20480
    ds_read_b64_tr_b16 v[118:119], v10 offset:20992
    ds_read_b64_tr_b16 v[120:121], v10 offset:22528
    ds_read_b64_tr_b16 v[122:123], v10 offset:23040
    s_waitcnt lgkmcnt(6)
    v_mfma_f32_32x32x16_bf16 v[28:43], v[108:111], v[76:79], v[28:43]
    s_waitcnt lgkmcnt(4)
    v_mfma_f32_32x32x16_bf16 v[28:43], v[112:115], v[80:83], v[28:43]
    s_waitcnt lgkmcnt(2)
    v_mfma_f32_32x32x16_bf16 v[28:43], v[116:119], v[84:87], v[28:43]
    s_waitcnt lgkmcnt(0)
    v_mfma_f32_32x32x16_bf16 v[28:43], v[120:123], v[88:91], v[28:43]
    s_waitcnt vmcnt(12)
    s_barrier
    s_add_u32 s15, s50, 0x0
    s_add_u32 m0, s47, 0x4000
    buffer_load_dwordx4 v7, s[32:35], s15 offen lds
    s_add_u32 s15, s50, 0x2000
    s_add_u32 m0, s47, 0x4400
    buffer_load_dwordx4 v7, s[32:35], s15 offen lds
    s_add_u32 s50, s50, 65536
    buffer_load_dwordx4 v[76:79], v6, s[24:27], s49 offen offset:0
    buffer_load_dwordx4 v[80:83], v6, s[24:27], s49 offen offset:1024
    buffer_load_dwordx4 v[84:87], v6, s[24:27], s49 offen offset:2048
    buffer_load_dwordx4 v[88:91], v6, s[24:27], s49 offen offset:3072
    s_add_u32 s49, s49, 4096
    ds_read_b64_tr_b16 v[124:125], v10 offset:24576
    ds_read_b64_tr_b16 v[126:127], v10 offset:25088
    ds_read_b64_tr_b16 v[128:129], v10 offset:26624
    ds_read_b64_tr_b16 v[130:131], v10 offset:27136
    ds_read_b64_tr_b16 v[132:133], v10 offset:28672
    ds_read_b64_tr_b16 v[134:135], v10 offset:29184
    ds_read_b64_tr_b16 v[136:137], v10 offset:30720
    ds_read_b64_tr_b16 v[138:139], v10 offset:31232
    s_waitcnt lgkmcnt(6)
    v_mfma_f32_32x32x16_bf16 v[28:43], v[124:127], v[92:95], v[28:43]
    s_waitcnt lgkmcnt(4)
    v_mfma_f32_32x32x16_bf16 v[28:43], v[128:131], v[96:99], v[28:43]
    s_waitcnt lgkmcnt(2)
    v_mfma_f32_32x32x16_bf16 v[28:43], v[132:135], v[100:103], v[28:43]
    s_waitcnt lgkmcnt(0)
    v_mfma_f32_32x32x16_bf16 v[28:43], v[136:139], v[104:107], v[28:43]
    s_add_u32 s48, s48, 4
    s_cmp_lt_u32 s48, 8
    s_cbranch_scc1 outp_kernel_seg1
    s_waitcnt vmcnt(0)
    s_lshl_b32 s15, s44, 7
    v_lshlrev_b32 v4, 2, v2
    v_add_u32 v4, s15, v4
    buffer_load_dword v140, v4, s[36:39], 0 offen
    v_add_u32 v4, 8192, v4
    buffer_load_dword v141, v4, s[36:39], 0 offen
    s_nop 7
    s_nop 7
    s_waitcnt vmcnt(0)
    v_cvt_pk_bf16_f32 v142, v12, v28
    v_and_b32 v143, 0xffff0000, v142
    v_lshlrev_b32 v142, 16, v142
    v_mul_f32 v142, v142, v140
    v_mul_f32 v143, v143, v141
    v_cvt_pk_bf16_f32 v142, v142, v143
    v_and_b32 v143, 0xffff0000, v142
    v_lshlrev_b32 v142, 16, v142
    v_add_f32 v12, v142, v143
    v_cvt_pk_bf16_f32 v142, v13, v29
    v_and_b32 v143, 0xffff0000, v142
    v_lshlrev_b32 v142, 16, v142
    v_mul_f32 v142, v142, v140
    v_mul_f32 v143, v143, v141
    v_cvt_pk_bf16_f32 v142, v142, v143
    v_and_b32 v143, 0xffff0000, v142
    v_lshlrev_b32 v142, 16, v142
    v_add_f32 v13, v142, v143
    v_cvt_pk_bf16_f32 v142, v14, v30
    v_and_b32 v143, 0xffff0000, v142
    v_lshlrev_b32 v142, 16, v142
    v_mul_f32 v142, v142, v140
    v_mul_f32 v143, v143, v141
    v_cvt_pk_bf16_f32 v142, v142, v143
    v_and_b32 v143, 0xffff0000, v142
    v_lshlrev_b32 v142, 16, v142
    v_add_f32 v14, v142, v143
    v_cvt_pk_bf16_f32 v142, v15, v31
    v_and_b32 v143, 0xffff0000, v142
    v_lshlrev_b32 v142, 16, v142
    v_mul_f32 v142, v142, v140
    v_mul_f32 v143, v143, v141
    v_cvt_pk_bf16_f32 v142, v142, v143
    v_and_b32 v143, 0xffff0000, v142
    v_lshlrev_b32 v142, 16, v142
    v_add_f32 v15, v142, v143
    v_cvt_pk_bf16_f32 v142, v16, v32
    v_and_b32 v143, 0xffff0000, v142
    v_lshlrev_b32 v142, 16, v142
    v_mul_f32 v142, v142, v140
    v_mul_f32 v143, v143, v141
    v_cvt_pk_bf16_f32 v142, v142, v143
    v_and_b32 v143, 0xffff0000, v142
    v_lshlrev_b32 v142, 16, v142
    v_add_f32 v16, v142, v143
    v_cvt_pk_bf16_f32 v142, v17, v33
    v_and_b32 v143, 0xffff0000, v142
    v_lshlrev_b32 v142, 16, v142
    v_mul_f32 v142, v142, v140
    v_mul_f32 v143, v143, v141
    v_cvt_pk_bf16_f32 v142, v142, v143
    v_and_b32 v143, 0xffff0000, v142
    v_lshlrev_b32 v142, 16, v142
    v_add_f32 v17, v142, v143
    v_cvt_pk_bf16_f32 v142, v18, v34
    v_and_b32 v143, 0xffff0000, v142
    v_lshlrev_b32 v142, 16, v142
    v_mul_f32 v142, v142, v140
    v_mul_f32 v143, v143, v141
    v_cvt_pk_bf16_f32 v142, v142, v143
    v_and_b32 v143, 0xffff0000, v142
    v_lshlrev_b32 v142, 16, v142
    v_add_f32 v18, v142, v143
    v_cvt_pk_bf16_f32 v142, v19, v35
    v_and_b32 v143, 0xffff0000, v142
    v_lshlrev_b32 v142, 16, v142
    v_mul_f32 v142, v142, v140
    v_mul_f32 v143, v143, v141
    v_cvt_pk_bf16_f32 v142, v142, v143
    v_and_b32 v143, 0xffff0000, v142
    v_lshlrev_b32 v142, 16, v142
    v_add_f32 v19, v142, v143
    v_cvt_pk_bf16_f32 v142, v20, v36
    v_and_b32 v143, 0xffff0000, v142
    v_lshlrev_b32 v142, 16, v142
    v_mul_f32 v142, v142, v140
    v_mul_f32 v143, v143, v141
    v_cvt_pk_bf16_f32 v142, v142, v143
    v_and_b32 v143, 0xffff0000, v142
    v_lshlrev_b32 v142, 16, v142
    v_add_f32 v20, v142, v143
    v_cvt_pk_bf16_f32 v142, v21, v37
    v_and_b32 v143, 0xffff0000, v142
    v_lshlrev_b32 v142, 16, v142
    v_mul_f32 v142, v142, v140
    v_mul_f32 v143, v143, v141
    v_cvt_pk_bf16_f32 v142, v142, v143
    v_and_b32 v143, 0xffff0000, v142
    v_lshlrev_b32 v142, 16, v142
    v_add_f32 v21, v142, v143
    v_cvt_pk_bf16_f32 v142, v22, v38
    v_and_b32 v143, 0xffff0000, v142
    v_lshlrev_b32 v142, 16, v142
    v_mul_f32 v142, v142, v140
    v_mul_f32 v143, v143, v141
    v_cvt_pk_bf16_f32 v142, v142, v143
    v_and_b32 v143, 0xffff0000, v142
    v_lshlrev_b32 v142, 16, v142
    v_add_f32 v22, v142, v143
    v_cvt_pk_bf16_f32 v142, v23, v39
    v_and_b32 v143, 0xffff0000, v142
    v_lshlrev_b32 v142, 16, v142
    v_mul_f32 v142, v142, v140
    v_mul_f32 v143, v143, v141
    v_cvt_pk_bf16_f32 v142, v142, v143
    v_and_b32 v143, 0xffff0000, v142
    v_lshlrev_b32 v142, 16, v142
    v_add_f32 v23, v142, v143
    v_cvt_pk_bf16_f32 v142, v24, v40
    v_and_b32 v143, 0xffff0000, v142
    v_lshlrev_b32 v142, 16, v142
    v_mul_f32 v142, v142, v140
    v_mul_f32 v143, v143, v141
    v_cvt_pk_bf16_f32 v142, v142, v143
    v_and_b32 v143, 0xffff0000, v142
    v_lshlrev_b32 v142, 16, v142
    v_add_f32 v24, v142, v143
    v_cvt_pk_bf16_f32 v142, v25, v41
    v_and_b32 v143, 0xffff0000, v142
    v_lshlrev_b32 v142, 16, v142
    v_mul_f32 v142, v142, v140
    v_mul_f32 v143, v143, v141
    v_cvt_pk_bf16_f32 v142, v142, v143
    v_and_b32 v143, 0xffff0000, v142
    v_lshlrev_b32 v142, 16, v142
    v_add_f32 v25, v142, v143
    v_cvt_pk_bf16_f32 v142, v26, v42
    v_and_b32 v143, 0xffff0000, v142
    v_lshlrev_b32 v142, 16, v142
    v_mul_f32 v142, v142, v140
    v_mul_f32 v143, v143, v141
    v_cvt_pk_bf16_f32 v142, v142, v143
    v_and_b32 v143, 0xffff0000, v142
    v_lshlrev_b32 v142, 16, v142
    v_add_f32 v26, v142, v143
    v_cvt_pk_bf16_f32 v142, v27, v43
    v_and_b32 v143, 0xffff0000, v142
    v_lshlrev_b32 v142, 16, v142
    v_mul_f32 v142, v142, v140
    v_mul_f32 v143, v143, v141
    v_cvt_pk_bf16_f32 v142, v142, v143
    v_and_b32 v143, 0xffff0000, v142
    v_lshlrev_b32 v142, 16, v142
    v_add_f32 v27, v142, v143
    s_lshl_b32 s15, s44, 5
    v_add_u32 v144, s15, v2
    v_lshlrev_b32 v144, 10, v144
    v_lshlrev_b32 v4, 4, v3
    v_add_u32 v144, v144, v4
    s_lshl_b32 s15, s14, 7
    s_lshl_b32 s16, s45, 6
    s_add_u32 s15, s15, s16
    v_cvt_pk_bf16_f32 v148, v12, v13
    v_cvt_pk_bf16_f32 v149, v14, v15
    v_cvt_pk_bf16_f32 v150, v16, v17
    v_cvt_pk_bf16_f32 v151, v18, v19
    s_nop 1
    v_permlane32_swap_b32 v148, v150
    v_permlane32_swap_b32 v149, v151
    buffer_store_dwordx4 v[148:151], v144, s[40:43], s15 offen offset:0
    s_nop 1
    v_cvt_pk_bf16_f32 v148, v20, v21
    v_cvt_pk_bf16_f32 v149, v22, v23
    v_cvt_pk_bf16_f32 v150, v24, v25
    v_cvt_pk_bf16_f32 v151, v26, v27
    s_nop 1
    v_permlane32_swap_b32 v148, v150
    v_permlane32_swap_b32 v149, v151
    buffer_store_dwordx4 v[148:151], v144, s[40:43], s15 offen offset:32
    s_nop 1
outp_kernel_end:
    s_endpgm

.section .rodata,"a"
.p2align 6
.amdhsa_kernel proj_kernel
  .amdhsa_next_free_vgpr 500
  .amdhsa_next_free_sgpr 59
  .amdhsa_accum_offset 244
  .amdhsa_group_segment_fixed_size 0
  .amdhsa_kernarg_size 120
  .amdhsa_user_sgpr_count 2
  .amdhsa_user_sgpr_kernarg_segment_ptr 1
  .amdhsa_system_sgpr_workgroup_id_x 1
.end_amdhsa_kernel

.p2align 6
.amdhsa_kernel projb_kernel
  .amdhsa_next_free_vgpr 500
  .amdhsa_next_free_sgpr 59
  .amdhsa_accum_offset 244
  .amdhsa_group_segment_fixed_size 0
  .amdhsa_kernarg_size 120
  .amdhsa_user_sgpr_count 2
  .amdhsa_user_sgpr_kernarg_segment_ptr 1
  .amdhsa_system_sgpr_workgroup_id_x 1
.end_amdhsa_kernel

.p2align 6
.amdhsa_kernel attna_kernel
  .amdhsa_next_free_vgpr 444
  .amdhsa_next_free_sgpr 44
  .amdhsa_accum_offset 252
  .amdhsa_group_segment_fixed_size 0
  .amdhsa_kernarg_size 120
  .amdhsa_user_sgpr_count 2
  .amdhsa_user_sgpr_kernarg_segment_ptr 1
  .amdhsa_system_sgpr_workgroup_id_x 1
.end_amdhsa_kernel

.p2align 6
.amdhsa_kernel attnb_kernel
  .amdhsa_next_free_vgpr 192
  .amdhsa_next_free_sgpr 29
  .amdhsa_accum_offset 192
  .amdhsa_group_segment_fixed_size 0
  .amdhsa_kernarg_size 120
  .amdhsa_user_sgpr_count 2
  .amdhsa_user_sgpr_kernarg_segment_ptr 1
  .amdhsa_system_sgpr_workgroup_id_x 1
.end_amdhsa_kernel

.p2align 6
.amdhsa_kernel outp_kernel
  .amdhsa_next_free_vgpr 152
  .amdhsa_next_free_sgpr 51
  .amdhsa_accum_offset 152
  .amdhsa_group_segment_fixed_size 0
  .amdhsa_kernarg_size 120
  .amdhsa_user_sgpr_count 2
  .amdhsa_user_sgpr_kernarg_segment_ptr 1
  .amdhsa_system_sgpr_workgroup_id_x 1
.end_amdhsa_kernel
```
